```python
import torch

def _softmax(x, axis=-1):
    return torch.softmax(x, dim=axis)
def _gelu(x):
    return torch.nn.functional.gelu(x, approximate="tanh")
def _silu(x):
    return torch.nn.functional.silu(x)
def _sigmoid(x):
    return torch.sigmoid(x)
def _layernorm(x, axis=-1, eps=1e-5):
    m = x.mean(dim=axis, keepdim=True)
    v = x.var(dim=axis, keepdim=True, unbiased=False)
    return (x - m) / torch.sqrt(v + eps)
def _scatter_add(tgt, idx, src, axis=0):
    return tgt.clone().index_add_(axis, idx, src)
def _segment_sum(src, seg, n):
    out = torch.zeros((n,) + src.shape[1:], dtype=src.dtype)
    return out.index_add_(0, seg, src)
def _pad(x, pw):
    flat = tuple(v for pair in reversed(pw) for v in pair)
    return torch.nn.functional.pad(x, flat)

kernel_name = 'recurrent_scan__sliding_block_cached__glu_gated_glu__prompt'

def setup_inputs():

    _w = (lambda a: (lambda t: t.to(torch.bfloat16) if t.is_floating_point() else t)(torch.as_tensor(a)))
    def _A_setup():
        B, Sq, D = 1, 2048, 512
        Hq, Hkv, Sk, Dh = 32, 8, 2048, 128
        assert Hq % Hkv == 0, (Hq, Hkv)
        return {
            "x": _w((lambda *s: torch.randn(*s, dtype=torch.bfloat16) * 0.05)(B, Sq, D)),
            "k_cache": _w((lambda *s: torch.randn(*s, dtype=torch.bfloat16) * 0.8)(B, Hkv, Sk, Dh)),
            "v_cache": _w((lambda *s: torch.randn(*s, dtype=torch.bfloat16) * 0.2)(B, Hkv, Sk, Dh)),
            "wq": _w((lambda *s: torch.randn(*s, dtype=torch.bfloat16) * 0.8)(D, Hq * Dh) * (D ** -0.5)),
            "wo": _w((lambda *s: torch.randn(*s, dtype=torch.bfloat16) * 0.2)(Hq * Dh, D) * ((Hq * Dh) ** -0.5)),
        }
    _A_in = _A_setup()

    def _B_setup():
        B, S, D, F = 1, 2048, 512, 1792
        return {
            "x": _w((lambda *s: torch.randn(*s, dtype=torch.bfloat16) * 0.05)(B, S, D)),
            "w_gate": _w((lambda *s: torch.randn(*s, dtype=torch.bfloat16) * 0.2)(D, F)),
            "w_up": _w((lambda *s: torch.randn(*s, dtype=torch.bfloat16) * 0.1)(D, F)),
            "w_down": _w((lambda *s: torch.randn(*s, dtype=torch.bfloat16) * 0.1)(F, D)),
        }
    _B_in = _B_setup()

    return {
        "A_x": _A_in["x"],
        "A_k_cache": _A_in["k_cache"],
        "A_v_cache": _A_in["v_cache"],
        "A_wq": _A_in["wq"],
        "A_wo": _A_in["wo"],
        "B_x": _B_in["x"],
        "B_w_gate": _B_in["w_gate"],
        "B_w_up": _B_in["w_up"],
        "B_w_down": _B_in["w_down"],
    }

def reference(A_x, A_k_cache, A_v_cache, A_wq, A_wo, B_x, B_w_gate, B_w_up, B_w_down):
    def _A_ref(x, k_cache, v_cache, wq, wo):
        B, Sq, D = x.shape
        Hq, Dh = 32, 128
        Hkv, Sk = k_cache.shape[1], k_cache.shape[2]
        W = min(4096, max(256, Sk // 4))
        rep = Hq // Hkv
        q = (lambda x, *d: x.permute(*d))((x @ wq).reshape(B, Sq, Hq, Dh), 0, 2, 1, 3)
        k = (lambda x, n, axis: torch.repeat_interleave(x, n, dim=axis))(k_cache[:, :, Sk - W:, :], rep, axis=1)
        v = (lambda x, n, axis: torch.repeat_interleave(x, n, dim=axis))(v_cache[:, :, Sk - W:, :], rep, axis=1)
        scores = torch.einsum("bhqd,bhkd->bhqk", q, k) * (Dh ** -0.5)
        p = _softmax(scores, axis=-1)
        o = torch.einsum("bhqk,bhkd->bhqd", p, v)
        return (lambda x, *d: x.permute(*d))(o, 0, 2, 1, 3).reshape(B, Sq, Hq * Dh) @ wo

    def _B_ref(x, w_gate, w_up, w_down):
        g = torch.einsum("bsd,df->bsf", x, w_gate)
        u = torch.einsum("bsd,df->bsf", x, w_up)
        h = _sigmoid(g) * u
        return torch.einsum("bsf,fd->bsd", h, w_down)

    x = A_x
    xn = _layernorm(x, axis=-1)
    s = _A_ref(xn, A_k_cache, A_v_cache, A_wq, A_wo)
    g = _silu(_B_ref(xn, B_w_gate, B_w_up, B_w_down))
    return x + s * g
```

```asm
; @launch grid=(256,1,1) block=(256,1,1) lds=163840
.amdgcn_target "amdgcn-amd-amdhsa--gfx950"
.text
.globl recurrent_scan__sliding_block_cached__glu_gated_glu__prompt_kernel
.p2align 8
.type recurrent_scan__sliding_block_cached__glu_gated_glu__prompt_kernel,@function
recurrent_scan__sliding_block_cached__glu_gated_glu__prompt_kernel:
  s_cmp_ge_u32 s2, 256
  s_cbranch_scc1 Lmain_end
  s_load_dwordx16 s[72:87], s[0:1], 0
  s_load_dwordx8 s[88:95], s[0:1], 64
  v_lshrrev_b32 v3, 6, v0
  v_lshrrev_b32 v2, 3, v0
  s_lshr_b32 s3, s2, 5
  v_readfirstlane_b32 s4, v3
  v_lshl_add_u32 v2, v3, 3, v2
  s_and_b32 s5, s2, 3
  s_lshl_b32 s3, s3, 2
  s_add_u32 s5, s5, s3
  v_and_b32 v3, 7, v0
  v_lshlrev_b32 v4, 10, v2
  v_lshl_add_u32 v4, v3, 4, v4
  v_add_u32 v5, 8192, v4
  s_lshl_b32 s100, s5, 16
  v_and_b32 v1, 63, v0
  s_and_b32 s6, s2, 4
  s_lshr_b32 s3, s2, 3
  s_add_u32 s3, s3, 0
  s_and_b32 s3, s3, 3
  s_add_u32 s6, s6, s3
  s_mov_b32 s10, 2097152
  s_mov_b32 s11, 0x20000
  s_lshl_b32 s53, s4, 14
  s_add_u32 s52, s53, 98304
  s_lshl_b32 s56, s5, 17
  s_and_b32 s57, s5, 30
  s_and_b32 s69, s5, 27
  s_and_b32 s61, s5, 7
  s_cmp_gt_u32 s6, s61
  s_cselect_b32 s3, 1, 0
  s_sub_u32 s7, s6, s3
  s_min_u32 s7, s7, 6
  s_cmp_eq_u32 s6, s61
  s_cselect_b32 s101, 1, 0
  s_bfe_u32 s3, s2, 0x40003
  s_lshl2_add_u32 s3, s3, s4
  s_lshl_b32 s3, s3, 10
  v_and_b32 v51, 7, v1
  v_lshlrev_b32 v51, 7, v51
  v_add_u32 v51, s3, v51
  s_getpc_b64 s[96:97]
Lpf2:
  v_min_u32 v50, Lmain_end-Lpf2, v51
  global_load_dword v51, v50, s[96:97]
  s_waitcnt lgkmcnt(0)
  s_mov_b32 s8, s72
  s_mov_b32 s9, s73
  buffer_load_dwordx4 v[64:67], v4, s[8:11], s100 offen offset:0
  buffer_load_dwordx4 v[68:71], v4, s[8:11], s100 offen offset:128
  buffer_load_dwordx4 v[72:75], v4, s[8:11], s100 offen offset:256
  s_mov_b32 s28, s84
  s_mov_b32 s29, s85
  s_mov_b32 s30, 1835008
  s_mov_b32 s31, 0x20000
  s_mov_b32 s32, s86
  s_mov_b32 s33, s87
  s_mov_b32 s34, 1835008
  buffer_load_dwordx4 v[76:79], v4, s[8:11], s100 offen offset:384
  s_mov_b32 s35, 0x20000
  s_mov_b32 s20, s78
  s_mov_b32 s21, s79
  s_mov_b32 s22, 4194304
  s_mov_b32 s23, 0x20000
  v_lshrrev_b32 v6, 3, v1
  v_mul_u32_u24 v6, 3584, v6
  buffer_load_dwordx4 v[80:83], v4, s[8:11], s100 offen offset:512
  v_bfe_u32 v7, v1, 4, 1
  v_lshlrev_b32 v7, 2, v7
  v_and_b32 v46, 7, v1
  v_xor_b32 v46, v46, v7
  v_lshl_add_u32 v46, v46, 4, v6
  s_lshl_b32 s54, s7, 9
  s_lshl_b32 s3, s4, 7
  buffer_load_dwordx4 v[84:87], v4, s[8:11], s100 offen offset:640
  s_add_u32 s54, s54, s3
  v_add_u32 v46, s54, v46
  v_add_u32 v47, 27648, v46
  v_lshrrev_b32 v6, 4, v1
  v_and_b32 v7, 15, v1
  v_lshlrev_b32 v48, 2, v6
  v_xor_b32 v48, v48, v7
  buffer_load_dwordx4 v[88:91], v4, s[8:11], s100 offen offset:768
  v_lshlrev_b32 v48, 4, v48
  s_lshl_b32 s55, s6, 10
  s_lshl_b32 s3, s4, 8
  s_add_u32 s55, s55, s3
  v_lshl_add_u32 v38, v6, 13, v48
  v_add_u32 v38, s55, v38
  s_lshl_b32 s55, s4, 12
  buffer_load_dwordx4 v[92:95], v4, s[8:11], s100 offen offset:896
  v_lshl_add_u32 v48, v6, 8, v48
  v_add_u32 v48, s55, v48
  v_add_u32 v39, 31744, v38
  v_add_u32 v40, 63488, v38
  v_add_u32 v41, 95232, v38
  v_lshrrev_b32 v2, 5, v1
  v_bfe_u32 v3, v1, 2, 2
  buffer_load_dwordx4 v[96:99], v5, s[8:11], s100 offen offset:0
  v_lshl_add_u32 v6, v2, 3, v3
  v_bfe_u32 v7, v1, 4, 1
  v_lshlrev_b32 v36, 5, v7
  v_and_b32 v7, 1, v1
  v_lshl_add_u32 v36, v7, 4, v36
  v_bfe_u32 v7, v1, 1, 1
  v_lshl_add_u32 v36, v7, 3, v36
  buffer_load_dwordx4 v[100:103], v5, s[8:11], s100 offen offset:128
  v_add_u32 v36, s52, v36
  v_lshl_add_u32 v37, v6, 7, v36
  v_lshl_add_u32 v36, v6, 8, v36
  v_lshrrev_b32 v6, 1, v3
  v_xor_b32 v7, 0, v3
  v_lshl_add_u32 v24, v7, 6, v36
  v_xor_b32 v7, 1, v3
  buffer_load_dwordx4 v[104:107], v5, s[8:11], s100 offen offset:256
  v_lshl_add_u32 v25, v7, 6, v36
  v_xor_b32 v7, 2, v3
  v_lshl_add_u32 v26, v7, 6, v36
  v_xor_b32 v7, 3, v3
  v_lshl_add_u32 v27, v7, 6, v36
  v_xor_b32 v7, 0, v6
  v_lshl_add_u32 v28, v7, 6, v37
  buffer_load_dwordx4 v[108:111], v5, s[8:11], s100 offen offset:384
  v_xor_b32 v7, 1, v6
  v_lshl_add_u32 v29, v7, 6, v37
  v_and_b32 v3, 31, v1
  v_and_b32 v6, 15, v1
  v_xor_b32 v7, v6, v2
  v_lshlrev_b32 v7, 4, v7
  v_lshl_add_u32 v34, v3, 10, v7
  buffer_load_dwordx4 v[112:115], v5, s[8:11], s100 offen offset:512
  s_lshl_b32 s3, s4, 8
  v_add_u32 v49, s3, v34
  s_lshl_b32 s3, s69, 5
  v_xor_b32 v34, s3, v34
  v_lshrrev_b32 v2, 3, v1
  v_and_b32 v7, 7, v1
  v_xor_b32 v7, v7, v2
  buffer_load_dwordx4 v[116:119], v5, s[8:11], s100 offen offset:640
  v_lshlrev_b32 v7, 4, v7
  v_lshl_add_u32 v52, v2, 10, v7
  v_add_u32 v52, s53, v52
  s_lshl_b32 s3, s4, 6
  s_add_u32 s3, s3, 65536
  v_lshlrev_b32 v53, 2, v2
  v_add_u32 v53, s3, v53
  buffer_load_dwordx4 v[120:123], v5, s[8:11], s100 offen offset:768
  v_lshlrev_b32 v58, 2, v3
  v_add_u32 v58, 65536, v58
  buffer_load_dwordx4 v[124:127], v5, s[8:11], s100 offen offset:896
  s_waitcnt vmcnt(15)
  v_lshlrev_b32 v128, 16, v64
  v_and_b32 v129, 0xffff0000, v64
  v_lshlrev_b32 v130, 16, v65
  v_and_b32 v131, 0xffff0000, v65
  v_pk_add_f32 v[2:3], v[128:129], v[130:131]
  v_lshlrev_b32 v132, 16, v66
  v_and_b32 v133, 0xffff0000, v66
  v_pk_add_f32 v[2:3], v[2:3], v[132:133]
  v_lshlrev_b32 v134, 16, v67
  v_and_b32 v135, 0xffff0000, v67
  v_pk_add_f32 v[2:3], v[2:3], v[134:135]
  s_waitcnt vmcnt(14)
  v_lshlrev_b32 v136, 16, v68
  v_and_b32 v137, 0xffff0000, v68
  v_pk_add_f32 v[2:3], v[2:3], v[136:137]
  v_lshlrev_b32 v138, 16, v69
  v_and_b32 v139, 0xffff0000, v69
  v_pk_add_f32 v[2:3], v[2:3], v[138:139]
  v_lshlrev_b32 v140, 16, v70
  v_and_b32 v141, 0xffff0000, v70
  v_pk_add_f32 v[2:3], v[2:3], v[140:141]
  v_lshlrev_b32 v142, 16, v71
  v_and_b32 v143, 0xffff0000, v71
  v_pk_add_f32 v[2:3], v[2:3], v[142:143]
  s_waitcnt vmcnt(13)
  v_lshlrev_b32 v144, 16, v72
  v_and_b32 v145, 0xffff0000, v72
  v_pk_add_f32 v[2:3], v[2:3], v[144:145]
  v_lshlrev_b32 v146, 16, v73
  v_and_b32 v147, 0xffff0000, v73
  v_pk_add_f32 v[2:3], v[2:3], v[146:147]
  v_lshlrev_b32 v148, 16, v74
  v_and_b32 v149, 0xffff0000, v74
  v_pk_add_f32 v[2:3], v[2:3], v[148:149]
  v_lshlrev_b32 v150, 16, v75
  v_and_b32 v151, 0xffff0000, v75
  v_pk_add_f32 v[2:3], v[2:3], v[150:151]
  s_waitcnt vmcnt(12)
  v_lshlrev_b32 v152, 16, v76
  v_and_b32 v153, 0xffff0000, v76
  v_pk_add_f32 v[2:3], v[2:3], v[152:153]
  v_lshlrev_b32 v154, 16, v77
  v_and_b32 v155, 0xffff0000, v77
  v_pk_add_f32 v[2:3], v[2:3], v[154:155]
  v_lshlrev_b32 v156, 16, v78
  v_and_b32 v157, 0xffff0000, v78
  v_pk_add_f32 v[2:3], v[2:3], v[156:157]
  v_lshlrev_b32 v158, 16, v79
  v_and_b32 v159, 0xffff0000, v79
  v_pk_add_f32 v[2:3], v[2:3], v[158:159]
  s_waitcnt vmcnt(11)
  v_lshlrev_b32 v160, 16, v80
  v_and_b32 v161, 0xffff0000, v80
  v_pk_add_f32 v[2:3], v[2:3], v[160:161]
  v_lshlrev_b32 v162, 16, v81
  v_and_b32 v163, 0xffff0000, v81
  v_pk_add_f32 v[2:3], v[2:3], v[162:163]
  v_lshlrev_b32 v164, 16, v82
  v_and_b32 v165, 0xffff0000, v82
  v_pk_add_f32 v[2:3], v[2:3], v[164:165]
  v_lshlrev_b32 v166, 16, v83
  v_and_b32 v167, 0xffff0000, v83
  v_pk_add_f32 v[2:3], v[2:3], v[166:167]
  s_waitcnt vmcnt(10)
  v_lshlrev_b32 v168, 16, v84
  v_and_b32 v169, 0xffff0000, v84
  v_pk_add_f32 v[2:3], v[2:3], v[168:169]
  v_lshlrev_b32 v170, 16, v85
  v_and_b32 v171, 0xffff0000, v85
  v_pk_add_f32 v[2:3], v[2:3], v[170:171]
  v_lshlrev_b32 v172, 16, v86
  v_and_b32 v173, 0xffff0000, v86
  v_pk_add_f32 v[2:3], v[2:3], v[172:173]
  v_lshlrev_b32 v174, 16, v87
  v_and_b32 v175, 0xffff0000, v87
  v_pk_add_f32 v[2:3], v[2:3], v[174:175]
  s_waitcnt vmcnt(9)
  v_lshlrev_b32 v176, 16, v88
  v_and_b32 v177, 0xffff0000, v88
  v_pk_add_f32 v[2:3], v[2:3], v[176:177]
  v_lshlrev_b32 v178, 16, v89
  v_and_b32 v179, 0xffff0000, v89
  v_pk_add_f32 v[2:3], v[2:3], v[178:179]
  v_lshlrev_b32 v180, 16, v90
  v_and_b32 v181, 0xffff0000, v90
  v_pk_add_f32 v[2:3], v[2:3], v[180:181]
  v_lshlrev_b32 v182, 16, v91
  v_and_b32 v183, 0xffff0000, v91
  v_pk_add_f32 v[2:3], v[2:3], v[182:183]
  s_waitcnt vmcnt(8)
  v_lshlrev_b32 v184, 16, v92
  v_and_b32 v185, 0xffff0000, v92
  v_pk_add_f32 v[2:3], v[2:3], v[184:185]
  v_lshlrev_b32 v186, 16, v93
  v_and_b32 v187, 0xffff0000, v93
  v_pk_add_f32 v[2:3], v[2:3], v[186:187]
  v_lshlrev_b32 v188, 16, v94
  v_and_b32 v189, 0xffff0000, v94
  v_pk_add_f32 v[2:3], v[2:3], v[188:189]
  v_lshlrev_b32 v190, 16, v95
  v_and_b32 v191, 0xffff0000, v95
  v_pk_add_f32 v[2:3], v[2:3], v[190:191]
  s_cmp_eq_u32 s101, 1
  s_cbranch_scc1 Lalta
  s_add_u32 m0, s52, 0
  s_xor_b32 s54, s69, 0
  s_mul_i32 s54, s54, 57344
  buffer_load_dwordx4 v46, s[28:31], s54 offen offset:0 lds
  buffer_load_dwordx4 v47, s[28:31], s54 offen offset:1024 lds
  s_add_u32 m0, s52, 2048
  s_nop 0
  buffer_load_dwordx4 v46, s[32:35], s54 offen offset:0 lds
  buffer_load_dwordx4 v47, s[32:35], s54 offen offset:1024 lds
  s_add_u32 m0, s52, 4096
  s_xor_b32 s54, s69, 1
  s_mul_i32 s54, s54, 57344
  buffer_load_dwordx4 v46, s[28:31], s54 offen offset:0 lds
  buffer_load_dwordx4 v47, s[28:31], s54 offen offset:1024 lds
  s_add_u32 m0, s52, 6144
  s_nop 0
  buffer_load_dwordx4 v46, s[32:35], s54 offen offset:0 lds
  buffer_load_dwordx4 v47, s[32:35], s54 offen offset:1024 lds
  s_branch Ljoina
Lalta:
  s_add_u32 m0, s52, 0
  s_xor_b32 s54, s56, 0
  buffer_load_dwordx4 v38, s[20:23], s54 offen offset:0 lds
  buffer_load_dwordx4 v39, s[20:23], s54 offen offset:1024 lds
  buffer_load_dwordx4 v40, s[20:23], s54 offen offset:2048 lds
  buffer_load_dwordx4 v41, s[20:23], s54 offen offset:3072 lds
  s_add_u32 m0, s52, 4096
  s_xor_b32 s54, s56, 131072
  buffer_load_dwordx4 v38, s[20:23], s54 offen offset:0 lds
  buffer_load_dwordx4 v39, s[20:23], s54 offen offset:1024 lds
  buffer_load_dwordx4 v40, s[20:23], s54 offen offset:2048 lds
  buffer_load_dwordx4 v41, s[20:23], s54 offen offset:3072 lds
Ljoina:
  v_add_f32 v2, v2, v3
  s_nop 1
  v_add_f32_dpp v2, v2, v2 quad_perm:[1,0,3,2] row_mask:0xf bank_mask:0xf
  s_nop 1
  v_add_f32_dpp v2, v2, v2 quad_perm:[2,3,0,1] row_mask:0xf bank_mask:0xf
  s_nop 1
  v_add_f32_dpp v2, v2, v2 row_half_mirror row_mask:0xf bank_mask:0xf
  v_mul_f32 v3, 0x3b000000, v2
  v_cvt_pk_bf16_f32 v2, v3, v3
  v_lshlrev_b32 v2, 16, v2
  v_sub_f32 v32, v3, v2
  v_pk_add_f32 v[128:129], v[128:129], v[2:3] op_sel_hi:[1,0] neg_lo:[0,1] neg_hi:[0,1]
  v_pk_add_f32 v[130:131], v[130:131], v[2:3] op_sel_hi:[1,0] neg_lo:[0,1] neg_hi:[0,1]
  v_pk_add_f32 v[132:133], v[132:133], v[2:3] op_sel_hi:[1,0] neg_lo:[0,1] neg_hi:[0,1]
  v_pk_add_f32 v[134:135], v[134:135], v[2:3] op_sel_hi:[1,0] neg_lo:[0,1] neg_hi:[0,1]
  v_cvt_pk_bf16_f32 v64, v128, v129
  v_cvt_pk_bf16_f32 v65, v130, v131
  v_cvt_pk_bf16_f32 v66, v132, v133
  v_cvt_pk_bf16_f32 v67, v134, v135
  ds_write_b128 v52, v[64:67] offset:0
  v_pk_add_f32 v[136:137], v[136:137], v[2:3] op_sel_hi:[1,0] neg_lo:[0,1] neg_hi:[0,1]
  v_pk_add_f32 v[138:139], v[138:139], v[2:3] op_sel_hi:[1,0] neg_lo:[0,1] neg_hi:[0,1]
  v_pk_add_f32 v[140:141], v[140:141], v[2:3] op_sel_hi:[1,0] neg_lo:[0,1] neg_hi:[0,1]
  v_pk_add_f32 v[142:143], v[142:143], v[2:3] op_sel_hi:[1,0] neg_lo:[0,1] neg_hi:[0,1]
  v_cvt_pk_bf16_f32 v68, v136, v137
  v_cvt_pk_bf16_f32 v69, v138, v139
  v_cvt_pk_bf16_f32 v70, v140, v141
  v_cvt_pk_bf16_f32 v71, v142, v143
  ds_write_b128 v52, v[68:71] offset:128
  v_pk_add_f32 v[144:145], v[144:145], v[2:3] op_sel_hi:[1,0] neg_lo:[0,1] neg_hi:[0,1]
  v_pk_add_f32 v[146:147], v[146:147], v[2:3] op_sel_hi:[1,0] neg_lo:[0,1] neg_hi:[0,1]
  v_pk_add_f32 v[148:149], v[148:149], v[2:3] op_sel_hi:[1,0] neg_lo:[0,1] neg_hi:[0,1]
  v_pk_add_f32 v[150:151], v[150:151], v[2:3] op_sel_hi:[1,0] neg_lo:[0,1] neg_hi:[0,1]
  v_cvt_pk_bf16_f32 v72, v144, v145
  v_cvt_pk_bf16_f32 v73, v146, v147
  v_cvt_pk_bf16_f32 v74, v148, v149
  v_cvt_pk_bf16_f32 v75, v150, v151
  ds_write_b128 v52, v[72:75] offset:256
  v_pk_add_f32 v[152:153], v[152:153], v[2:3] op_sel_hi:[1,0] neg_lo:[0,1] neg_hi:[0,1]
  v_pk_add_f32 v[154:155], v[154:155], v[2:3] op_sel_hi:[1,0] neg_lo:[0,1] neg_hi:[0,1]
  v_pk_add_f32 v[156:157], v[156:157], v[2:3] op_sel_hi:[1,0] neg_lo:[0,1] neg_hi:[0,1]
  v_pk_add_f32 v[158:159], v[158:159], v[2:3] op_sel_hi:[1,0] neg_lo:[0,1] neg_hi:[0,1]
  v_cvt_pk_bf16_f32 v76, v152, v153
  v_cvt_pk_bf16_f32 v77, v154, v155
  v_cvt_pk_bf16_f32 v78, v156, v157
  v_cvt_pk_bf16_f32 v79, v158, v159
  ds_write_b128 v52, v[76:79] offset:384
  v_pk_add_f32 v[160:161], v[160:161], v[2:3] op_sel_hi:[1,0] neg_lo:[0,1] neg_hi:[0,1]
  v_pk_add_f32 v[162:163], v[162:163], v[2:3] op_sel_hi:[1,0] neg_lo:[0,1] neg_hi:[0,1]
  v_pk_add_f32 v[164:165], v[164:165], v[2:3] op_sel_hi:[1,0] neg_lo:[0,1] neg_hi:[0,1]
  v_pk_add_f32 v[166:167], v[166:167], v[2:3] op_sel_hi:[1,0] neg_lo:[0,1] neg_hi:[0,1]
  v_cvt_pk_bf16_f32 v80, v160, v161
  v_cvt_pk_bf16_f32 v81, v162, v163
  v_cvt_pk_bf16_f32 v82, v164, v165
  v_cvt_pk_bf16_f32 v83, v166, v167
  ds_write_b128 v52, v[80:83] offset:512
  v_pk_add_f32 v[168:169], v[168:169], v[2:3] op_sel_hi:[1,0] neg_lo:[0,1] neg_hi:[0,1]
  v_pk_add_f32 v[170:171], v[170:171], v[2:3] op_sel_hi:[1,0] neg_lo:[0,1] neg_hi:[0,1]
  v_pk_add_f32 v[172:173], v[172:173], v[2:3] op_sel_hi:[1,0] neg_lo:[0,1] neg_hi:[0,1]
  v_pk_add_f32 v[174:175], v[174:175], v[2:3] op_sel_hi:[1,0] neg_lo:[0,1] neg_hi:[0,1]
  v_cvt_pk_bf16_f32 v84, v168, v169
  v_cvt_pk_bf16_f32 v85, v170, v171
  v_cvt_pk_bf16_f32 v86, v172, v173
  v_cvt_pk_bf16_f32 v87, v174, v175
  ds_write_b128 v52, v[84:87] offset:640
  v_pk_add_f32 v[176:177], v[176:177], v[2:3] op_sel_hi:[1,0] neg_lo:[0,1] neg_hi:[0,1]
  v_pk_add_f32 v[178:179], v[178:179], v[2:3] op_sel_hi:[1,0] neg_lo:[0,1] neg_hi:[0,1]
  v_pk_add_f32 v[180:181], v[180:181], v[2:3] op_sel_hi:[1,0] neg_lo:[0,1] neg_hi:[0,1]
  v_pk_add_f32 v[182:183], v[182:183], v[2:3] op_sel_hi:[1,0] neg_lo:[0,1] neg_hi:[0,1]
  v_cvt_pk_bf16_f32 v88, v176, v177
  v_cvt_pk_bf16_f32 v89, v178, v179
  v_cvt_pk_bf16_f32 v90, v180, v181
  v_cvt_pk_bf16_f32 v91, v182, v183
  ds_write_b128 v52, v[88:91] offset:768
  v_pk_add_f32 v[184:185], v[184:185], v[2:3] op_sel_hi:[1,0] neg_lo:[0,1] neg_hi:[0,1]
  v_pk_add_f32 v[186:187], v[186:187], v[2:3] op_sel_hi:[1,0] neg_lo:[0,1] neg_hi:[0,1]
  v_pk_add_f32 v[188:189], v[188:189], v[2:3] op_sel_hi:[1,0] neg_lo:[0,1] neg_hi:[0,1]
  v_pk_add_f32 v[190:191], v[190:191], v[2:3] op_sel_hi:[1,0] neg_lo:[0,1] neg_hi:[0,1]
  v_cvt_pk_bf16_f32 v92, v184, v185
  v_cvt_pk_bf16_f32 v93, v186, v187
  v_cvt_pk_bf16_f32 v94, v188, v189
  v_cvt_pk_bf16_f32 v95, v190, v191
  ds_write_b128 v52, v[92:95] offset:896
  s_waitcnt vmcnt(15)
  v_lshlrev_b32 v192, 16, v96
  v_and_b32 v193, 0xffff0000, v96
  v_lshlrev_b32 v194, 16, v97
  v_and_b32 v195, 0xffff0000, v97
  v_pk_add_f32 v[4:5], v[192:193], v[194:195]
  v_lshlrev_b32 v196, 16, v98
  v_and_b32 v197, 0xffff0000, v98
  v_pk_add_f32 v[4:5], v[4:5], v[196:197]
  v_lshlrev_b32 v198, 16, v99
  v_and_b32 v199, 0xffff0000, v99
  v_pk_add_f32 v[4:5], v[4:5], v[198:199]
  s_waitcnt vmcnt(14)
  v_lshlrev_b32 v200, 16, v100
  v_and_b32 v201, 0xffff0000, v100
  v_pk_add_f32 v[4:5], v[4:5], v[200:201]
  v_lshlrev_b32 v202, 16, v101
  v_and_b32 v203, 0xffff0000, v101
  v_pk_add_f32 v[4:5], v[4:5], v[202:203]
  v_lshlrev_b32 v204, 16, v102
  v_and_b32 v205, 0xffff0000, v102
  v_pk_add_f32 v[4:5], v[4:5], v[204:205]
  v_lshlrev_b32 v206, 16, v103
  v_and_b32 v207, 0xffff0000, v103
  v_pk_add_f32 v[4:5], v[4:5], v[206:207]
  s_waitcnt vmcnt(13)
  v_lshlrev_b32 v208, 16, v104
  v_and_b32 v209, 0xffff0000, v104
  v_pk_add_f32 v[4:5], v[4:5], v[208:209]
  v_lshlrev_b32 v210, 16, v105
  v_and_b32 v211, 0xffff0000, v105
  v_pk_add_f32 v[4:5], v[4:5], v[210:211]
  v_lshlrev_b32 v212, 16, v106
  v_and_b32 v213, 0xffff0000, v106
  v_pk_add_f32 v[4:5], v[4:5], v[212:213]
  v_lshlrev_b32 v214, 16, v107
  v_and_b32 v215, 0xffff0000, v107
  v_pk_add_f32 v[4:5], v[4:5], v[214:215]
  s_waitcnt vmcnt(12)
  v_lshlrev_b32 v216, 16, v108
  v_and_b32 v217, 0xffff0000, v108
  v_pk_add_f32 v[4:5], v[4:5], v[216:217]
  v_lshlrev_b32 v218, 16, v109
  v_and_b32 v219, 0xffff0000, v109
  v_pk_add_f32 v[4:5], v[4:5], v[218:219]
  v_lshlrev_b32 v220, 16, v110
  v_and_b32 v221, 0xffff0000, v110
  v_pk_add_f32 v[4:5], v[4:5], v[220:221]
  v_lshlrev_b32 v222, 16, v111
  v_and_b32 v223, 0xffff0000, v111
  v_pk_add_f32 v[4:5], v[4:5], v[222:223]
  s_waitcnt vmcnt(11)
  v_lshlrev_b32 v224, 16, v112
  v_and_b32 v225, 0xffff0000, v112
  v_pk_add_f32 v[4:5], v[4:5], v[224:225]
  v_lshlrev_b32 v226, 16, v113
  v_and_b32 v227, 0xffff0000, v113
  v_pk_add_f32 v[4:5], v[4:5], v[226:227]
  v_lshlrev_b32 v228, 16, v114
  v_and_b32 v229, 0xffff0000, v114
  v_pk_add_f32 v[4:5], v[4:5], v[228:229]
  v_lshlrev_b32 v230, 16, v115
  v_and_b32 v231, 0xffff0000, v115
  v_pk_add_f32 v[4:5], v[4:5], v[230:231]
  s_waitcnt vmcnt(10)
  v_lshlrev_b32 v232, 16, v116
  v_and_b32 v233, 0xffff0000, v116
  v_pk_add_f32 v[4:5], v[4:5], v[232:233]
  v_lshlrev_b32 v234, 16, v117
  v_and_b32 v235, 0xffff0000, v117
  v_pk_add_f32 v[4:5], v[4:5], v[234:235]
  v_lshlrev_b32 v236, 16, v118
  v_and_b32 v237, 0xffff0000, v118
  v_pk_add_f32 v[4:5], v[4:5], v[236:237]
  v_lshlrev_b32 v238, 16, v119
  v_and_b32 v239, 0xffff0000, v119
  v_pk_add_f32 v[4:5], v[4:5], v[238:239]
  s_waitcnt vmcnt(9)
  v_lshlrev_b32 v240, 16, v120
  v_and_b32 v241, 0xffff0000, v120
  v_pk_add_f32 v[4:5], v[4:5], v[240:241]
  v_lshlrev_b32 v242, 16, v121
  v_and_b32 v243, 0xffff0000, v121
  v_pk_add_f32 v[4:5], v[4:5], v[242:243]
  v_lshlrev_b32 v244, 16, v122
  v_and_b32 v245, 0xffff0000, v122
  v_pk_add_f32 v[4:5], v[4:5], v[244:245]
  v_lshlrev_b32 v246, 16, v123
  v_and_b32 v247, 0xffff0000, v123
  v_pk_add_f32 v[4:5], v[4:5], v[246:247]
  s_waitcnt vmcnt(8)
  v_lshlrev_b32 v248, 16, v124
  v_and_b32 v249, 0xffff0000, v124
  v_pk_add_f32 v[4:5], v[4:5], v[248:249]
  v_lshlrev_b32 v250, 16, v125
  v_and_b32 v251, 0xffff0000, v125
  v_pk_add_f32 v[4:5], v[4:5], v[250:251]
  v_lshlrev_b32 v252, 16, v126
  v_and_b32 v253, 0xffff0000, v126
  v_pk_add_f32 v[4:5], v[4:5], v[252:253]
  v_lshlrev_b32 v254, 16, v127
  v_and_b32 v255, 0xffff0000, v127
  v_pk_add_f32 v[4:5], v[4:5], v[254:255]
  v_add_f32 v4, v4, v5
  s_nop 1
  v_add_f32_dpp v4, v4, v4 quad_perm:[1,0,3,2] row_mask:0xf bank_mask:0xf
  s_nop 1
  v_add_f32_dpp v4, v4, v4 quad_perm:[2,3,0,1] row_mask:0xf bank_mask:0xf
  s_nop 1
  v_add_f32_dpp v4, v4, v4 row_half_mirror row_mask:0xf bank_mask:0xf
  v_mul_f32 v5, 0x3b000000, v4
  v_cvt_pk_bf16_f32 v4, v5, v5
  v_lshlrev_b32 v4, 16, v4
  v_sub_f32 v33, v5, v4
  s_cmp_eq_u32 s101, 1
  s_cbranch_scc1 Laltb
  s_add_u32 m0, s52, 8192
  s_xor_b32 s54, s69, 2
  s_mul_i32 s54, s54, 57344
  buffer_load_dwordx4 v46, s[28:31], s54 offen offset:0 lds
  buffer_load_dwordx4 v47, s[28:31], s54 offen offset:1024 lds
  s_add_u32 m0, s52, 10240
  s_nop 0
  buffer_load_dwordx4 v46, s[32:35], s54 offen offset:0 lds
  buffer_load_dwordx4 v47, s[32:35], s54 offen offset:1024 lds
  s_add_u32 m0, s52, 12288
  s_xor_b32 s54, s69, 3
  s_mul_i32 s54, s54, 57344
  buffer_load_dwordx4 v46, s[28:31], s54 offen offset:0 lds
  buffer_load_dwordx4 v47, s[28:31], s54 offen offset:1024 lds
  s_add_u32 m0, s52, 14336
  s_nop 0
  buffer_load_dwordx4 v46, s[32:35], s54 offen offset:0 lds
  buffer_load_dwordx4 v47, s[32:35], s54 offen offset:1024 lds
  s_branch Ljoinb
Laltb:
  s_add_u32 m0, s52, 8192
  s_xor_b32 s54, s56, 262144
  buffer_load_dwordx4 v38, s[20:23], s54 offen offset:0 lds
  buffer_load_dwordx4 v39, s[20:23], s54 offen offset:1024 lds
  buffer_load_dwordx4 v40, s[20:23], s54 offen offset:2048 lds
  buffer_load_dwordx4 v41, s[20:23], s54 offen offset:3072 lds
  s_add_u32 m0, s52, 12288
  s_xor_b32 s54, s56, 393216
  buffer_load_dwordx4 v38, s[20:23], s54 offen offset:0 lds
  buffer_load_dwordx4 v39, s[20:23], s54 offen offset:1024 lds
  buffer_load_dwordx4 v40, s[20:23], s54 offen offset:2048 lds
  buffer_load_dwordx4 v41, s[20:23], s54 offen offset:3072 lds
Ljoinb:
  v_pk_add_f32 v[192:193], v[192:193], v[4:5] op_sel_hi:[1,0] neg_lo:[0,1] neg_hi:[0,1]
  v_pk_add_f32 v[194:195], v[194:195], v[4:5] op_sel_hi:[1,0] neg_lo:[0,1] neg_hi:[0,1]
  v_pk_add_f32 v[196:197], v[196:197], v[4:5] op_sel_hi:[1,0] neg_lo:[0,1] neg_hi:[0,1]
  v_pk_add_f32 v[198:199], v[198:199], v[4:5] op_sel_hi:[1,0] neg_lo:[0,1] neg_hi:[0,1]
  v_cvt_pk_bf16_f32 v96, v192, v193
  v_cvt_pk_bf16_f32 v97, v194, v195
  v_cvt_pk_bf16_f32 v98, v196, v197
  v_cvt_pk_bf16_f32 v99, v198, v199
  ds_write_b128 v52, v[96:99] offset:8320
  v_pk_add_f32 v[200:201], v[200:201], v[4:5] op_sel_hi:[1,0] neg_lo:[0,1] neg_hi:[0,1]
  v_pk_add_f32 v[202:203], v[202:203], v[4:5] op_sel_hi:[1,0] neg_lo:[0,1] neg_hi:[0,1]
  v_pk_add_f32 v[204:205], v[204:205], v[4:5] op_sel_hi:[1,0] neg_lo:[0,1] neg_hi:[0,1]
  v_pk_add_f32 v[206:207], v[206:207], v[4:5] op_sel_hi:[1,0] neg_lo:[0,1] neg_hi:[0,1]
  v_cvt_pk_bf16_f32 v100, v200, v201
  v_cvt_pk_bf16_f32 v101, v202, v203
  v_cvt_pk_bf16_f32 v102, v204, v205
  v_cvt_pk_bf16_f32 v103, v206, v207
  ds_write_b128 v52, v[100:103] offset:8192
  v_pk_add_f32 v[208:209], v[208:209], v[4:5] op_sel_hi:[1,0] neg_lo:[0,1] neg_hi:[0,1]
  v_pk_add_f32 v[210:211], v[210:211], v[4:5] op_sel_hi:[1,0] neg_lo:[0,1] neg_hi:[0,1]
  v_pk_add_f32 v[212:213], v[212:213], v[4:5] op_sel_hi:[1,0] neg_lo:[0,1] neg_hi:[0,1]
  v_pk_add_f32 v[214:215], v[214:215], v[4:5] op_sel_hi:[1,0] neg_lo:[0,1] neg_hi:[0,1]
  v_cvt_pk_bf16_f32 v104, v208, v209
  v_cvt_pk_bf16_f32 v105, v210, v211
  v_cvt_pk_bf16_f32 v106, v212, v213
  v_cvt_pk_bf16_f32 v107, v214, v215
  ds_write_b128 v52, v[104:107] offset:8576
  v_pk_add_f32 v[216:217], v[216:217], v[4:5] op_sel_hi:[1,0] neg_lo:[0,1] neg_hi:[0,1]
  v_pk_add_f32 v[218:219], v[218:219], v[4:5] op_sel_hi:[1,0] neg_lo:[0,1] neg_hi:[0,1]
  v_pk_add_f32 v[220:221], v[220:221], v[4:5] op_sel_hi:[1,0] neg_lo:[0,1] neg_hi:[0,1]
  v_pk_add_f32 v[222:223], v[222:223], v[4:5] op_sel_hi:[1,0] neg_lo:[0,1] neg_hi:[0,1]
  v_cvt_pk_bf16_f32 v108, v216, v217
  v_cvt_pk_bf16_f32 v109, v218, v219
  v_cvt_pk_bf16_f32 v110, v220, v221
  v_cvt_pk_bf16_f32 v111, v222, v223
  ds_write_b128 v52, v[108:111] offset:8448
  v_pk_add_f32 v[224:225], v[224:225], v[4:5] op_sel_hi:[1,0] neg_lo:[0,1] neg_hi:[0,1]
  v_pk_add_f32 v[226:227], v[226:227], v[4:5] op_sel_hi:[1,0] neg_lo:[0,1] neg_hi:[0,1]
  v_pk_add_f32 v[228:229], v[228:229], v[4:5] op_sel_hi:[1,0] neg_lo:[0,1] neg_hi:[0,1]
  v_pk_add_f32 v[230:231], v[230:231], v[4:5] op_sel_hi:[1,0] neg_lo:[0,1] neg_hi:[0,1]
  v_cvt_pk_bf16_f32 v112, v224, v225
  v_cvt_pk_bf16_f32 v113, v226, v227
  v_cvt_pk_bf16_f32 v114, v228, v229
  v_cvt_pk_bf16_f32 v115, v230, v231
  ds_write_b128 v52, v[112:115] offset:8832
  v_pk_add_f32 v[232:233], v[232:233], v[4:5] op_sel_hi:[1,0] neg_lo:[0,1] neg_hi:[0,1]
  v_pk_add_f32 v[234:235], v[234:235], v[4:5] op_sel_hi:[1,0] neg_lo:[0,1] neg_hi:[0,1]
  v_pk_add_f32 v[236:237], v[236:237], v[4:5] op_sel_hi:[1,0] neg_lo:[0,1] neg_hi:[0,1]
  v_pk_add_f32 v[238:239], v[238:239], v[4:5] op_sel_hi:[1,0] neg_lo:[0,1] neg_hi:[0,1]
  v_cvt_pk_bf16_f32 v116, v232, v233
  v_cvt_pk_bf16_f32 v117, v234, v235
  v_cvt_pk_bf16_f32 v118, v236, v237
  v_cvt_pk_bf16_f32 v119, v238, v239
  ds_write_b128 v52, v[116:119] offset:8704
  v_pk_add_f32 v[240:241], v[240:241], v[4:5] op_sel_hi:[1,0] neg_lo:[0,1] neg_hi:[0,1]
  v_pk_add_f32 v[242:243], v[242:243], v[4:5] op_sel_hi:[1,0] neg_lo:[0,1] neg_hi:[0,1]
  v_pk_add_f32 v[244:245], v[244:245], v[4:5] op_sel_hi:[1,0] neg_lo:[0,1] neg_hi:[0,1]
  v_pk_add_f32 v[246:247], v[246:247], v[4:5] op_sel_hi:[1,0] neg_lo:[0,1] neg_hi:[0,1]
  v_cvt_pk_bf16_f32 v120, v240, v241
  v_cvt_pk_bf16_f32 v121, v242, v243
  v_cvt_pk_bf16_f32 v122, v244, v245
  v_cvt_pk_bf16_f32 v123, v246, v247
  ds_write_b128 v52, v[120:123] offset:9088
  v_pk_add_f32 v[248:249], v[248:249], v[4:5] op_sel_hi:[1,0] neg_lo:[0,1] neg_hi:[0,1]
  v_pk_add_f32 v[250:251], v[250:251], v[4:5] op_sel_hi:[1,0] neg_lo:[0,1] neg_hi:[0,1]
  v_pk_add_f32 v[252:253], v[252:253], v[4:5] op_sel_hi:[1,0] neg_lo:[0,1] neg_hi:[0,1]
  v_pk_add_f32 v[254:255], v[254:255], v[4:5] op_sel_hi:[1,0] neg_lo:[0,1] neg_hi:[0,1]
  v_cvt_pk_bf16_f32 v124, v248, v249
  v_cvt_pk_bf16_f32 v125, v250, v251
  v_cvt_pk_bf16_f32 v126, v252, v253
  v_cvt_pk_bf16_f32 v127, v254, v255
  ds_write_b128 v52, v[124:127] offset:8960
  s_waitcnt lgkmcnt(0)
  s_barrier
  s_cmp_eq_u32 s101, 1
  s_cbranch_scc1 Lidle
  v_xor_b32 v36, 0, v34
  ds_read_b128 a[160:163], v36 offset:0
  ds_read_b128 a[164:167], v36 offset:32768
  s_waitcnt vmcnt(12)
  ds_read_b64_tr_b16 a[128:129], v28 offset:0
  ds_read_b64_tr_b16 a[130:131], v28 offset:512
  ds_read_b64_tr_b16 a[132:133], v29 offset:0
  ds_read_b64_tr_b16 a[134:135], v29 offset:512
  ds_read_b64_tr_b16 a[136:137], v28 offset:2048
  ds_read_b64_tr_b16 a[138:139], v28 offset:2560
  ds_read_b64_tr_b16 a[140:141], v29 offset:2048
  ds_read_b64_tr_b16 a[142:143], v29 offset:2560
  s_waitcnt vmcnt(8) lgkmcnt(0)
  v_mfma_f32_32x32x16_bf16 a[0:15], a[128:131], a[160:163], 0
  v_xor_b32 v36, 32, v34
  ds_read_b64_tr_b16 a[144:145], v28 offset:4096
  ds_read_b64_tr_b16 a[146:147], v28 offset:4608
  s_add_u32 m0, s52, 0
  s_xor_b32 s54, s69, 4
  s_mul_i32 s54, s54, 57344
  v_mfma_f32_32x32x16_bf16 a[16:31], a[128:131], a[164:167], 0
  ds_read_b128 a[168:171], v36 offset:0
  ds_read_b128 a[172:175], v36 offset:32768
  buffer_load_dwordx4 v46, s[28:31], s54 offen offset:0 lds
  v_mul_f32 v54, v128, v128
  v_mul_f32 v56, v192, v192
  v_mfma_f32_32x32x16_bf16 a[32:47], a[132:135], a[160:163], 0
  ds_read_b64_tr_b16 a[148:149], v29 offset:4096
  ds_read_b64_tr_b16 a[150:151], v29 offset:4608
  v_mul_f32 v55, v129, v129
  v_mul_f32 v57, v193, v193
  v_fmac_f32 v54, v130, v130
  v_mfma_f32_32x32x16_bf16 a[48:63], a[132:135], a[164:167], 0
  ds_read_b64_tr_b16 a[152:153], v28 offset:6144
  ds_read_b64_tr_b16 a[154:155], v28 offset:6656
  buffer_load_dwordx4 v47, s[28:31], s54 offen offset:1024 lds
  s_add_u32 m0, s52, 2048
  v_fmac_f32 v56, v194, v194
  v_mfma_f32_32x32x16_bf16 a[64:79], a[136:139], a[160:163], 0
  ds_read_b64_tr_b16 a[156:157], v29 offset:6144
  ds_read_b64_tr_b16 a[158:159], v29 offset:6656
  v_fmac_f32 v55, v131, v131
  v_fmac_f32 v57, v195, v195
  v_fmac_f32 v54, v132, v132
  v_mfma_f32_32x32x16_bf16 a[80:95], a[136:139], a[164:167], 0
  buffer_load_dwordx4 v46, s[32:35], s54 offen offset:0 lds
  v_fmac_f32 v56, v196, v196
  v_fmac_f32 v55, v133, v133
  v_fmac_f32 v57, v197, v197
  v_fmac_f32 v54, v134, v134
  v_mfma_f32_32x32x16_bf16 a[96:111], a[140:143], a[160:163], 0
  v_fmac_f32 v56, v198, v198
  v_fmac_f32 v55, v135, v135
  v_fmac_f32 v57, v199, v199
  v_fmac_f32 v54, v136, v136
  v_fmac_f32 v56, v200, v200
  v_mfma_f32_32x32x16_bf16 a[112:127], a[140:143], a[164:167], 0
  buffer_load_dwordx4 v47, s[32:35], s54 offen offset:1024 lds
  v_fmac_f32 v55, v137, v137
  v_fmac_f32 v57, v201, v201
  v_fmac_f32 v54, v138, v138
  v_fmac_f32 v56, v202, v202
  s_waitcnt vmcnt(8) lgkmcnt(0)
  v_mfma_f32_32x32x16_bf16 a[0:15], a[144:147], a[168:171], a[0:15]
  v_xor_b32 v36, 64, v34
  ds_read_b64_tr_b16 a[128:129], v28 offset:8192
  ds_read_b64_tr_b16 a[130:131], v28 offset:8704
  s_add_u32 m0, s52, 4096
  s_xor_b32 s54, s69, 5
  s_mul_i32 s54, s54, 57344
  v_mfma_f32_32x32x16_bf16 a[16:31], a[144:147], a[172:175], a[16:31]
  ds_read_b128 a[160:163], v36 offset:0
  ds_read_b128 a[164:167], v36 offset:32768
  buffer_load_dwordx4 v46, s[28:31], s54 offen offset:0 lds
  v_fmac_f32 v55, v139, v139
  v_fmac_f32 v57, v203, v203
  v_mfma_f32_32x32x16_bf16 a[32:47], a[148:151], a[168:171], a[32:47]
  ds_read_b64_tr_b16 a[132:133], v29 offset:8192
  ds_read_b64_tr_b16 a[134:135], v29 offset:8704
  v_fmac_f32 v54, v140, v140
  v_fmac_f32 v56, v204, v204
  v_fmac_f32 v55, v141, v141
  v_mfma_f32_32x32x16_bf16 a[48:63], a[148:151], a[172:175], a[48:63]
  ds_read_b64_tr_b16 a[136:137], v28 offset:10240
  ds_read_b64_tr_b16 a[138:139], v28 offset:10752
  buffer_load_dwordx4 v47, s[28:31], s54 offen offset:1024 lds
  s_add_u32 m0, s52, 6144
  v_fmac_f32 v57, v205, v205
  v_mfma_f32_32x32x16_bf16 a[64:79], a[152:155], a[168:171], a[64:79]
  ds_read_b64_tr_b16 a[140:141], v29 offset:10240
  ds_read_b64_tr_b16 a[142:143], v29 offset:10752
  v_fmac_f32 v54, v142, v142
  v_fmac_f32 v56, v206, v206
  v_fmac_f32 v55, v143, v143
  v_mfma_f32_32x32x16_bf16 a[80:95], a[152:155], a[172:175], a[80:95]
  buffer_load_dwordx4 v46, s[32:35], s54 offen offset:0 lds
  v_fmac_f32 v57, v207, v207
  v_fmac_f32 v54, v144, v144
  v_fmac_f32 v56, v208, v208
  v_fmac_f32 v55, v145, v145
  v_mfma_f32_32x32x16_bf16 a[96:111], a[156:159], a[168:171], a[96:111]
  v_fmac_f32 v57, v209, v209
  v_fmac_f32 v54, v146, v146
  v_fmac_f32 v56, v210, v210
  v_fmac_f32 v55, v147, v147
  v_fmac_f32 v57, v211, v211
  v_mfma_f32_32x32x16_bf16 a[112:127], a[156:159], a[172:175], a[112:127]
  buffer_load_dwordx4 v47, s[32:35], s54 offen offset:1024 lds
  v_fmac_f32 v54, v148, v148
  v_fmac_f32 v56, v212, v212
  v_fmac_f32 v55, v149, v149
  v_fmac_f32 v57, v213, v213
  s_waitcnt vmcnt(8) lgkmcnt(0)
  v_mfma_f32_32x32x16_bf16 a[0:15], a[128:131], a[160:163], a[0:15]
  v_xor_b32 v36, 96, v34
  ds_read_b64_tr_b16 a[144:145], v28 offset:12288
  ds_read_b64_tr_b16 a[146:147], v28 offset:12800
  s_add_u32 m0, s52, 8192
  s_xor_b32 s54, s69, 6
  s_mul_i32 s54, s54, 57344
  v_mfma_f32_32x32x16_bf16 a[16:31], a[128:131], a[164:167], a[16:31]
  ds_read_b128 a[168:171], v36 offset:0
  ds_read_b128 a[172:175], v36 offset:32768
  buffer_load_dwordx4 v46, s[28:31], s54 offen offset:0 lds
  v_fmac_f32 v54, v150, v150
  v_fmac_f32 v56, v214, v214
  v_mfma_f32_32x32x16_bf16 a[32:47], a[132:135], a[160:163], a[32:47]
  ds_read_b64_tr_b16 a[148:149], v29 offset:12288
  ds_read_b64_tr_b16 a[150:151], v29 offset:12800
  v_fmac_f32 v55, v151, v151
  v_fmac_f32 v57, v215, v215
  v_fmac_f32 v54, v152, v152
  v_mfma_f32_32x32x16_bf16 a[48:63], a[132:135], a[164:167], a[48:63]
  ds_read_b64_tr_b16 a[152:153], v28 offset:14336
  ds_read_b64_tr_b16 a[154:155], v28 offset:14848
  buffer_load_dwordx4 v47, s[28:31], s54 offen offset:1024 lds
  s_add_u32 m0, s52, 10240
  v_fmac_f32 v56, v216, v216
  v_mfma_f32_32x32x16_bf16 a[64:79], a[136:139], a[160:163], a[64:79]
  ds_read_b64_tr_b16 a[156:157], v29 offset:14336
  ds_read_b64_tr_b16 a[158:159], v29 offset:14848
  v_fmac_f32 v55, v153, v153
  v_fmac_f32 v57, v217, v217
  v_fmac_f32 v54, v154, v154
  v_mfma_f32_32x32x16_bf16 a[80:95], a[136:139], a[164:167], a[80:95]
  buffer_load_dwordx4 v46, s[32:35], s54 offen offset:0 lds
  v_fmac_f32 v56, v218, v218
  v_fmac_f32 v55, v155, v155
  v_fmac_f32 v57, v219, v219
  v_fmac_f32 v54, v156, v156
  v_mfma_f32_32x32x16_bf16 a[96:111], a[140:143], a[160:163], a[96:111]
  v_fmac_f32 v56, v220, v220
  v_fmac_f32 v55, v157, v157
  v_fmac_f32 v57, v221, v221
  v_fmac_f32 v54, v158, v158
  v_fmac_f32 v56, v222, v222
  v_mfma_f32_32x32x16_bf16 a[112:127], a[140:143], a[164:167], a[112:127]
  buffer_load_dwordx4 v47, s[32:35], s54 offen offset:1024 lds
  v_fmac_f32 v55, v159, v159
  v_fmac_f32 v57, v223, v223
  v_fmac_f32 v54, v160, v160
  v_fmac_f32 v56, v224, v224
  s_waitcnt vmcnt(8) lgkmcnt(0)
  v_mfma_f32_32x32x16_bf16 a[0:15], a[144:147], a[168:171], a[0:15]
  v_xor_b32 v36, 128, v34
  ds_read_b64_tr_b16 a[128:129], v28 offset:0
  ds_read_b64_tr_b16 a[130:131], v28 offset:512
  s_add_u32 m0, s52, 12288
  s_xor_b32 s54, s69, 7
  s_mul_i32 s54, s54, 57344
  v_mfma_f32_32x32x16_bf16 a[16:31], a[144:147], a[172:175], a[16:31]
  ds_read_b128 a[160:163], v36 offset:0
  ds_read_b128 a[164:167], v36 offset:32768
  buffer_load_dwordx4 v46, s[28:31], s54 offen offset:0 lds
  v_fmac_f32 v55, v161, v161
  v_fmac_f32 v57, v225, v225
  v_mfma_f32_32x32x16_bf16 a[32:47], a[148:151], a[168:171], a[32:47]
  ds_read_b64_tr_b16 a[132:133], v29 offset:0
  ds_read_b64_tr_b16 a[134:135], v29 offset:512
  v_fmac_f32 v54, v162, v162
  v_fmac_f32 v56, v226, v226
  v_fmac_f32 v55, v163, v163
  v_mfma_f32_32x32x16_bf16 a[48:63], a[148:151], a[172:175], a[48:63]
  ds_read_b64_tr_b16 a[136:137], v28 offset:2048
  ds_read_b64_tr_b16 a[138:139], v28 offset:2560
  buffer_load_dwordx4 v47, s[28:31], s54 offen offset:1024 lds
  s_add_u32 m0, s52, 14336
  v_fmac_f32 v57, v227, v227
  v_mfma_f32_32x32x16_bf16 a[64:79], a[152:155], a[168:171], a[64:79]
  ds_read_b64_tr_b16 a[140:141], v29 offset:2048
  ds_read_b64_tr_b16 a[142:143], v29 offset:2560
  v_fmac_f32 v54, v164, v164
  v_fmac_f32 v56, v228, v228
  v_fmac_f32 v55, v165, v165
  v_mfma_f32_32x32x16_bf16 a[80:95], a[152:155], a[172:175], a[80:95]
  buffer_load_dwordx4 v46, s[32:35], s54 offen offset:0 lds
  v_fmac_f32 v57, v229, v229
  v_fmac_f32 v54, v166, v166
  v_fmac_f32 v56, v230, v230
  v_fmac_f32 v55, v167, v167
  v_mfma_f32_32x32x16_bf16 a[96:111], a[156:159], a[168:171], a[96:111]
  v_fmac_f32 v57, v231, v231
  v_fmac_f32 v54, v168, v168
  v_fmac_f32 v56, v232, v232
  v_fmac_f32 v55, v169, v169
  v_fmac_f32 v57, v233, v233
  v_mfma_f32_32x32x16_bf16 a[112:127], a[156:159], a[172:175], a[112:127]
  buffer_load_dwordx4 v47, s[32:35], s54 offen offset:1024 lds
  v_fmac_f32 v54, v170, v170
  v_fmac_f32 v56, v234, v234
  v_fmac_f32 v55, v171, v171
  v_fmac_f32 v57, v235, v235
  s_waitcnt vmcnt(8) lgkmcnt(0)
  v_mfma_f32_32x32x16_bf16 a[0:15], a[128:131], a[160:163], a[0:15]
  v_xor_b32 v36, 160, v34
  ds_read_b64_tr_b16 a[144:145], v28 offset:4096
  ds_read_b64_tr_b16 a[146:147], v28 offset:4608
  s_add_u32 m0, s52, 0
  s_xor_b32 s54, s69, 8
  s_mul_i32 s54, s54, 57344
  v_mfma_f32_32x32x16_bf16 a[16:31], a[128:131], a[164:167], a[16:31]
  ds_read_b128 a[168:171], v36 offset:0
  ds_read_b128 a[172:175], v36 offset:32768
  buffer_load_dwordx4 v46, s[28:31], s54 offen offset:0 lds
  v_fmac_f32 v54, v172, v172
  v_fmac_f32 v56, v236, v236
  v_mfma_f32_32x32x16_bf16 a[32:47], a[132:135], a[160:163], a[32:47]
  ds_read_b64_tr_b16 a[148:149], v29 offset:4096
  ds_read_b64_tr_b16 a[150:151], v29 offset:4608
  v_fmac_f32 v55, v173, v173
  v_fmac_f32 v57, v237, v237
  v_fmac_f32 v54, v174, v174
  v_mfma_f32_32x32x16_bf16 a[48:63], a[132:135], a[164:167], a[48:63]
  ds_read_b64_tr_b16 a[152:153], v28 offset:6144
  ds_read_b64_tr_b16 a[154:155], v28 offset:6656
  buffer_load_dwordx4 v47, s[28:31], s54 offen offset:1024 lds
  s_add_u32 m0, s52, 2048
  v_fmac_f32 v56, v238, v238
  v_mfma_f32_32x32x16_bf16 a[64:79], a[136:139], a[160:163], a[64:79]
  ds_read_b64_tr_b16 a[156:157], v29 offset:6144
  ds_read_b64_tr_b16 a[158:159], v29 offset:6656
  v_fmac_f32 v55, v175, v175
  v_fmac_f32 v57, v239, v239
  v_fmac_f32 v54, v176, v176
  v_mfma_f32_32x32x16_bf16 a[80:95], a[136:139], a[164:167], a[80:95]
  buffer_load_dwordx4 v46, s[32:35], s54 offen offset:0 lds
  v_fmac_f32 v56, v240, v240
  v_fmac_f32 v55, v177, v177
  v_fmac_f32 v57, v241, v241
  v_fmac_f32 v54, v178, v178
  v_mfma_f32_32x32x16_bf16 a[96:111], a[140:143], a[160:163], a[96:111]
  v_fmac_f32 v56, v242, v242
  v_fmac_f32 v55, v179, v179
  v_fmac_f32 v57, v243, v243
  v_fmac_f32 v54, v180, v180
  v_fmac_f32 v56, v244, v244
  v_mfma_f32_32x32x16_bf16 a[112:127], a[140:143], a[164:167], a[112:127]
  buffer_load_dwordx4 v47, s[32:35], s54 offen offset:1024 lds
  v_fmac_f32 v55, v181, v181
  v_fmac_f32 v57, v245, v245
  v_fmac_f32 v54, v182, v182
  v_fmac_f32 v56, v246, v246
  s_waitcnt vmcnt(8) lgkmcnt(0)
  v_mfma_f32_32x32x16_bf16 a[0:15], a[144:147], a[168:171], a[0:15]
  v_xor_b32 v36, 192, v34
  ds_read_b64_tr_b16 a[128:129], v28 offset:8192
  ds_read_b64_tr_b16 a[130:131], v28 offset:8704
  s_add_u32 m0, s52, 4096
  s_xor_b32 s54, s69, 9
  s_mul_i32 s54, s54, 57344
  v_mfma_f32_32x32x16_bf16 a[16:31], a[144:147], a[172:175], a[16:31]
  ds_read_b128 a[160:163], v36 offset:0
  ds_read_b128 a[164:167], v36 offset:32768
  buffer_load_dwordx4 v46, s[28:31], s54 offen offset:0 lds
  v_fmac_f32 v55, v183, v183
  v_fmac_f32 v57, v247, v247
  v_mfma_f32_32x32x16_bf16 a[32:47], a[148:151], a[168:171], a[32:47]
  ds_read_b64_tr_b16 a[132:133], v29 offset:8192
  ds_read_b64_tr_b16 a[134:135], v29 offset:8704
  v_fmac_f32 v54, v184, v184
  v_fmac_f32 v56, v248, v248
  v_fmac_f32 v55, v185, v185
  v_mfma_f32_32x32x16_bf16 a[48:63], a[148:151], a[172:175], a[48:63]
  ds_read_b64_tr_b16 a[136:137], v28 offset:10240
  ds_read_b64_tr_b16 a[138:139], v28 offset:10752
  buffer_load_dwordx4 v47, s[28:31], s54 offen offset:1024 lds
  s_add_u32 m0, s52, 6144
  v_fmac_f32 v57, v249, v249
  v_mfma_f32_32x32x16_bf16 a[64:79], a[152:155], a[168:171], a[64:79]
  ds_read_b64_tr_b16 a[140:141], v29 offset:10240
  ds_read_b64_tr_b16 a[142:143], v29 offset:10752
  v_fmac_f32 v54, v186, v186
  v_fmac_f32 v56, v250, v250
  v_fmac_f32 v55, v187, v187
  v_mfma_f32_32x32x16_bf16 a[80:95], a[152:155], a[172:175], a[80:95]
  buffer_load_dwordx4 v46, s[32:35], s54 offen offset:0 lds
  v_fmac_f32 v57, v251, v251
  v_fmac_f32 v54, v188, v188
  v_fmac_f32 v56, v252, v252
  v_fmac_f32 v55, v189, v189
  v_mfma_f32_32x32x16_bf16 a[96:111], a[156:159], a[168:171], a[96:111]
  v_fmac_f32 v57, v253, v253
  v_fmac_f32 v54, v190, v190
  v_fmac_f32 v56, v254, v254
  v_fmac_f32 v55, v191, v191
  v_fmac_f32 v57, v255, v255
  v_mfma_f32_32x32x16_bf16 a[112:127], a[156:159], a[172:175], a[112:127]
  buffer_load_dwordx4 v47, s[32:35], s54 offen offset:1024 lds
  v_add_f32 v54, v54, v55
  v_add_f32 v56, v56, v57
  v_mul_f32 v32, v32, v32
  v_mul_f32 v33, v33, v33
  s_waitcnt vmcnt(8) lgkmcnt(0)
  v_mfma_f32_32x32x16_bf16 a[0:15], a[128:131], a[160:163], a[0:15]
  v_xor_b32 v36, 224, v34
  ds_read_b64_tr_b16 a[144:145], v28 offset:12288
  ds_read_b64_tr_b16 a[146:147], v28 offset:12800
  s_add_u32 m0, s52, 8192
  s_xor_b32 s54, s69, 10
  s_mul_i32 s54, s54, 57344
  v_mfma_f32_32x32x16_bf16 a[16:31], a[128:131], a[164:167], a[16:31]
  ds_read_b128 a[168:171], v36 offset:0
  ds_read_b128 a[172:175], v36 offset:32768
  buffer_load_dwordx4 v46, s[28:31], s54 offen offset:0 lds
  v_add_f32_dpp v54, v54, v54 quad_perm:[1,0,3,2] row_mask:0xf bank_mask:0xf
  v_add_f32_dpp v56, v56, v56 quad_perm:[1,0,3,2] row_mask:0xf bank_mask:0xf
  v_mfma_f32_32x32x16_bf16 a[32:47], a[132:135], a[160:163], a[32:47]
  ds_read_b64_tr_b16 a[148:149], v29 offset:12288
  ds_read_b64_tr_b16 a[150:151], v29 offset:12800
  v_add_f32_dpp v54, v54, v54 quad_perm:[2,3,0,1] row_mask:0xf bank_mask:0xf
  v_add_f32_dpp v56, v56, v56 quad_perm:[2,3,0,1] row_mask:0xf bank_mask:0xf
  s_nop 0
  v_add_f32_dpp v54, v54, v54 row_half_mirror row_mask:0xf bank_mask:0xf
  v_mfma_f32_32x32x16_bf16 a[48:63], a[132:135], a[164:167], a[48:63]
  ds_read_b64_tr_b16 a[152:153], v28 offset:14336
  ds_read_b64_tr_b16 a[154:155], v28 offset:14848
  buffer_load_dwordx4 v47, s[28:31], s54 offen offset:1024 lds
  s_add_u32 m0, s52, 10240
  v_add_f32_dpp v56, v56, v56 row_half_mirror row_mask:0xf bank_mask:0xf
  v_mfma_f32_32x32x16_bf16 a[64:79], a[136:139], a[160:163], a[64:79]
  ds_read_b64_tr_b16 a[156:157], v29 offset:14336
  ds_read_b64_tr_b16 a[158:159], v29 offset:14848
  v_mul_f32 v54, 0x3b000000, v54
  v_mul_f32 v56, 0x3b000000, v56
  v_sub_f32 v54, v54, v32
  v_mfma_f32_32x32x16_bf16 a[80:95], a[136:139], a[164:167], a[80:95]
  buffer_load_dwordx4 v46, s[32:35], s54 offen offset:0 lds
  v_sub_f32 v56, v56, v33
  v_cvt_pk_bf16_f32 v54, v54, v54
  v_cvt_pk_bf16_f32 v56, v56, v56
  v_lshlrev_b32 v54, 16, v54
  v_mfma_f32_32x32x16_bf16 a[96:111], a[140:143], a[160:163], a[96:111]
  v_lshlrev_b32 v56, 16, v56
  v_add_f32 v54, 0x3727c5ac, v54
  v_add_f32 v56, 0x3727c5ac, v56
  v_cvt_pk_bf16_f32 v54, v54, v54
  v_cvt_pk_bf16_f32 v56, v56, v56
  v_mfma_f32_32x32x16_bf16 a[112:127], a[140:143], a[164:167], a[112:127]
  buffer_load_dwordx4 v47, s[32:35], s54 offen offset:1024 lds
  v_lshlrev_b32 v54, 16, v54
  v_lshlrev_b32 v56, 16, v56
  v_sqrt_f32 v54, v54
  s_waitcnt vmcnt(8) lgkmcnt(0)
  v_mfma_f32_32x32x16_bf16 a[0:15], a[144:147], a[168:171], a[0:15]
  v_xor_b32 v36, 256, v34
  ds_read_b64_tr_b16 a[128:129], v28 offset:0
  ds_read_b64_tr_b16 a[130:131], v28 offset:512
  s_add_u32 m0, s52, 12288
  s_xor_b32 s54, s69, 11
  s_mul_i32 s54, s54, 57344
  v_mfma_f32_32x32x16_bf16 a[16:31], a[144:147], a[172:175], a[16:31]
  ds_read_b128 a[160:163], v36 offset:0
  ds_read_b128 a[164:167], v36 offset:32768
  buffer_load_dwordx4 v46, s[28:31], s54 offen offset:0 lds
  v_sqrt_f32 v56, v56
  v_mfma_f32_32x32x16_bf16 a[32:47], a[148:151], a[168:171], a[32:47]
  ds_read_b64_tr_b16 a[132:133], v29 offset:0
  ds_read_b64_tr_b16 a[134:135], v29 offset:512
  v_cvt_pk_bf16_f32 v54, v54, v54
  v_cvt_pk_bf16_f32 v56, v56, v56
  v_lshlrev_b32 v54, 16, v54
  v_mfma_f32_32x32x16_bf16 a[48:63], a[148:151], a[172:175], a[48:63]
  ds_read_b64_tr_b16 a[136:137], v28 offset:2048
  ds_read_b64_tr_b16 a[138:139], v28 offset:2560
  buffer_load_dwordx4 v47, s[28:31], s54 offen offset:1024 lds
  s_add_u32 m0, s52, 14336
  v_lshlrev_b32 v56, 16, v56
  v_mfma_f32_32x32x16_bf16 a[64:79], a[152:155], a[168:171], a[64:79]
  ds_read_b64_tr_b16 a[140:141], v29 offset:2048
  ds_read_b64_tr_b16 a[142:143], v29 offset:2560
  ds_write_b32 v53, v54
  ds_write_b32 v53, v56 offset:32
  s_mov_b32 s12, s74
  v_mfma_f32_32x32x16_bf16 a[80:95], a[152:155], a[172:175], a[80:95]
  buffer_load_dwordx4 v46, s[32:35], s54 offen offset:0 lds
  s_mov_b32 s13, s75
  s_mov_b32 s14, 4194304
  s_mov_b32 s15, 0x20000
  s_mov_b32 s16, s76
  v_mfma_f32_32x32x16_bf16 a[96:111], a[156:159], a[168:171], a[96:111]
  s_mov_b32 s17, s77
  s_mov_b32 s18, 4194304
  s_mov_b32 s19, 0x20000
  s_mov_b32 s24, s80
  s_mov_b32 s25, s81
  v_mfma_f32_32x32x16_bf16 a[112:127], a[156:159], a[172:175], a[112:127]
  buffer_load_dwordx4 v47, s[32:35], s54 offen offset:1024 lds
  s_mov_b32 s26, 4194304
  s_mov_b32 s27, 0x20000
  s_add_u32 s76, s94, 33554432
  s_addc_u32 s77, s95, 0
  s_waitcnt vmcnt(8) lgkmcnt(2)
  v_mfma_f32_32x32x16_bf16 a[0:15], a[128:131], a[160:163], a[0:15]
  v_xor_b32 v36, 288, v34
  ds_read_b64_tr_b16 a[144:145], v28 offset:4096
  ds_read_b64_tr_b16 a[146:147], v28 offset:4608
  s_add_u32 m0, s52, 0
  s_xor_b32 s54, s69, 12
  s_mul_i32 s54, s54, 57344
  v_mfma_f32_32x32x16_bf16 a[16:31], a[128:131], a[164:167], a[16:31]
  ds_read_b128 a[168:171], v36 offset:0
  ds_read_b128 a[172:175], v36 offset:32768
  buffer_load_dwordx4 v46, s[28:31], s54 offen offset:0 lds
  s_mov_b32 s78, 32768
  s_mov_b32 s79, 0x20000
  v_mfma_f32_32x32x16_bf16 a[32:47], a[132:135], a[160:163], a[32:47]
  ds_read_b64_tr_b16 a[148:149], v29 offset:4096
  ds_read_b64_tr_b16 a[150:151], v29 offset:4608
  s_mov_b32 s80, s92
  s_mov_b32 s81, s93
  s_mov_b32 s82, 256
  v_mfma_f32_32x32x16_bf16 a[48:63], a[132:135], a[164:167], a[48:63]
  ds_read_b64_tr_b16 a[152:153], v28 offset:6144
  ds_read_b64_tr_b16 a[154:155], v28 offset:6656
  buffer_load_dwordx4 v47, s[28:31], s54 offen offset:1024 lds
  s_add_u32 m0, s52, 2048
  s_mov_b32 s83, 0x20000
  v_mfma_f32_32x32x16_bf16 a[64:79], a[136:139], a[160:163], a[64:79]
  ds_read_b64_tr_b16 a[156:157], v29 offset:6144
  ds_read_b64_tr_b16 a[158:159], v29 offset:6656
  s_lshl2_add_u32 s70, s5, s4
  s_lshl_b32 s70, s70, 7
  s_lshl2_add_u32 s70, s6, s70
  v_mfma_f32_32x32x16_bf16 a[80:95], a[136:139], a[164:167], a[80:95]
  buffer_load_dwordx4 v46, s[32:35], s54 offen offset:0 lds
  v_mov_b32 v5, 0
  buffer_store_dword v5, off, s[76:79], s70 sc1
  s_lshl_b32 s61, s5, 7
  s_add_u32 s61, s61, 16384
  v_mfma_f32_32x32x16_bf16 a[96:111], a[140:143], a[160:163], a[96:111]
  s_lshl2_add_u32 s3, s6, s61
  buffer_store_dword v5, off, s[76:79], s3 sc1
  v_min_u32 v4, 1, v0
  v_lshlrev_b32 v4, 20, v4
  v_mov_b32 v5, 1
  v_mfma_f32_32x32x16_bf16 a[112:127], a[140:143], a[164:167], a[112:127]
  buffer_load_dwordx4 v47, s[32:35], s54 offen offset:1024 lds
  s_lshl_b32 s71, s5, 2
  s_add_u32 s71, s71, 128
  s_waitcnt vmcnt(10) lgkmcnt(0)
  v_mfma_f32_32x32x16_bf16 a[0:15], a[144:147], a[168:171], a[0:15]
  v_xor_b32 v36, 320, v34
  ds_read_b64_tr_b16 a[128:129], v28 offset:8192
  ds_read_b64_tr_b16 a[130:131], v28 offset:8704
  s_add_u32 m0, s52, 4096
  s_xor_b32 s54, s69, 13
  s_mul_i32 s54, s54, 57344
  v_mfma_f32_32x32x16_bf16 a[16:31], a[144:147], a[172:175], a[16:31]
  ds_read_b128 a[160:163], v36 offset:0
  ds_read_b128 a[164:167], v36 offset:32768
  buffer_load_dwordx4 v46, s[28:31], s54 offen offset:0 lds
  v_mfma_f32_32x32x16_bf16 a[32:47], a[148:151], a[168:171], a[32:47]
  ds_read_b64_tr_b16 a[132:133], v29 offset:8192
  ds_read_b64_tr_b16 a[134:135], v29 offset:8704
  v_mfma_f32_32x32x16_bf16 a[48:63], a[148:151], a[172:175], a[48:63]
  ds_read_b64_tr_b16 a[136:137], v28 offset:10240
  ds_read_b64_tr_b16 a[138:139], v28 offset:10752
  buffer_load_dwordx4 v47, s[28:31], s54 offen offset:1024 lds
  s_add_u32 m0, s52, 6144
  v_mfma_f32_32x32x16_bf16 a[64:79], a[152:155], a[168:171], a[64:79]
  ds_read_b64_tr_b16 a[140:141], v29 offset:10240
  ds_read_b64_tr_b16 a[142:143], v29 offset:10752
  v_mfma_f32_32x32x16_bf16 a[80:95], a[152:155], a[172:175], a[80:95]
  buffer_load_dwordx4 v46, s[32:35], s54 offen offset:0 lds
  v_mfma_f32_32x32x16_bf16 a[96:111], a[156:159], a[168:171], a[96:111]
  v_mfma_f32_32x32x16_bf16 a[112:127], a[156:159], a[172:175], a[112:127]
  buffer_load_dwordx4 v47, s[32:35], s54 offen offset:1024 lds
  s_waitcnt vmcnt(10) lgkmcnt(0)
  v_mfma_f32_32x32x16_bf16 a[0:15], a[128:131], a[160:163], a[0:15]
  v_xor_b32 v36, 352, v34
  ds_read_b64_tr_b16 a[144:145], v28 offset:12288
  ds_read_b64_tr_b16 a[146:147], v28 offset:12800
  s_add_u32 m0, s52, 8192
  s_xor_b32 s54, s69, 14
  s_mul_i32 s54, s54, 57344
  v_mfma_f32_32x32x16_bf16 a[16:31], a[128:131], a[164:167], a[16:31]
  ds_read_b128 a[168:171], v36 offset:0
  ds_read_b128 a[172:175], v36 offset:32768
  buffer_load_dwordx4 v46, s[28:31], s54 offen offset:0 lds
  v_mfma_f32_32x32x16_bf16 a[32:47], a[132:135], a[160:163], a[32:47]
  ds_read_b64_tr_b16 a[148:149], v29 offset:12288
  ds_read_b64_tr_b16 a[150:151], v29 offset:12800
  v_mfma_f32_32x32x16_bf16 a[48:63], a[132:135], a[164:167], a[48:63]
  ds_read_b64_tr_b16 a[152:153], v28 offset:14336
  ds_read_b64_tr_b16 a[154:155], v28 offset:14848
  buffer_load_dwordx4 v47, s[28:31], s54 offen offset:1024 lds
  s_add_u32 m0, s52, 10240
  v_mfma_f32_32x32x16_bf16 a[64:79], a[136:139], a[160:163], a[64:79]
  ds_read_b64_tr_b16 a[156:157], v29 offset:14336
  ds_read_b64_tr_b16 a[158:159], v29 offset:14848
  v_mfma_f32_32x32x16_bf16 a[80:95], a[136:139], a[164:167], a[80:95]
  buffer_load_dwordx4 v46, s[32:35], s54 offen offset:0 lds
  v_mfma_f32_32x32x16_bf16 a[96:111], a[140:143], a[160:163], a[96:111]
  v_mfma_f32_32x32x16_bf16 a[112:127], a[140:143], a[164:167], a[112:127]
  buffer_load_dwordx4 v47, s[32:35], s54 offen offset:1024 lds
  s_waitcnt vmcnt(8) lgkmcnt(0)
  v_mfma_f32_32x32x16_bf16 a[0:15], a[144:147], a[168:171], a[0:15]
  v_xor_b32 v36, 384, v34
  ds_read_b64_tr_b16 a[128:129], v28 offset:0
  ds_read_b64_tr_b16 a[130:131], v28 offset:512
  s_add_u32 m0, s52, 12288
  s_xor_b32 s54, s69, 15
  s_mul_i32 s54, s54, 57344
  v_mfma_f32_32x32x16_bf16 a[16:31], a[144:147], a[172:175], a[16:31]
  ds_read_b128 a[160:163], v36 offset:0
  ds_read_b128 a[164:167], v36 offset:32768
  buffer_load_dwordx4 v46, s[28:31], s54 offen offset:0 lds
  v_mfma_f32_32x32x16_bf16 a[32:47], a[148:151], a[168:171], a[32:47]
  ds_read_b64_tr_b16 a[132:133], v29 offset:0
  ds_read_b64_tr_b16 a[134:135], v29 offset:512
  v_mfma_f32_32x32x16_bf16 a[48:63], a[148:151], a[172:175], a[48:63]
  ds_read_b64_tr_b16 a[136:137], v28 offset:2048
  ds_read_b64_tr_b16 a[138:139], v28 offset:2560
  buffer_load_dwordx4 v47, s[28:31], s54 offen offset:1024 lds
  s_add_u32 m0, s52, 14336
  v_mfma_f32_32x32x16_bf16 a[64:79], a[152:155], a[168:171], a[64:79]
  ds_read_b64_tr_b16 a[140:141], v29 offset:2048
  ds_read_b64_tr_b16 a[142:143], v29 offset:2560
  v_mfma_f32_32x32x16_bf16 a[80:95], a[152:155], a[172:175], a[80:95]
  buffer_load_dwordx4 v46, s[32:35], s54 offen offset:0 lds
  v_mfma_f32_32x32x16_bf16 a[96:111], a[156:159], a[168:171], a[96:111]
  v_mfma_f32_32x32x16_bf16 a[112:127], a[156:159], a[172:175], a[112:127]
  buffer_load_dwordx4 v47, s[32:35], s54 offen offset:1024 lds
  s_waitcnt vmcnt(8) lgkmcnt(0)
  v_mfma_f32_32x32x16_bf16 a[0:15], a[128:131], a[160:163], a[0:15]
  v_xor_b32 v36, 416, v34
  ds_read_b64_tr_b16 a[144:145], v28 offset:4096
  ds_read_b64_tr_b16 a[146:147], v28 offset:4608
  s_add_u32 m0, s52, 0
  s_xor_b32 s54, s69, 16
  s_mul_i32 s54, s54, 57344
  v_mfma_f32_32x32x16_bf16 a[16:31], a[128:131], a[164:167], a[16:31]
  ds_read_b128 a[168:171], v36 offset:0
  ds_read_b128 a[172:175], v36 offset:32768
  buffer_load_dwordx4 v46, s[28:31], s54 offen offset:0 lds
  v_mfma_f32_32x32x16_bf16 a[32:47], a[132:135], a[160:163], a[32:47]
  ds_read_b64_tr_b16 a[148:149], v29 offset:4096
  ds_read_b64_tr_b16 a[150:151], v29 offset:4608
  v_mfma_f32_32x32x16_bf16 a[48:63], a[132:135], a[164:167], a[48:63]
  ds_read_b64_tr_b16 a[152:153], v28 offset:6144
  ds_read_b64_tr_b16 a[154:155], v28 offset:6656
  buffer_load_dwordx4 v47, s[28:31], s54 offen offset:1024 lds
  s_add_u32 m0, s52, 2048
  v_mfma_f32_32x32x16_bf16 a[64:79], a[136:139], a[160:163], a[64:79]
  ds_read_b64_tr_b16 a[156:157], v29 offset:6144
  ds_read_b64_tr_b16 a[158:159], v29 offset:6656
  v_mfma_f32_32x32x16_bf16 a[80:95], a[136:139], a[164:167], a[80:95]
  buffer_load_dwordx4 v46, s[32:35], s54 offen offset:0 lds
  v_mfma_f32_32x32x16_bf16 a[96:111], a[140:143], a[160:163], a[96:111]
  v_mfma_f32_32x32x16_bf16 a[112:127], a[140:143], a[164:167], a[112:127]
  buffer_load_dwordx4 v47, s[32:35], s54 offen offset:1024 lds
  s_waitcnt vmcnt(8) lgkmcnt(0)
  v_mfma_f32_32x32x16_bf16 a[0:15], a[144:147], a[168:171], a[0:15]
  v_xor_b32 v36, 448, v34
  ds_read_b64_tr_b16 a[128:129], v28 offset:8192
  ds_read_b64_tr_b16 a[130:131], v28 offset:8704
  s_add_u32 m0, s52, 4096
  s_xor_b32 s54, s69, 17
  s_mul_i32 s54, s54, 57344
  v_mfma_f32_32x32x16_bf16 a[16:31], a[144:147], a[172:175], a[16:31]
  ds_read_b128 a[160:163], v36 offset:0
  ds_read_b128 a[164:167], v36 offset:32768
  buffer_load_dwordx4 v46, s[28:31], s54 offen offset:0 lds
  v_mfma_f32_32x32x16_bf16 a[32:47], a[148:151], a[168:171], a[32:47]
  ds_read_b64_tr_b16 a[132:133], v29 offset:8192
  ds_read_b64_tr_b16 a[134:135], v29 offset:8704
  v_mfma_f32_32x32x16_bf16 a[48:63], a[148:151], a[172:175], a[48:63]
  ds_read_b64_tr_b16 a[136:137], v28 offset:10240
  ds_read_b64_tr_b16 a[138:139], v28 offset:10752
  buffer_load_dwordx4 v47, s[28:31], s54 offen offset:1024 lds
  s_add_u32 m0, s52, 6144
  v_mfma_f32_32x32x16_bf16 a[64:79], a[152:155], a[168:171], a[64:79]
  ds_read_b64_tr_b16 a[140:141], v29 offset:10240
  ds_read_b64_tr_b16 a[142:143], v29 offset:10752
  v_mfma_f32_32x32x16_bf16 a[80:95], a[152:155], a[172:175], a[80:95]
  buffer_load_dwordx4 v46, s[32:35], s54 offen offset:0 lds
  v_mfma_f32_32x32x16_bf16 a[96:111], a[156:159], a[168:171], a[96:111]
  v_mfma_f32_32x32x16_bf16 a[112:127], a[156:159], a[172:175], a[112:127]
  buffer_load_dwordx4 v47, s[32:35], s54 offen offset:1024 lds
  s_waitcnt vmcnt(8) lgkmcnt(0)
  v_mfma_f32_32x32x16_bf16 a[0:15], a[128:131], a[160:163], a[0:15]
  v_xor_b32 v36, 480, v34
  ds_read_b64_tr_b16 a[144:145], v28 offset:12288
  ds_read_b64_tr_b16 a[146:147], v28 offset:12800
  s_add_u32 m0, s52, 8192
  s_xor_b32 s54, s69, 18
  s_mul_i32 s54, s54, 57344
  v_mfma_f32_32x32x16_bf16 a[16:31], a[128:131], a[164:167], a[16:31]
  ds_read_b128 a[168:171], v36 offset:0
  ds_read_b128 a[172:175], v36 offset:32768
  buffer_load_dwordx4 v46, s[28:31], s54 offen offset:0 lds
  v_mfma_f32_32x32x16_bf16 a[32:47], a[132:135], a[160:163], a[32:47]
  ds_read_b64_tr_b16 a[148:149], v29 offset:12288
  ds_read_b64_tr_b16 a[150:151], v29 offset:12800
  v_mfma_f32_32x32x16_bf16 a[48:63], a[132:135], a[164:167], a[48:63]
  ds_read_b64_tr_b16 a[152:153], v28 offset:14336
  ds_read_b64_tr_b16 a[154:155], v28 offset:14848
  buffer_load_dwordx4 v47, s[28:31], s54 offen offset:1024 lds
  s_add_u32 m0, s52, 10240
  v_mfma_f32_32x32x16_bf16 a[64:79], a[136:139], a[160:163], a[64:79]
  ds_read_b64_tr_b16 a[156:157], v29 offset:14336
  ds_read_b64_tr_b16 a[158:159], v29 offset:14848
  v_mfma_f32_32x32x16_bf16 a[80:95], a[136:139], a[164:167], a[80:95]
  buffer_load_dwordx4 v46, s[32:35], s54 offen offset:0 lds
  v_mfma_f32_32x32x16_bf16 a[96:111], a[140:143], a[160:163], a[96:111]
  v_mfma_f32_32x32x16_bf16 a[112:127], a[140:143], a[164:167], a[112:127]
  buffer_load_dwordx4 v47, s[32:35], s54 offen offset:1024 lds
  s_waitcnt vmcnt(8) lgkmcnt(0)
  v_mfma_f32_32x32x16_bf16 a[0:15], a[144:147], a[168:171], a[0:15]
  v_xor_b32 v36, 512, v34
  ds_read_b64_tr_b16 a[128:129], v28 offset:0
  ds_read_b64_tr_b16 a[130:131], v28 offset:512
  s_add_u32 m0, s52, 12288
  s_xor_b32 s54, s69, 19
  s_mul_i32 s54, s54, 57344
  v_mfma_f32_32x32x16_bf16 a[16:31], a[144:147], a[172:175], a[16:31]
  ds_read_b128 a[160:163], v36 offset:0
  ds_read_b128 a[164:167], v36 offset:32768
  buffer_load_dwordx4 v46, s[28:31], s54 offen offset:0 lds
  v_mfma_f32_32x32x16_bf16 a[32:47], a[148:151], a[168:171], a[32:47]
  ds_read_b64_tr_b16 a[132:133], v29 offset:0
  ds_read_b64_tr_b16 a[134:135], v29 offset:512
  v_mfma_f32_32x32x16_bf16 a[48:63], a[148:151], a[172:175], a[48:63]
  ds_read_b64_tr_b16 a[136:137], v28 offset:2048
  ds_read_b64_tr_b16 a[138:139], v28 offset:2560
  buffer_load_dwordx4 v47, s[28:31], s54 offen offset:1024 lds
  s_add_u32 m0, s52, 14336
  v_mfma_f32_32x32x16_bf16 a[64:79], a[152:155], a[168:171], a[64:79]
  ds_read_b64_tr_b16 a[140:141], v29 offset:2048
  ds_read_b64_tr_b16 a[142:143], v29 offset:2560
  v_mfma_f32_32x32x16_bf16 a[80:95], a[152:155], a[172:175], a[80:95]
  buffer_load_dwordx4 v46, s[32:35], s54 offen offset:0 lds
  v_mfma_f32_32x32x16_bf16 a[96:111], a[156:159], a[168:171], a[96:111]
  v_mfma_f32_32x32x16_bf16 a[112:127], a[156:159], a[172:175], a[112:127]
  buffer_load_dwordx4 v47, s[32:35], s54 offen offset:1024 lds
  s_waitcnt vmcnt(8) lgkmcnt(0)
  v_mfma_f32_32x32x16_bf16 a[0:15], a[128:131], a[160:163], a[0:15]
  v_xor_b32 v36, 544, v34
  ds_read_b64_tr_b16 a[144:145], v28 offset:4096
  ds_read_b64_tr_b16 a[146:147], v28 offset:4608
  s_add_u32 m0, s52, 0
  s_xor_b32 s54, s69, 20
  s_mul_i32 s54, s54, 57344
  v_mfma_f32_32x32x16_bf16 a[16:31], a[128:131], a[164:167], a[16:31]
  ds_read_b128 a[168:171], v36 offset:0
  ds_read_b128 a[172:175], v36 offset:32768
  buffer_load_dwordx4 v46, s[28:31], s54 offen offset:0 lds
  v_mfma_f32_32x32x16_bf16 a[32:47], a[132:135], a[160:163], a[32:47]
  ds_read_b64_tr_b16 a[148:149], v29 offset:4096
  ds_read_b64_tr_b16 a[150:151], v29 offset:4608
  s_barrier
  v_mfma_f32_32x32x16_bf16 a[48:63], a[132:135], a[164:167], a[48:63]
  ds_read_b64_tr_b16 a[152:153], v28 offset:6144
  ds_read_b64_tr_b16 a[154:155], v28 offset:6656
  buffer_load_dwordx4 v47, s[28:31], s54 offen offset:1024 lds
  s_add_u32 m0, s52, 2048
  v_mfma_f32_32x32x16_bf16 a[64:79], a[136:139], a[160:163], a[64:79]
  ds_read_b64_tr_b16 a[156:157], v29 offset:6144
  ds_read_b64_tr_b16 a[158:159], v29 offset:6656
  buffer_atomic_add v5, v4, s[80:83], s71 offen
  v_mfma_f32_32x32x16_bf16 a[80:95], a[136:139], a[164:167], a[80:95]
  buffer_load_dwordx4 v46, s[32:35], s54 offen offset:0 lds
  ds_read_b32 v10, v58
  ds_read_b32 v11, v58 offset:128
  v_mfma_f32_32x32x16_bf16 a[96:111], a[140:143], a[160:163], a[96:111]
  v_mfma_f32_32x32x16_bf16 a[112:127], a[140:143], a[164:167], a[112:127]
  buffer_load_dwordx4 v47, s[32:35], s54 offen offset:1024 lds
  s_waitcnt vmcnt(9) lgkmcnt(2)
  v_mfma_f32_32x32x16_bf16 a[0:15], a[144:147], a[168:171], a[0:15]
  v_xor_b32 v36, 576, v34
  ds_read_b64_tr_b16 a[128:129], v28 offset:8192
  ds_read_b64_tr_b16 a[130:131], v28 offset:8704
  s_add_u32 m0, s52, 4096
  s_xor_b32 s54, s69, 21
  s_mul_i32 s54, s54, 57344
  v_mfma_f32_32x32x16_bf16 a[16:31], a[144:147], a[172:175], a[16:31]
  ds_read_b128 a[160:163], v36 offset:0
  ds_read_b128 a[164:167], v36 offset:32768
  buffer_load_dwordx4 v46, s[28:31], s54 offen offset:0 lds
  s_waitcnt lgkmcnt(5)
  v_rcp_f32 v8, v10
  v_mfma_f32_32x32x16_bf16 a[32:47], a[148:151], a[168:171], a[32:47]
  ds_read_b64_tr_b16 a[132:133], v29 offset:8192
  ds_read_b64_tr_b16 a[134:135], v29 offset:8704
  s_waitcnt lgkmcnt(6)
  v_rcp_f32 v9, v11
  v_mul_f32 v58, 0x3e0293ee, v8
  v_mfma_f32_32x32x16_bf16 a[48:63], a[148:151], a[172:175], a[48:63]
  ds_read_b64_tr_b16 a[136:137], v28 offset:10240
  ds_read_b64_tr_b16 a[138:139], v28 offset:10752
  buffer_load_dwordx4 v47, s[28:31], s54 offen offset:1024 lds
  s_add_u32 m0, s52, 6144
  v_mul_f32 v59, 0x3e0293ee, v9
  v_mfma_f32_32x32x16_bf16 a[64:79], a[152:155], a[168:171], a[64:79]
  ds_read_b64_tr_b16 a[140:141], v29 offset:10240
  ds_read_b64_tr_b16 a[142:143], v29 offset:10752
  v_mul_f32 v8, 0xbfb8aa3b, v8
  v_mul_f32 v9, 0xbfb8aa3b, v9
  s_mov_b32 s36, s88
  v_mfma_f32_32x32x16_bf16 a[80:95], a[152:155], a[172:175], a[80:95]
  buffer_load_dwordx4 v46, s[32:35], s54 offen offset:0 lds
  s_mov_b32 s37, s89
  s_mov_b32 s38, 1835008
  s_mov_b32 s39, 0x20000
  s_mov_b32 s48, s90
  v_mfma_f32_32x32x16_bf16 a[96:111], a[156:159], a[168:171], a[96:111]
  s_mov_b32 s49, s91
  s_mov_b32 s50, 2097152
  s_mov_b32 s51, 0x20000
  s_mov_b32 s40, s94
  s_mov_b32 s41, s95
  v_mfma_f32_32x32x16_bf16 a[112:127], a[156:159], a[172:175], a[112:127]
  buffer_load_dwordx4 v47, s[32:35], s54 offen offset:1024 lds
  s_mov_b32 s42, 33554432
  s_mov_b32 s43, 0x20000
  s_add_u32 s44, s94, 20971520
  s_addc_u32 s45, s95, 0
  s_waitcnt vmcnt(9) lgkmcnt(0)
  v_mfma_f32_32x32x16_bf16 a[0:15], a[128:131], a[160:163], a[0:15]
  v_xor_b32 v36, 608, v34
  ds_read_b64_tr_b16 a[144:145], v28 offset:12288
  ds_read_b64_tr_b16 a[146:147], v28 offset:12800
  s_add_u32 m0, s52, 8192
  s_xor_b32 s54, s69, 22
  s_mul_i32 s54, s54, 57344
  v_mfma_f32_32x32x16_bf16 a[16:31], a[128:131], a[164:167], a[16:31]
  ds_read_b128 a[168:171], v36 offset:0
  ds_read_b128 a[172:175], v36 offset:32768
  buffer_load_dwordx4 v46, s[28:31], s54 offen offset:0 lds
  s_mov_b32 s46, 7340032
  s_mov_b32 s47, 0x20000
  v_mfma_f32_32x32x16_bf16 a[32:47], a[132:135], a[160:163], a[32:47]
  ds_read_b64_tr_b16 a[148:149], v29 offset:12288
  ds_read_b64_tr_b16 a[150:151], v29 offset:12800
  s_add_u32 s84, s94, 20971520
  s_addc_u32 s85, s95, 0
  s_mov_b32 s86, 63488
  v_mfma_f32_32x32x16_bf16 a[48:63], a[132:135], a[164:167], a[48:63]
  ds_read_b64_tr_b16 a[152:153], v28 offset:14336
  ds_read_b64_tr_b16 a[154:155], v28 offset:14848
  buffer_load_dwordx4 v47, s[28:31], s54 offen offset:1024 lds
  s_add_u32 m0, s52, 10240
  s_mov_b32 s87, 0x20000
  v_mfma_f32_32x32x16_bf16 a[64:79], a[136:139], a[160:163], a[64:79]
  ds_read_b64_tr_b16 a[156:157], v29 offset:14336
  ds_read_b64_tr_b16 a[158:159], v29 offset:14848
  s_cmp_eq_u32 s101, 1
  s_cselect_b32 s46, 0, s46
  s_mov_b32 s94, s61
  v_mfma_f32_32x32x16_bf16 a[80:95], a[136:139], a[164:167], a[80:95]
  buffer_load_dwordx4 v46, s[32:35], s54 offen offset:0 lds
  s_lshl_b32 s58, s6, 19
  s_lshl_b32 s3, s57, 14
  s_or_b32 s58, s58, s3
  s_lshl_b32 s60, s6, 19
  v_mfma_f32_32x32x16_bf16 a[96:111], a[140:143], a[160:163], a[96:111]
  s_or_b32 s60, s60, 0x60000
  s_lshl_b32 s3, s5, 14
  s_and_b32 s3, s3, 114688
  s_or_b32 s60, s60, s3
  s_mul_i32 s68, s5, 229376
  v_mfma_f32_32x32x16_bf16 a[112:127], a[140:143], a[164:167], a[112:127]
  buffer_load_dwordx4 v47, s[32:35], s54 offen offset:1024 lds
  s_lshl_b32 s3, s4, 13
  s_add_u32 s66, s68, s3
  s_lshl_b32 s3, s7, 15
  s_add_u32 s66, s66, s3
  s_waitcnt vmcnt(8) lgkmcnt(0)
  v_mfma_f32_32x32x16_bf16 a[0:15], a[144:147], a[168:171], a[0:15]
  v_xor_b32 v36, 640, v34
  ds_read_b64_tr_b16 a[128:129], v28 offset:0
  ds_read_b64_tr_b16 a[130:131], v28 offset:512
  s_add_u32 m0, s52, 12288
  s_xor_b32 s54, s69, 23
  s_mul_i32 s54, s54, 57344
  v_mfma_f32_32x32x16_bf16 a[16:31], a[144:147], a[172:175], a[16:31]
  ds_read_b128 a[160:163], v36 offset:0
  ds_read_b128 a[164:167], v36 offset:32768
  buffer_load_dwordx4 v46, s[28:31], s54 offen offset:0 lds
  s_add_u32 s67, s66, 4096
  s_mul_i32 s3, s4, 55296
  v_mfma_f32_32x32x16_bf16 a[32:47], a[148:151], a[168:171], a[32:47]
  ds_read_b64_tr_b16 a[132:133], v29 offset:0
  ds_read_b64_tr_b16 a[134:135], v29 offset:512
  s_add_u32 s3, s3, s68
  s_add_u32 s84, s84, s3
  s_addc_u32 s85, s85, 0
  v_mfma_f32_32x32x16_bf16 a[48:63], a[148:151], a[172:175], a[48:63]
  ds_read_b64_tr_b16 a[136:137], v28 offset:2048
  ds_read_b64_tr_b16 a[138:139], v28 offset:2560
  buffer_load_dwordx4 v47, s[28:31], s54 offen offset:1024 lds
  s_add_u32 m0, s52, 14336
  s_lshr_b32 s3, s2, 5
  v_mfma_f32_32x32x16_bf16 a[64:79], a[152:155], a[168:171], a[64:79]
  ds_read_b64_tr_b16 a[140:141], v29 offset:2048
  ds_read_b64_tr_b16 a[142:143], v29 offset:2560
  s_mul_i32 s3, s3, 2
  s_and_b32 s55, s6, 3
  s_mul_i32 s55, s55, 4
  v_mfma_f32_32x32x16_bf16 a[80:95], a[152:155], a[172:175], a[80:95]
  buffer_load_dwordx4 v46, s[32:35], s54 offen offset:0 lds
  s_add_u32 s3, s3, s55
  s_sub_u32 s55, s3, 14
  s_min_u32 s3, s3, s55
  s_sub_u32 s55, s3, 14
  v_mfma_f32_32x32x16_bf16 a[96:111], a[156:159], a[168:171], a[96:111]
  s_min_u32 s3, s3, s55
  s_sub_u32 s55, s3, 14
  s_min_u32 s3, s3, s55
  s_sub_u32 s55, s3, 14
  s_min_u32 s3, s3, s55
  v_mfma_f32_32x32x16_bf16 a[112:127], a[156:159], a[172:175], a[112:127]
  buffer_load_dwordx4 v47, s[32:35], s54 offen offset:1024 lds
  s_lshl_b32 s59, s3, 15
  s_lshl_b32 s68, s3, 12
  s_lshl_b32 s62, s5, 19
  s_lshl_b32 s3, s6, 13
  s_waitcnt vmcnt(8) lgkmcnt(0)
  v_mfma_f32_32x32x16_bf16 a[0:15], a[128:131], a[160:163], a[0:15]
  v_xor_b32 v36, 672, v34
  ds_read_b64_tr_b16 a[144:145], v28 offset:4096
  ds_read_b64_tr_b16 a[146:147], v28 offset:4608
  s_add_u32 m0, s52, 0
  s_xor_b32 s54, s69, 24
  s_mul_i32 s54, s54, 57344
  v_mfma_f32_32x32x16_bf16 a[16:31], a[128:131], a[164:167], a[16:31]
  ds_read_b128 a[168:171], v36 offset:0
  ds_read_b128 a[172:175], v36 offset:32768
  buffer_load_dwordx4 v46, s[28:31], s54 offen offset:0 lds
  s_add_u32 s62, s62, s3
  s_add_u32 s63, s62, 4096
  v_mfma_f32_32x32x16_bf16 a[32:47], a[132:135], a[160:163], a[32:47]
  ds_read_b64_tr_b16 a[148:149], v29 offset:4096
  ds_read_b64_tr_b16 a[150:151], v29 offset:4608
  s_add_u32 s64, s62, 65536
  s_add_u32 s65, s62, 69632
  s_and_b32 s3, s5, 0
  v_mfma_f32_32x32x16_bf16 a[48:63], a[132:135], a[164:167], a[48:63]
  ds_read_b64_tr_b16 a[152:153], v28 offset:6144
  ds_read_b64_tr_b16 a[154:155], v28 offset:6656
  buffer_load_dwordx4 v47, s[28:31], s54 offen offset:1024 lds
  s_add_u32 m0, s52, 2048
  s_xor_b32 s7, s6, s3
  v_mfma_f32_32x32x16_bf16 a[64:79], a[136:139], a[160:163], a[64:79]
  ds_read_b64_tr_b16 a[156:157], v29 offset:6144
  ds_read_b64_tr_b16 a[158:159], v29 offset:6656
  s_lshl3_add_u32 s92, s5, s7
  s_lshl_b32 s92, s92, 16
  s_lshl_b32 s3, s7, 7
  v_mfma_f32_32x32x16_bf16 a[80:95], a[136:139], a[164:167], a[80:95]
  buffer_load_dwordx4 v46, s[32:35], s54 offen offset:0 lds
  s_add_u32 s93, s100, s3
  s_lshl_b32 s3, s4, 17
  v_lshlrev_b32 v50, 4, v1
  v_add_u32 v50, s3, v50
  v_mfma_f32_32x32x16_bf16 a[96:111], a[140:143], a[160:163], a[96:111]
  v_lshrrev_b32 v6, 4, v1
  v_and_b32 v7, 15, v1
  s_lshl_b32 s55, s4, 12
  s_lshl_b32 s3, s4, 8
  v_add_u32 v16, 0, v6
  v_mfma_f32_32x32x16_bf16 a[112:127], a[140:143], a[164:167], a[112:127]
  buffer_load_dwordx4 v47, s[32:35], s54 offen offset:1024 lds
  v_xor_b32 v16, v16, v7
  v_lshlrev_b32 v16, 4, v16
  v_lshl_add_u32 v16, v6, 8, v16
  v_add_u32 v16, s55, v16
  s_waitcnt vmcnt(8) lgkmcnt(0)
  v_mfma_f32_32x32x16_bf16 a[0:15], a[144:147], a[168:171], a[0:15]
  v_xor_b32 v36, 704, v34
  ds_read_b64_tr_b16 a[128:129], v28 offset:8192
  ds_read_b64_tr_b16 a[130:131], v28 offset:8704
  s_add_u32 m0, s52, 4096
  s_xor_b32 s54, s69, 25
  s_mul_i32 s54, s54, 57344
  v_mfma_f32_32x32x16_bf16 a[16:31], a[144:147], a[172:175], a[16:31]
  ds_read_b128 a[160:163], v36 offset:0
  ds_read_b128 a[164:167], v36 offset:32768
  buffer_load_dwordx4 v46, s[28:31], s54 offen offset:0 lds
  v_lshlrev_b32 v42, 1, v6
  v_xor_b32 v42, 0, v42
  v_mfma_f32_32x32x16_bf16 a[32:47], a[148:151], a[168:171], a[32:47]
  ds_read_b64_tr_b16 a[132:133], v29 offset:8192
  ds_read_b64_tr_b16 a[134:135], v29 offset:8704
  v_xor_b32 v42, v42, v7
  v_lshlrev_b32 v42, 4, v42
  v_lshl_add_u32 v42, v6, 10, v42
  v_mfma_f32_32x32x16_bf16 a[48:63], a[148:151], a[172:175], a[48:63]
  ds_read_b64_tr_b16 a[136:137], v28 offset:10240
  ds_read_b64_tr_b16 a[138:139], v28 offset:10752
  buffer_load_dwordx4 v47, s[28:31], s54 offen offset:1024 lds
  s_add_u32 m0, s52, 6144
  v_add_u32 v42, s3, v42
  v_mfma_f32_32x32x16_bf16 a[64:79], a[152:155], a[168:171], a[64:79]
  ds_read_b64_tr_b16 a[140:141], v29 offset:10240
  ds_read_b64_tr_b16 a[142:143], v29 offset:10752
  v_add_u32 v42, 0, v42
  v_add_u32 v17, 4, v6
  v_xor_b32 v17, v17, v7
  v_mfma_f32_32x32x16_bf16 a[80:95], a[152:155], a[172:175], a[80:95]
  buffer_load_dwordx4 v46, s[32:35], s54 offen offset:0 lds
  v_lshlrev_b32 v17, 4, v17
  v_lshl_add_u32 v17, v6, 8, v17
  v_add_u32 v17, s55, v17
  v_lshlrev_b32 v43, 1, v6
  v_mfma_f32_32x32x16_bf16 a[96:111], a[156:159], a[168:171], a[96:111]
  v_xor_b32 v43, 8, v43
  v_xor_b32 v43, v43, v7
  v_lshlrev_b32 v43, 4, v43
  v_lshl_add_u32 v43, v6, 10, v43
  v_add_u32 v43, s3, v43
  v_mfma_f32_32x32x16_bf16 a[112:127], a[156:159], a[172:175], a[112:127]
  buffer_load_dwordx4 v47, s[32:35], s54 offen offset:1024 lds
  v_add_u32 v43, 3072, v43
  v_add_u32 v18, 8, v6
  v_xor_b32 v18, v18, v7
  v_lshlrev_b32 v18, 4, v18
  s_waitcnt vmcnt(8) lgkmcnt(0)
  v_mfma_f32_32x32x16_bf16 a[0:15], a[128:131], a[160:163], a[0:15]
  v_xor_b32 v36, 736, v34
  ds_read_b64_tr_b16 a[144:145], v28 offset:12288
  ds_read_b64_tr_b16 a[146:147], v28 offset:12800
  s_add_u32 m0, s52, 8192
  s_xor_b32 s54, s69, 26
  s_mul_i32 s54, s54, 57344
  v_mfma_f32_32x32x16_bf16 a[16:31], a[128:131], a[164:167], a[16:31]
  ds_read_b128 a[168:171], v36 offset:0
  ds_read_b128 a[172:175], v36 offset:32768
  buffer_load_dwordx4 v46, s[28:31], s54 offen offset:0 lds
  v_lshl_add_u32 v18, v6, 8, v18
  v_add_u32 v18, s55, v18
  v_mfma_f32_32x32x16_bf16 a[32:47], a[132:135], a[160:163], a[32:47]
  ds_read_b64_tr_b16 a[148:149], v29 offset:12288
  ds_read_b64_tr_b16 a[150:151], v29 offset:12800
  v_lshlrev_b32 v44, 1, v6
  v_xor_b32 v44, 0, v44
  v_xor_b32 v44, v44, v7
  v_mfma_f32_32x32x16_bf16 a[48:63], a[132:135], a[164:167], a[48:63]
  ds_read_b64_tr_b16 a[152:153], v28 offset:14336
  ds_read_b64_tr_b16 a[154:155], v28 offset:14848
  buffer_load_dwordx4 v47, s[28:31], s54 offen offset:1024 lds
  s_add_u32 m0, s52, 10240
  v_lshlrev_b32 v44, 4, v44
  v_mfma_f32_32x32x16_bf16 a[64:79], a[136:139], a[160:163], a[64:79]
  ds_read_b64_tr_b16 a[156:157], v29 offset:14336
  ds_read_b64_tr_b16 a[158:159], v29 offset:14848
  v_lshl_add_u32 v44, v6, 10, v44
  v_add_u32 v44, s3, v44
  v_add_u32 v44, 6144, v44
  v_mfma_f32_32x32x16_bf16 a[80:95], a[136:139], a[164:167], a[80:95]
  buffer_load_dwordx4 v46, s[32:35], s54 offen offset:0 lds
  v_add_u32 v19, 12, v6
  v_xor_b32 v19, v19, v7
  v_lshlrev_b32 v19, 4, v19
  v_lshl_add_u32 v19, v6, 8, v19
  v_mfma_f32_32x32x16_bf16 a[96:111], a[140:143], a[160:163], a[96:111]
  v_add_u32 v19, s55, v19
  v_lshlrev_b32 v45, 1, v6
  v_xor_b32 v45, 8, v45
  v_xor_b32 v45, v45, v7
  v_lshlrev_b32 v45, 4, v45
  v_mfma_f32_32x32x16_bf16 a[112:127], a[140:143], a[164:167], a[112:127]
  buffer_load_dwordx4 v47, s[32:35], s54 offen offset:1024 lds
  v_lshl_add_u32 v45, v6, 10, v45
  v_add_u32 v45, s3, v45
  v_add_u32 v45, 9216, v45
  v_lshrrev_b32 v2, 5, v1
  s_waitcnt vmcnt(8) lgkmcnt(0)
  v_mfma_f32_32x32x16_bf16 a[0:15], a[144:147], a[168:171], a[0:15]
  v_xor_b32 v36, 768, v34
  ds_read_b64_tr_b16 a[128:129], v28 offset:0
  ds_read_b64_tr_b16 a[130:131], v28 offset:512
  s_add_u32 m0, s52, 12288
  s_xor_b32 s54, s69, 27
  s_mul_i32 s54, s54, 57344
  v_mfma_f32_32x32x16_bf16 a[16:31], a[144:147], a[172:175], a[16:31]
  ds_read_b128 a[160:163], v36 offset:0
  ds_read_b128 a[164:167], v36 offset:32768
  buffer_load_dwordx4 v46, s[28:31], s54 offen offset:0 lds
  v_bfe_u32 v3, v1, 2, 2
  v_lshl_add_u32 v6, v2, 3, v3
  v_mfma_f32_32x32x16_bf16 a[32:47], a[148:151], a[168:171], a[32:47]
  ds_read_b64_tr_b16 a[132:133], v29 offset:0
  ds_read_b64_tr_b16 a[134:135], v29 offset:512
  v_bfe_u32 v7, v1, 4, 1
  v_lshlrev_b32 v23, 4, v7
  v_and_b32 v7, 1, v1
  v_mfma_f32_32x32x16_bf16 a[48:63], a[148:151], a[172:175], a[48:63]
  ds_read_b64_tr_b16 a[136:137], v28 offset:2048
  ds_read_b64_tr_b16 a[138:139], v28 offset:2560
  buffer_load_dwordx4 v47, s[28:31], s54 offen offset:1024 lds
  s_add_u32 m0, s52, 14336
  v_lshl_add_u32 v23, v7, 3, v23
  v_mfma_f32_32x32x16_bf16 a[64:79], a[152:155], a[168:171], a[64:79]
  ds_read_b64_tr_b16 a[140:141], v29 offset:2048
  ds_read_b64_tr_b16 a[142:143], v29 offset:2560
  v_bfe_u32 v7, v1, 1, 1
  v_lshl_add_u32 v23, v7, 5, v23
  v_lshl_add_u32 v6, v6, 8, v23
  v_mfma_f32_32x32x16_bf16 a[80:95], a[152:155], a[172:175], a[80:95]
  buffer_load_dwordx4 v46, s[32:35], s54 offen offset:0 lds
  v_add_u32 v6, 98304, v6
  v_xor_b32 v7, 0, v3
  v_lshl_add_u32 v20, v7, 6, v6
  v_xor_b32 v7, 1, v3
  v_mfma_f32_32x32x16_bf16 a[96:111], a[156:159], a[168:171], a[96:111]
  v_lshl_add_u32 v21, v7, 6, v6
  v_xor_b32 v7, 2, v3
  v_lshl_add_u32 v22, v7, 6, v6
  v_xor_b32 v7, 3, v3
  v_lshl_add_u32 v23, v7, 6, v6
  v_mfma_f32_32x32x16_bf16 a[112:127], a[156:159], a[172:175], a[112:127]
  buffer_load_dwordx4 v47, s[32:35], s54 offen offset:1024 lds
  s_waitcnt vmcnt(8) lgkmcnt(0)
  v_mfma_f32_32x32x16_bf16 a[0:15], a[128:131], a[160:163], a[0:15]
  v_xor_b32 v36, 800, v34
  ds_read_b64_tr_b16 a[144:145], v28 offset:4096
  ds_read_b64_tr_b16 a[146:147], v28 offset:4608
  s_add_u32 m0, s52, 0
  s_xor_b32 s54, s69, 28
  s_mul_i32 s54, s54, 57344
  v_mfma_f32_32x32x16_bf16 a[16:31], a[128:131], a[164:167], a[16:31]
  ds_read_b128 a[168:171], v36 offset:0
  ds_read_b128 a[172:175], v36 offset:32768
  buffer_load_dwordx4 v46, s[28:31], s54 offen offset:0 lds
  v_mfma_f32_32x32x16_bf16 a[32:47], a[132:135], a[160:163], a[32:47]
  ds_read_b64_tr_b16 a[148:149], v29 offset:4096
  ds_read_b64_tr_b16 a[150:151], v29 offset:4608
  v_mfma_f32_32x32x16_bf16 a[48:63], a[132:135], a[164:167], a[48:63]
  ds_read_b64_tr_b16 a[152:153], v28 offset:6144
  ds_read_b64_tr_b16 a[154:155], v28 offset:6656
  buffer_load_dwordx4 v47, s[28:31], s54 offen offset:1024 lds
  s_add_u32 m0, s52, 2048
  v_mfma_f32_32x32x16_bf16 a[64:79], a[136:139], a[160:163], a[64:79]
  ds_read_b64_tr_b16 a[156:157], v29 offset:6144
  ds_read_b64_tr_b16 a[158:159], v29 offset:6656
  v_mfma_f32_32x32x16_bf16 a[80:95], a[136:139], a[164:167], a[80:95]
  buffer_load_dwordx4 v46, s[32:35], s54 offen offset:0 lds
  v_mfma_f32_32x32x16_bf16 a[96:111], a[140:143], a[160:163], a[96:111]
  v_mfma_f32_32x32x16_bf16 a[112:127], a[140:143], a[164:167], a[112:127]
  buffer_load_dwordx4 v47, s[32:35], s54 offen offset:1024 lds
  s_waitcnt vmcnt(8) lgkmcnt(0)
  v_mfma_f32_32x32x16_bf16 a[0:15], a[144:147], a[168:171], a[0:15]
  v_xor_b32 v36, 832, v34
  ds_read_b64_tr_b16 a[128:129], v28 offset:8192
  ds_read_b64_tr_b16 a[130:131], v28 offset:8704
  s_add_u32 m0, s52, 4096
  s_xor_b32 s54, s69, 29
  s_mul_i32 s54, s54, 57344
  v_mfma_f32_32x32x16_bf16 a[16:31], a[144:147], a[172:175], a[16:31]
  ds_read_b128 a[160:163], v36 offset:0
  ds_read_b128 a[164:167], v36 offset:32768
  buffer_load_dwordx4 v46, s[28:31], s54 offen offset:0 lds
  v_mfma_f32_32x32x16_bf16 a[32:47], a[148:151], a[168:171], a[32:47]
  ds_read_b64_tr_b16 a[132:133], v29 offset:8192
  ds_read_b64_tr_b16 a[134:135], v29 offset:8704
  v_mfma_f32_32x32x16_bf16 a[48:63], a[148:151], a[172:175], a[48:63]
  ds_read_b64_tr_b16 a[136:137], v28 offset:10240
  ds_read_b64_tr_b16 a[138:139], v28 offset:10752
  buffer_load_dwordx4 v47, s[28:31], s54 offen offset:1024 lds
  s_add_u32 m0, s52, 6144
  v_mfma_f32_32x32x16_bf16 a[64:79], a[152:155], a[168:171], a[64:79]
  ds_read_b64_tr_b16 a[140:141], v29 offset:10240
  ds_read_b64_tr_b16 a[142:143], v29 offset:10752
  v_mfma_f32_32x32x16_bf16 a[80:95], a[152:155], a[172:175], a[80:95]
  buffer_load_dwordx4 v46, s[32:35], s54 offen offset:0 lds
  v_mfma_f32_32x32x16_bf16 a[96:111], a[156:159], a[168:171], a[96:111]
  v_mfma_f32_32x32x16_bf16 a[112:127], a[156:159], a[172:175], a[112:127]
  buffer_load_dwordx4 v47, s[32:35], s54 offen offset:1024 lds
  s_waitcnt vmcnt(8) lgkmcnt(0)
  v_mfma_f32_32x32x16_bf16 a[0:15], a[128:131], a[160:163], a[0:15]
  v_xor_b32 v36, 864, v34
  ds_read_b64_tr_b16 a[144:145], v28 offset:12288
  ds_read_b64_tr_b16 a[146:147], v28 offset:12800
  s_add_u32 m0, s52, 8192
  s_xor_b32 s54, s69, 30
  s_mul_i32 s54, s54, 57344
  v_mfma_f32_32x32x16_bf16 a[16:31], a[128:131], a[164:167], a[16:31]
  ds_read_b128 a[168:171], v36 offset:0
  ds_read_b128 a[172:175], v36 offset:32768
  buffer_load_dwordx4 v46, s[28:31], s54 offen offset:0 lds
  v_mfma_f32_32x32x16_bf16 a[32:47], a[132:135], a[160:163], a[32:47]
  ds_read_b64_tr_b16 a[148:149], v29 offset:12288
  ds_read_b64_tr_b16 a[150:151], v29 offset:12800
  v_mfma_f32_32x32x16_bf16 a[48:63], a[132:135], a[164:167], a[48:63]
  ds_read_b64_tr_b16 a[152:153], v28 offset:14336
  ds_read_b64_tr_b16 a[154:155], v28 offset:14848
  buffer_load_dwordx4 v47, s[28:31], s54 offen offset:1024 lds
  s_add_u32 m0, s52, 10240
  v_mfma_f32_32x32x16_bf16 a[64:79], a[136:139], a[160:163], a[64:79]
  ds_read_b64_tr_b16 a[156:157], v29 offset:14336
  ds_read_b64_tr_b16 a[158:159], v29 offset:14848
  v_mfma_f32_32x32x16_bf16 a[80:95], a[136:139], a[164:167], a[80:95]
  buffer_load_dwordx4 v46, s[32:35], s54 offen offset:0 lds
  v_mfma_f32_32x32x16_bf16 a[96:111], a[140:143], a[160:163], a[96:111]
  v_mfma_f32_32x32x16_bf16 a[112:127], a[140:143], a[164:167], a[112:127]
  buffer_load_dwordx4 v47, s[32:35], s54 offen offset:1024 lds
  s_waitcnt vmcnt(8) lgkmcnt(0)
  v_mfma_f32_32x32x16_bf16 a[0:15], a[144:147], a[168:171], a[0:15]
  v_xor_b32 v36, 896, v34
  ds_read_b64_tr_b16 a[128:129], v28 offset:0
  ds_read_b64_tr_b16 a[130:131], v28 offset:512
  s_add_u32 m0, s52, 12288
  s_xor_b32 s54, s69, 31
  s_mul_i32 s54, s54, 57344
  v_mfma_f32_32x32x16_bf16 a[16:31], a[144:147], a[172:175], a[16:31]
  ds_read_b128 a[160:163], v36 offset:0
  ds_read_b128 a[164:167], v36 offset:32768
  buffer_load_dwordx4 v46, s[28:31], s54 offen offset:0 lds
  v_mfma_f32_32x32x16_bf16 a[32:47], a[148:151], a[168:171], a[32:47]
  ds_read_b64_tr_b16 a[132:133], v29 offset:0
  ds_read_b64_tr_b16 a[134:135], v29 offset:512
  v_mfma_f32_32x32x16_bf16 a[48:63], a[148:151], a[172:175], a[48:63]
  ds_read_b64_tr_b16 a[136:137], v28 offset:2048
  ds_read_b64_tr_b16 a[138:139], v28 offset:2560
  buffer_load_dwordx4 v47, s[28:31], s54 offen offset:1024 lds
  s_add_u32 m0, s52, 14336
  v_mfma_f32_32x32x16_bf16 a[64:79], a[152:155], a[168:171], a[64:79]
  ds_read_b64_tr_b16 a[140:141], v29 offset:2048
  ds_read_b64_tr_b16 a[142:143], v29 offset:2560
  v_mfma_f32_32x32x16_bf16 a[80:95], a[152:155], a[172:175], a[80:95]
  buffer_load_dwordx4 v46, s[32:35], s54 offen offset:0 lds
  v_mfma_f32_32x32x16_bf16 a[96:111], a[156:159], a[168:171], a[96:111]
  v_mfma_f32_32x32x16_bf16 a[112:127], a[156:159], a[172:175], a[112:127]
  buffer_load_dwordx4 v47, s[32:35], s54 offen offset:1024 lds
  s_waitcnt vmcnt(8) lgkmcnt(0)
  v_mfma_f32_32x32x16_bf16 a[0:15], a[128:131], a[160:163], a[0:15]
  v_xor_b32 v36, 928, v34
  ds_read_b64_tr_b16 a[144:145], v28 offset:4096
  ds_read_b64_tr_b16 a[146:147], v28 offset:4608
  s_add_u32 m0, s52, 0
  s_xor_b32 s54, s56, 0
  v_mfma_f32_32x32x16_bf16 a[16:31], a[128:131], a[164:167], a[16:31]
  ds_read_b128 a[168:171], v36 offset:0
  ds_read_b128 a[172:175], v36 offset:32768
  buffer_load_dwordx4 v38, s[20:23], s54 offen offset:0 lds
  v_mfma_f32_32x32x16_bf16 a[32:47], a[132:135], a[160:163], a[32:47]
  ds_read_b64_tr_b16 a[148:149], v29 offset:4096
  ds_read_b64_tr_b16 a[150:151], v29 offset:4608
  v_mfma_f32_32x32x16_bf16 a[48:63], a[132:135], a[164:167], a[48:63]
  ds_read_b64_tr_b16 a[152:153], v28 offset:6144
  ds_read_b64_tr_b16 a[154:155], v28 offset:6656
  buffer_load_dwordx4 v39, s[20:23], s54 offen offset:1024 lds
  v_mfma_f32_32x32x16_bf16 a[64:79], a[136:139], a[160:163], a[64:79]
  ds_read_b64_tr_b16 a[156:157], v29 offset:6144
  ds_read_b64_tr_b16 a[158:159], v29 offset:6656
  v_mfma_f32_32x32x16_bf16 a[80:95], a[136:139], a[164:167], a[80:95]
  buffer_load_dwordx4 v40, s[20:23], s54 offen offset:2048 lds
  v_mfma_f32_32x32x16_bf16 a[96:111], a[140:143], a[160:163], a[96:111]
  v_mfma_f32_32x32x16_bf16 a[112:127], a[140:143], a[164:167], a[112:127]
  buffer_load_dwordx4 v41, s[20:23], s54 offen offset:3072 lds
  s_waitcnt vmcnt(8) lgkmcnt(0)
  v_mfma_f32_32x32x16_bf16 a[0:15], a[144:147], a[168:171], a[0:15]
  v_xor_b32 v36, 960, v34
  ds_read_b64_tr_b16 a[128:129], v28 offset:8192
  ds_read_b64_tr_b16 a[130:131], v28 offset:8704
  s_add_u32 m0, s52, 4096
  s_xor_b32 s54, s56, 131072
  v_mfma_f32_32x32x16_bf16 a[16:31], a[144:147], a[172:175], a[16:31]
  ds_read_b128 a[160:163], v36 offset:0
  ds_read_b128 a[164:167], v36 offset:32768
  buffer_load_dwordx4 v38, s[20:23], s54 offen offset:0 lds
  v_mfma_f32_32x32x16_bf16 a[32:47], a[148:151], a[168:171], a[32:47]
  ds_read_b64_tr_b16 a[132:133], v29 offset:8192
  ds_read_b64_tr_b16 a[134:135], v29 offset:8704
  v_mfma_f32_32x32x16_bf16 a[48:63], a[148:151], a[172:175], a[48:63]
  ds_read_b64_tr_b16 a[136:137], v28 offset:10240
  ds_read_b64_tr_b16 a[138:139], v28 offset:10752
  buffer_load_dwordx4 v39, s[20:23], s54 offen offset:1024 lds
  v_mfma_f32_32x32x16_bf16 a[64:79], a[152:155], a[168:171], a[64:79]
  ds_read_b64_tr_b16 a[140:141], v29 offset:10240
  ds_read_b64_tr_b16 a[142:143], v29 offset:10752
  v_mfma_f32_32x32x16_bf16 a[80:95], a[152:155], a[172:175], a[80:95]
  buffer_load_dwordx4 v40, s[20:23], s54 offen offset:2048 lds
  v_mfma_f32_32x32x16_bf16 a[96:111], a[156:159], a[168:171], a[96:111]
  v_mfma_f32_32x32x16_bf16 a[112:127], a[156:159], a[172:175], a[112:127]
  buffer_load_dwordx4 v41, s[20:23], s54 offen offset:3072 lds
  s_waitcnt vmcnt(8) lgkmcnt(0)
  v_mfma_f32_32x32x16_bf16 a[0:15], a[128:131], a[160:163], a[0:15]
  v_xor_b32 v36, 992, v34
  ds_read_b64_tr_b16 a[144:145], v28 offset:12288
  ds_read_b64_tr_b16 a[146:147], v28 offset:12800
  s_add_u32 m0, s52, 8192
  s_xor_b32 s54, s56, 262144
  v_mfma_f32_32x32x16_bf16 a[16:31], a[128:131], a[164:167], a[16:31]
  ds_read_b128 a[168:171], v36 offset:0
  ds_read_b128 a[172:175], v36 offset:32768
  buffer_load_dwordx4 v38, s[20:23], s54 offen offset:0 lds
  v_mfma_f32_32x32x16_bf16 a[32:47], a[132:135], a[160:163], a[32:47]
  ds_read_b64_tr_b16 a[148:149], v29 offset:12288
  ds_read_b64_tr_b16 a[150:151], v29 offset:12800
  v_mfma_f32_32x32x16_bf16 a[48:63], a[132:135], a[164:167], a[48:63]
  ds_read_b64_tr_b16 a[152:153], v28 offset:14336
  ds_read_b64_tr_b16 a[154:155], v28 offset:14848
  buffer_load_dwordx4 v39, s[20:23], s54 offen offset:1024 lds
  v_mfma_f32_32x32x16_bf16 a[64:79], a[136:139], a[160:163], a[64:79]
  ds_read_b64_tr_b16 a[156:157], v29 offset:14336
  ds_read_b64_tr_b16 a[158:159], v29 offset:14848
  v_mfma_f32_32x32x16_bf16 a[80:95], a[136:139], a[164:167], a[80:95]
  buffer_load_dwordx4 v40, s[20:23], s54 offen offset:2048 lds
  v_mfma_f32_32x32x16_bf16 a[96:111], a[140:143], a[160:163], a[96:111]
  v_mfma_f32_32x32x16_bf16 a[112:127], a[140:143], a[164:167], a[112:127]
  buffer_load_dwordx4 v41, s[20:23], s54 offen offset:3072 lds
  s_and_b32 s3, s5, 4
  s_lshl_b32 s3, s3, 5
  v_xor_b32 v34, s3, v34
  s_waitcnt vmcnt(8) lgkmcnt(0)
  v_mfma_f32_32x32x16_bf16 a[0:15], a[144:147], a[168:171], a[0:15]
  v_xor_b32 v36, 0, v34
  ds_read_b64_tr_b16 a[128:129], v24 offset:0
  ds_read_b64_tr_b16 a[130:131], v24 offset:1024
  s_add_u32 m0, s52, 12288
  s_xor_b32 s54, s56, 393216
  v_mfma_f32_32x32x16_bf16 a[16:31], a[144:147], a[172:175], a[16:31]
  ds_read_b128 a[160:163], v36 offset:0
  ds_read_b128 a[164:167], v36 offset:32768
  buffer_load_dwordx4 v38, s[20:23], s54 offen offset:0 lds
  v_mfma_f32_32x32x16_bf16 a[32:47], a[148:151], a[168:171], a[32:47]
  ds_read_b64_tr_b16 a[132:133], v25 offset:0
  ds_read_b64_tr_b16 a[134:135], v25 offset:1024
  v_mfma_f32_32x32x16_bf16 a[48:63], a[148:151], a[172:175], a[48:63]
  ds_read_b64_tr_b16 a[136:137], v26 offset:0
  ds_read_b64_tr_b16 a[138:139], v26 offset:1024
  buffer_load_dwordx4 v39, s[20:23], s54 offen offset:1024 lds
  v_mfma_f32_32x32x16_bf16 a[64:79], a[152:155], a[168:171], a[64:79]
  ds_read_b64_tr_b16 a[140:141], v27 offset:0
  ds_read_b64_tr_b16 a[142:143], v27 offset:1024
  v_mfma_f32_32x32x16_bf16 a[80:95], a[152:155], a[172:175], a[80:95]
  buffer_load_dwordx4 v40, s[20:23], s54 offen offset:2048 lds
  v_mfma_f32_32x32x16_bf16 a[96:111], a[156:159], a[168:171], a[96:111]
  v_mfma_f32_32x32x16_bf16 a[112:127], a[156:159], a[172:175], a[112:127]
  buffer_load_dwordx4 v41, s[20:23], s54 offen offset:3072 lds
LQ:
  s_waitcnt vmcnt(8) lgkmcnt(0)
  v_mfma_f32_32x32x16_bf16 v[128:143], a[128:131], a[160:163], 0
  v_xor_b32 v36, 32, v34
  ds_read_b64_tr_b16 a[144:145], v24 offset:4096
  ds_read_b64_tr_b16 a[146:147], v24 offset:5120
  s_add_u32 m0, s52, 0
  s_xor_b32 s54, s56, 524288
  v_mfma_f32_32x32x16_bf16 v[144:159], a[128:131], a[164:167], 0
  ds_read_b128 a[168:171], v36 offset:0
  ds_read_b128 a[172:175], v36 offset:32768
  buffer_load_dwordx4 v38, s[20:23], s54 offen offset:0 lds
  v_mfma_f32_32x32x16_bf16 v[160:175], a[132:135], a[160:163], 0
  ds_read_b64_tr_b16 a[148:149], v25 offset:4096
  ds_read_b64_tr_b16 a[150:151], v25 offset:5120
  v_mfma_f32_32x32x16_bf16 v[176:191], a[132:135], a[164:167], 0
  ds_read_b64_tr_b16 a[152:153], v26 offset:4096
  ds_read_b64_tr_b16 a[154:155], v26 offset:5120
  buffer_load_dwordx4 v39, s[20:23], s54 offen offset:1024 lds
  v_mfma_f32_32x32x16_bf16 v[192:207], a[136:139], a[160:163], 0
  ds_read_b64_tr_b16 a[156:157], v27 offset:4096
  ds_read_b64_tr_b16 a[158:159], v27 offset:5120
  v_mfma_f32_32x32x16_bf16 v[208:223], a[136:139], a[164:167], 0
  buffer_load_dwordx4 v40, s[20:23], s54 offen offset:2048 lds
  v_mfma_f32_32x32x16_bf16 v[224:239], a[140:143], a[160:163], 0
  v_mfma_f32_32x32x16_bf16 v[240:255], a[140:143], a[164:167], 0
  buffer_load_dwordx4 v41, s[20:23], s54 offen offset:3072 lds
  s_waitcnt vmcnt(8) lgkmcnt(0)
  v_mfma_f32_32x32x16_bf16 v[128:143], a[144:147], a[168:171], v[128:143]
  v_xor_b32 v36, 64, v34
  ds_read_b64_tr_b16 a[128:129], v24 offset:8192
  ds_read_b64_tr_b16 a[130:131], v24 offset:9216
  s_add_u32 m0, s52, 4096
  s_xor_b32 s54, s56, 655360
  v_mfma_f32_32x32x16_bf16 v[144:159], a[144:147], a[172:175], v[144:159]
  ds_read_b128 a[160:163], v36 offset:0
  ds_read_b128 a[164:167], v36 offset:32768
  buffer_load_dwordx4 v38, s[20:23], s54 offen offset:0 lds
  v_accvgpr_read_b32 v64, a0
  v_accvgpr_read_b32 v65, a1
  v_mfma_f32_32x32x16_bf16 v[160:175], a[148:151], a[168:171], v[160:175]
  ds_read_b64_tr_b16 a[132:133], v25 offset:8192
  ds_read_b64_tr_b16 a[134:135], v25 offset:9216
  v_accvgpr_read_b32 v66, a2
  v_accvgpr_read_b32 v67, a3
  v_accvgpr_read_b32 v68, a4
  v_mfma_f32_32x32x16_bf16 v[176:191], a[148:151], a[172:175], v[176:191]
  ds_read_b64_tr_b16 a[136:137], v26 offset:8192
  ds_read_b64_tr_b16 a[138:139], v26 offset:9216
  buffer_load_dwordx4 v39, s[20:23], s54 offen offset:1024 lds
  v_accvgpr_read_b32 v69, a5
  v_accvgpr_read_b32 v70, a6
  v_mfma_f32_32x32x16_bf16 v[192:207], a[152:155], a[168:171], v[192:207]
  ds_read_b64_tr_b16 a[140:141], v27 offset:8192
  ds_read_b64_tr_b16 a[142:143], v27 offset:9216
  v_accvgpr_read_b32 v71, a7
  v_mul_f32 v64, v64, v8
  v_mul_f32 v65, v65, v8
  v_mfma_f32_32x32x16_bf16 v[208:223], a[152:155], a[172:175], v[208:223]
  buffer_load_dwordx4 v40, s[20:23], s54 offen offset:2048 lds
  v_mul_f32 v66, v66, v8
  v_mul_f32 v67, v67, v8
  v_mul_f32 v68, v68, v8
  v_mul_f32 v69, v69, v8
  v_mfma_f32_32x32x16_bf16 v[224:239], a[156:159], a[168:171], v[224:239]
  v_mul_f32 v70, v70, v8
  v_mul_f32 v71, v71, v8
  v_exp_f32 v64, v64
  v_mfma_f32_32x32x16_bf16 v[240:255], a[156:159], a[172:175], v[240:255]
  buffer_load_dwordx4 v41, s[20:23], s54 offen offset:3072 lds
  v_exp_f32 v65, v65
  v_exp_f32 v66, v66
  s_waitcnt vmcnt(8) lgkmcnt(0)
  v_mfma_f32_32x32x16_bf16 v[128:143], a[128:131], a[160:163], v[128:143]
  v_xor_b32 v36, 96, v34
  ds_read_b64_tr_b16 a[144:145], v24 offset:12288
  ds_read_b64_tr_b16 a[146:147], v24 offset:13312
  s_add_u32 m0, s52, 8192
  s_xor_b32 s54, s56, 786432
  v_mfma_f32_32x32x16_bf16 v[144:159], a[128:131], a[164:167], v[144:159]
  ds_read_b128 a[168:171], v36 offset:0
  ds_read_b128 a[172:175], v36 offset:32768
  buffer_load_dwordx4 v38, s[20:23], s54 offen offset:0 lds
  v_exp_f32 v67, v67
  v_mfma_f32_32x32x16_bf16 v[160:175], a[132:135], a[160:163], v[160:175]
  ds_read_b64_tr_b16 a[148:149], v25 offset:12288
  ds_read_b64_tr_b16 a[150:151], v25 offset:13312
  v_exp_f32 v68, v68
  v_mfma_f32_32x32x16_bf16 v[176:191], a[132:135], a[164:167], v[176:191]
  ds_read_b64_tr_b16 a[152:153], v26 offset:12288
  ds_read_b64_tr_b16 a[154:155], v26 offset:13312
  buffer_load_dwordx4 v39, s[20:23], s54 offen offset:1024 lds
  v_exp_f32 v69, v69
  v_mfma_f32_32x32x16_bf16 v[192:207], a[136:139], a[160:163], v[192:207]
  ds_read_b64_tr_b16 a[156:157], v27 offset:12288
  ds_read_b64_tr_b16 a[158:159], v27 offset:13312
  v_exp_f32 v70, v70
  v_mfma_f32_32x32x16_bf16 v[208:223], a[136:139], a[164:167], v[208:223]
  buffer_load_dwordx4 v40, s[20:23], s54 offen offset:2048 lds
  v_exp_f32 v71, v71
  v_accvgpr_read_b32 v72, a64
  v_accvgpr_read_b32 v73, a65
  v_mfma_f32_32x32x16_bf16 v[224:239], a[140:143], a[160:163], v[224:239]
  v_accvgpr_read_b32 v74, a66
  v_accvgpr_read_b32 v75, a67
  v_accvgpr_read_b32 v76, a68
  v_accvgpr_read_b32 v77, a69
  v_accvgpr_read_b32 v78, a70
  v_mfma_f32_32x32x16_bf16 v[240:255], a[140:143], a[164:167], v[240:255]
  buffer_load_dwordx4 v41, s[20:23], s54 offen offset:3072 lds
  v_accvgpr_read_b32 v79, a71
  v_fma_f32 v64, v64, v10, v10
  v_fma_f32 v65, v65, v10, v10
  v_fma_f32 v66, v66, v10, v10
  s_waitcnt vmcnt(8) lgkmcnt(0)
  v_mfma_f32_32x32x16_bf16 v[128:143], a[144:147], a[168:171], v[128:143]
  v_xor_b32 v36, 128, v34
  ds_read_b64_tr_b16 a[128:129], v24 offset:0
  ds_read_b64_tr_b16 a[130:131], v24 offset:1024
  s_add_u32 m0, s52, 12288
  s_xor_b32 s54, s56, 917504
  v_mfma_f32_32x32x16_bf16 v[144:159], a[144:147], a[172:175], v[144:159]
  ds_read_b128 a[160:163], v36 offset:0
  ds_read_b128 a[164:167], v36 offset:32768
  buffer_load_dwordx4 v38, s[20:23], s54 offen offset:0 lds
  v_fma_f32 v67, v67, v10, v10
  v_fma_f32 v68, v68, v10, v10
  v_mfma_f32_32x32x16_bf16 v[160:175], a[148:151], a[168:171], v[160:175]
  ds_read_b64_tr_b16 a[132:133], v25 offset:0
  ds_read_b64_tr_b16 a[134:135], v25 offset:1024
  v_fma_f32 v69, v69, v10, v10
  v_fma_f32 v70, v70, v10, v10
  v_fma_f32 v71, v71, v10, v10
  v_mfma_f32_32x32x16_bf16 v[176:191], a[148:151], a[172:175], v[176:191]
  ds_read_b64_tr_b16 a[136:137], v26 offset:0
  ds_read_b64_tr_b16 a[138:139], v26 offset:1024
  buffer_load_dwordx4 v39, s[20:23], s54 offen offset:1024 lds
  v_rcp_f32 v64, v64
  v_mfma_f32_32x32x16_bf16 v[192:207], a[152:155], a[168:171], v[192:207]
  ds_read_b64_tr_b16 a[140:141], v27 offset:0
  ds_read_b64_tr_b16 a[142:143], v27 offset:1024
  v_rcp_f32 v65, v65
  v_mfma_f32_32x32x16_bf16 v[208:223], a[152:155], a[172:175], v[208:223]
  buffer_load_dwordx4 v40, s[20:23], s54 offen offset:2048 lds
  v_rcp_f32 v66, v66
  v_rcp_f32 v67, v67
  v_mfma_f32_32x32x16_bf16 v[224:239], a[156:159], a[168:171], v[224:239]
  v_rcp_f32 v68, v68
  v_rcp_f32 v69, v69
  v_mfma_f32_32x32x16_bf16 v[240:255], a[156:159], a[172:175], v[240:255]
  buffer_load_dwordx4 v41, s[20:23], s54 offen offset:3072 lds
  v_rcp_f32 v70, v70
  v_rcp_f32 v71, v71
  s_waitcnt vmcnt(8) lgkmcnt(0)
  v_mfma_f32_32x32x16_bf16 v[128:143], a[128:131], a[160:163], v[128:143]
  v_xor_b32 v36, 160, v34
  ds_read_b64_tr_b16 a[144:145], v24 offset:4096
  ds_read_b64_tr_b16 a[146:147], v24 offset:5120
  s_add_u32 m0, s52, 0
  s_xor_b32 s54, s56, 1048576
  v_mfma_f32_32x32x16_bf16 v[144:159], a[128:131], a[164:167], v[144:159]
  ds_read_b128 a[168:171], v36 offset:0
  ds_read_b128 a[172:175], v36 offset:32768
  buffer_load_dwordx4 v38, s[20:23], s54 offen offset:0 lds
  v_mul_f32 v72, v72, v64
  v_mul_f32 v73, v73, v65
  v_mfma_f32_32x32x16_bf16 v[160:175], a[132:135], a[160:163], v[160:175]
  ds_read_b64_tr_b16 a[148:149], v25 offset:4096
  ds_read_b64_tr_b16 a[150:151], v25 offset:5120
  v_mul_f32 v74, v74, v66
  v_mul_f32 v75, v75, v67
  v_mul_f32 v76, v76, v68
  v_mfma_f32_32x32x16_bf16 v[176:191], a[132:135], a[164:167], v[176:191]
  ds_read_b64_tr_b16 a[152:153], v26 offset:4096
  ds_read_b64_tr_b16 a[154:155], v26 offset:5120
  buffer_load_dwordx4 v39, s[20:23], s54 offen offset:1024 lds
  v_mul_f32 v77, v77, v69
  v_mul_f32 v78, v78, v70
  v_mfma_f32_32x32x16_bf16 v[192:207], a[136:139], a[160:163], v[192:207]
  ds_read_b64_tr_b16 a[156:157], v27 offset:4096
  ds_read_b64_tr_b16 a[158:159], v27 offset:5120
  v_mul_f32 v79, v79, v71
  v_cvt_pk_bf16_f32 v96, v72, v73
  v_cvt_pk_bf16_f32 v97, v74, v75
  v_mfma_f32_32x32x16_bf16 v[208:223], a[136:139], a[164:167], v[208:223]
  buffer_load_dwordx4 v40, s[20:23], s54 offen offset:2048 lds
  v_cvt_pk_bf16_f32 v98, v76, v77
  v_cvt_pk_bf16_f32 v99, v78, v79
  v_accvgpr_read_b32 v80, a8
  v_accvgpr_read_b32 v81, a9
  v_mfma_f32_32x32x16_bf16 v[224:239], a[140:143], a[160:163], v[224:239]
  v_accvgpr_read_b32 v82, a10
  v_accvgpr_read_b32 v83, a11
  v_accvgpr_read_b32 v84, a12
  v_accvgpr_read_b32 v85, a13
  v_accvgpr_read_b32 v86, a14
  v_mfma_f32_32x32x16_bf16 v[240:255], a[140:143], a[164:167], v[240:255]
  buffer_load_dwordx4 v41, s[20:23], s54 offen offset:3072 lds
  v_accvgpr_read_b32 v87, a15
  v_mul_f32 v80, v80, v8
  v_mul_f32 v81, v81, v8
  v_mul_f32 v82, v82, v8
  s_waitcnt vmcnt(8) lgkmcnt(0)
  v_mfma_f32_32x32x16_bf16 v[128:143], a[144:147], a[168:171], v[128:143]
  v_xor_b32 v36, 192, v34
  ds_read_b64_tr_b16 a[128:129], v24 offset:8192
  ds_read_b64_tr_b16 a[130:131], v24 offset:9216
  s_add_u32 m0, s52, 4096
  s_xor_b32 s54, s56, 1179648
  v_mfma_f32_32x32x16_bf16 v[144:159], a[144:147], a[172:175], v[144:159]
  ds_read_b128 a[160:163], v36 offset:0
  ds_read_b128 a[164:167], v36 offset:32768
  buffer_load_dwordx4 v38, s[20:23], s54 offen offset:0 lds
  v_mul_f32 v83, v83, v8
  v_mul_f32 v84, v84, v8
  v_mfma_f32_32x32x16_bf16 v[160:175], a[148:151], a[168:171], v[160:175]
  ds_read_b64_tr_b16 a[132:133], v25 offset:8192
  ds_read_b64_tr_b16 a[134:135], v25 offset:9216
  v_mul_f32 v85, v85, v8
  v_mul_f32 v86, v86, v8
  v_mul_f32 v87, v87, v8
  v_mfma_f32_32x32x16_bf16 v[176:191], a[148:151], a[172:175], v[176:191]
  ds_read_b64_tr_b16 a[136:137], v26 offset:8192
  ds_read_b64_tr_b16 a[138:139], v26 offset:9216
  buffer_load_dwordx4 v39, s[20:23], s54 offen offset:1024 lds
  v_exp_f32 v80, v80
  v_mfma_f32_32x32x16_bf16 v[192:207], a[152:155], a[168:171], v[192:207]
  ds_read_b64_tr_b16 a[140:141], v27 offset:8192
  ds_read_b64_tr_b16 a[142:143], v27 offset:9216
  v_exp_f32 v81, v81
  v_mfma_f32_32x32x16_bf16 v[208:223], a[152:155], a[172:175], v[208:223]
  buffer_load_dwordx4 v40, s[20:23], s54 offen offset:2048 lds
  v_exp_f32 v82, v82
  v_exp_f32 v83, v83
  v_mfma_f32_32x32x16_bf16 v[224:239], a[156:159], a[168:171], v[224:239]
  v_exp_f32 v84, v84
  v_exp_f32 v85, v85
  v_mfma_f32_32x32x16_bf16 v[240:255], a[156:159], a[172:175], v[240:255]
  buffer_load_dwordx4 v41, s[20:23], s54 offen offset:3072 lds
  v_exp_f32 v86, v86
  v_exp_f32 v87, v87
  s_waitcnt vmcnt(8) lgkmcnt(0)
  v_mfma_f32_32x32x16_bf16 v[128:143], a[128:131], a[160:163], v[128:143]
  v_xor_b32 v36, 224, v34
  ds_read_b64_tr_b16 a[144:145], v24 offset:12288
  ds_read_b64_tr_b16 a[146:147], v24 offset:13312
  s_add_u32 m0, s52, 8192
  s_xor_b32 s54, s56, 1310720
  v_mfma_f32_32x32x16_bf16 v[144:159], a[128:131], a[164:167], v[144:159]
  ds_read_b128 a[168:171], v36 offset:0
  ds_read_b128 a[172:175], v36 offset:32768
  buffer_load_dwordx4 v38, s[20:23], s54 offen offset:0 lds
  v_accvgpr_read_b32 v88, a72
  v_accvgpr_read_b32 v89, a73
  v_mfma_f32_32x32x16_bf16 v[160:175], a[132:135], a[160:163], v[160:175]
  ds_read_b64_tr_b16 a[148:149], v25 offset:12288
  ds_read_b64_tr_b16 a[150:151], v25 offset:13312
  v_accvgpr_read_b32 v90, a74
  v_accvgpr_read_b32 v91, a75
  v_accvgpr_read_b32 v92, a76
  v_mfma_f32_32x32x16_bf16 v[176:191], a[132:135], a[164:167], v[176:191]
  ds_read_b64_tr_b16 a[152:153], v26 offset:12288
  ds_read_b64_tr_b16 a[154:155], v26 offset:13312
  buffer_load_dwordx4 v39, s[20:23], s54 offen offset:1024 lds
  v_accvgpr_read_b32 v93, a77
  v_accvgpr_read_b32 v94, a78
  v_mfma_f32_32x32x16_bf16 v[192:207], a[136:139], a[160:163], v[192:207]
  ds_read_b64_tr_b16 a[156:157], v27 offset:12288
  ds_read_b64_tr_b16 a[158:159], v27 offset:13312
  v_accvgpr_read_b32 v95, a79
  v_fma_f32 v80, v80, v10, v10
  v_fma_f32 v81, v81, v10, v10
  v_mfma_f32_32x32x16_bf16 v[208:223], a[136:139], a[164:167], v[208:223]
  buffer_load_dwordx4 v40, s[20:23], s54 offen offset:2048 lds
  v_fma_f32 v82, v82, v10, v10
  v_fma_f32 v83, v83, v10, v10
  v_fma_f32 v84, v84, v10, v10
  v_fma_f32 v85, v85, v10, v10
  v_mfma_f32_32x32x16_bf16 v[224:239], a[140:143], a[160:163], v[224:239]
  v_fma_f32 v86, v86, v10, v10
  v_fma_f32 v87, v87, v10, v10
  v_rcp_f32 v80, v80
  v_mfma_f32_32x32x16_bf16 v[240:255], a[140:143], a[164:167], v[240:255]
  buffer_load_dwordx4 v41, s[20:23], s54 offen offset:3072 lds
  v_rcp_f32 v81, v81
  v_rcp_f32 v82, v82
  s_waitcnt vmcnt(8) lgkmcnt(0)
  v_mfma_f32_32x32x16_bf16 v[128:143], a[144:147], a[168:171], v[128:143]
  v_xor_b32 v36, 256, v34
  ds_read_b64_tr_b16 a[128:129], v24 offset:0
  ds_read_b64_tr_b16 a[130:131], v24 offset:1024
  s_add_u32 m0, s52, 12288
  s_xor_b32 s54, s56, 1441792
  v_mfma_f32_32x32x16_bf16 v[144:159], a[144:147], a[172:175], v[144:159]
  ds_read_b128 a[160:163], v36 offset:0
  ds_read_b128 a[164:167], v36 offset:32768
  buffer_load_dwordx4 v38, s[20:23], s54 offen offset:0 lds
  v_rcp_f32 v83, v83
  v_mfma_f32_32x32x16_bf16 v[160:175], a[148:151], a[168:171], v[160:175]
  ds_read_b64_tr_b16 a[132:133], v25 offset:0
  ds_read_b64_tr_b16 a[134:135], v25 offset:1024
  v_rcp_f32 v84, v84
  v_mfma_f32_32x32x16_bf16 v[176:191], a[148:151], a[172:175], v[176:191]
  ds_read_b64_tr_b16 a[136:137], v26 offset:0
  ds_read_b64_tr_b16 a[138:139], v26 offset:1024
  buffer_load_dwordx4 v39, s[20:23], s54 offen offset:1024 lds
  v_rcp_f32 v85, v85
  v_mfma_f32_32x32x16_bf16 v[192:207], a[152:155], a[168:171], v[192:207]
  ds_read_b64_tr_b16 a[140:141], v27 offset:0
  ds_read_b64_tr_b16 a[142:143], v27 offset:1024
  v_rcp_f32 v86, v86
  v_mfma_f32_32x32x16_bf16 v[208:223], a[152:155], a[172:175], v[208:223]
  buffer_load_dwordx4 v40, s[20:23], s54 offen offset:2048 lds
  v_rcp_f32 v87, v87
  v_mul_f32 v88, v88, v80
  v_mul_f32 v89, v89, v81
  v_mfma_f32_32x32x16_bf16 v[224:239], a[156:159], a[168:171], v[224:239]
  v_mul_f32 v90, v90, v82
  v_mul_f32 v91, v91, v83
  v_mul_f32 v92, v92, v84
  v_mul_f32 v93, v93, v85
  v_mul_f32 v94, v94, v86
  v_mfma_f32_32x32x16_bf16 v[240:255], a[156:159], a[172:175], v[240:255]
  buffer_load_dwordx4 v41, s[20:23], s54 offen offset:3072 lds
  v_mul_f32 v95, v95, v87
  v_cvt_pk_bf16_f32 v100, v88, v89
  v_cvt_pk_bf16_f32 v101, v90, v91
  v_cvt_pk_bf16_f32 v102, v92, v93
  s_waitcnt vmcnt(8) lgkmcnt(0)
  v_mfma_f32_32x32x16_bf16 v[128:143], a[128:131], a[160:163], v[128:143]
  v_xor_b32 v36, 288, v34
  ds_read_b64_tr_b16 a[144:145], v24 offset:4096
  ds_read_b64_tr_b16 a[146:147], v24 offset:5120
  s_add_u32 m0, s52, 0
  s_xor_b32 s54, s56, 1572864
  v_mfma_f32_32x32x16_bf16 v[144:159], a[128:131], a[164:167], v[144:159]
  ds_read_b128 a[168:171], v36 offset:0
  ds_read_b128 a[172:175], v36 offset:32768
  buffer_load_dwordx4 v38, s[20:23], s54 offen offset:0 lds
  v_cvt_pk_bf16_f32 v103, v94, v95
  v_accvgpr_read_b32 v64, a16
  v_mfma_f32_32x32x16_bf16 v[160:175], a[132:135], a[160:163], v[160:175]
  ds_read_b64_tr_b16 a[148:149], v25 offset:4096
  ds_read_b64_tr_b16 a[150:151], v25 offset:5120
  v_accvgpr_read_b32 v65, a17
  v_accvgpr_read_b32 v66, a18
  v_accvgpr_read_b32 v67, a19
  v_mfma_f32_32x32x16_bf16 v[176:191], a[132:135], a[164:167], v[176:191]
  ds_read_b64_tr_b16 a[152:153], v26 offset:4096
  ds_read_b64_tr_b16 a[154:155], v26 offset:5120
  buffer_load_dwordx4 v39, s[20:23], s54 offen offset:1024 lds
  v_accvgpr_read_b32 v68, a20
  v_accvgpr_read_b32 v69, a21
  v_mfma_f32_32x32x16_bf16 v[192:207], a[136:139], a[160:163], v[192:207]
  ds_read_b64_tr_b16 a[156:157], v27 offset:4096
  ds_read_b64_tr_b16 a[158:159], v27 offset:5120
  v_accvgpr_read_b32 v70, a22
  v_accvgpr_read_b32 v71, a23
  v_mul_f32 v64, v64, v9
  v_mfma_f32_32x32x16_bf16 v[208:223], a[136:139], a[164:167], v[208:223]
  buffer_load_dwordx4 v40, s[20:23], s54 offen offset:2048 lds
  v_mul_f32 v65, v65, v9
  v_mul_f32 v66, v66, v9
  v_mul_f32 v67, v67, v9
  v_mul_f32 v68, v68, v9
  v_mfma_f32_32x32x16_bf16 v[224:239], a[140:143], a[160:163], v[224:239]
  v_mul_f32 v69, v69, v9
  v_mul_f32 v70, v70, v9
  v_mul_f32 v71, v71, v9
  v_exp_f32 v64, v64
  v_mfma_f32_32x32x16_bf16 v[240:255], a[140:143], a[164:167], v[240:255]
  buffer_load_dwordx4 v41, s[20:23], s54 offen offset:3072 lds
  v_exp_f32 v65, v65
  v_exp_f32 v66, v66
  s_waitcnt vmcnt(8) lgkmcnt(0)
  v_mfma_f32_32x32x16_bf16 v[128:143], a[144:147], a[168:171], v[128:143]
  v_xor_b32 v36, 320, v34
  ds_read_b64_tr_b16 a[128:129], v24 offset:8192
  ds_read_b64_tr_b16 a[130:131], v24 offset:9216
  s_add_u32 m0, s52, 4096
  s_xor_b32 s54, s56, 1703936
  v_mfma_f32_32x32x16_bf16 v[144:159], a[144:147], a[172:175], v[144:159]
  ds_read_b128 a[160:163], v36 offset:0
  ds_read_b128 a[164:167], v36 offset:32768
  buffer_load_dwordx4 v38, s[20:23], s54 offen offset:0 lds
  v_exp_f32 v67, v67
  v_mfma_f32_32x32x16_bf16 v[160:175], a[148:151], a[168:171], v[160:175]
  ds_read_b64_tr_b16 a[132:133], v25 offset:8192
  ds_read_b64_tr_b16 a[134:135], v25 offset:9216
  v_exp_f32 v68, v68
  v_mfma_f32_32x32x16_bf16 v[176:191], a[148:151], a[172:175], v[176:191]
  ds_read_b64_tr_b16 a[136:137], v26 offset:8192
  ds_read_b64_tr_b16 a[138:139], v26 offset:9216
  buffer_load_dwordx4 v39, s[20:23], s54 offen offset:1024 lds
  v_exp_f32 v69, v69
  v_mfma_f32_32x32x16_bf16 v[192:207], a[152:155], a[168:171], v[192:207]
  ds_read_b64_tr_b16 a[140:141], v27 offset:8192
  ds_read_b64_tr_b16 a[142:143], v27 offset:9216
  v_exp_f32 v70, v70
  v_mfma_f32_32x32x16_bf16 v[208:223], a[152:155], a[172:175], v[208:223]
  buffer_load_dwordx4 v40, s[20:23], s54 offen offset:2048 lds
  v_exp_f32 v71, v71
  v_accvgpr_read_b32 v72, a80
  v_accvgpr_read_b32 v73, a81
  v_mfma_f32_32x32x16_bf16 v[224:239], a[156:159], a[168:171], v[224:239]
  v_accvgpr_read_b32 v74, a82
  v_accvgpr_read_b32 v75, a83
  v_accvgpr_read_b32 v76, a84
  v_accvgpr_read_b32 v77, a85
  v_accvgpr_read_b32 v78, a86
  v_mfma_f32_32x32x16_bf16 v[240:255], a[156:159], a[172:175], v[240:255]
  buffer_load_dwordx4 v41, s[20:23], s54 offen offset:3072 lds
  v_accvgpr_read_b32 v79, a87
  v_fma_f32 v64, v64, v11, v11
  v_fma_f32 v65, v65, v11, v11
  v_fma_f32 v66, v66, v11, v11
  s_waitcnt vmcnt(8) lgkmcnt(0)
  v_mfma_f32_32x32x16_bf16 v[128:143], a[128:131], a[160:163], v[128:143]
  v_xor_b32 v36, 352, v34
  ds_read_b64_tr_b16 a[144:145], v24 offset:12288
  ds_read_b64_tr_b16 a[146:147], v24 offset:13312
  s_add_u32 m0, s52, 8192
  s_xor_b32 s54, s56, 1835008
  v_mfma_f32_32x32x16_bf16 v[144:159], a[128:131], a[164:167], v[144:159]
  ds_read_b128 a[168:171], v36 offset:0
  ds_read_b128 a[172:175], v36 offset:32768
  buffer_load_dwordx4 v38, s[20:23], s54 offen offset:0 lds
  v_fma_f32 v67, v67, v11, v11
  v_fma_f32 v68, v68, v11, v11
  v_mfma_f32_32x32x16_bf16 v[160:175], a[132:135], a[160:163], v[160:175]
  ds_read_b64_tr_b16 a[148:149], v25 offset:12288
  ds_read_b64_tr_b16 a[150:151], v25 offset:13312
  v_fma_f32 v69, v69, v11, v11
  v_fma_f32 v70, v70, v11, v11
  v_fma_f32 v71, v71, v11, v11
  v_mfma_f32_32x32x16_bf16 v[176:191], a[132:135], a[164:167], v[176:191]
  ds_read_b64_tr_b16 a[152:153], v26 offset:12288
  ds_read_b64_tr_b16 a[154:155], v26 offset:13312
  buffer_load_dwordx4 v39, s[20:23], s54 offen offset:1024 lds
  v_rcp_f32 v64, v64
  v_mfma_f32_32x32x16_bf16 v[192:207], a[136:139], a[160:163], v[192:207]
  ds_read_b64_tr_b16 a[156:157], v27 offset:12288
  ds_read_b64_tr_b16 a[158:159], v27 offset:13312
  v_rcp_f32 v65, v65
  v_mfma_f32_32x32x16_bf16 v[208:223], a[136:139], a[164:167], v[208:223]
  buffer_load_dwordx4 v40, s[20:23], s54 offen offset:2048 lds
  v_rcp_f32 v66, v66
  v_rcp_f32 v67, v67
  v_mfma_f32_32x32x16_bf16 v[224:239], a[140:143], a[160:163], v[224:239]
  v_rcp_f32 v68, v68
  v_rcp_f32 v69, v69
  v_mfma_f32_32x32x16_bf16 v[240:255], a[140:143], a[164:167], v[240:255]
  buffer_load_dwordx4 v41, s[20:23], s54 offen offset:3072 lds
  v_rcp_f32 v70, v70
  v_rcp_f32 v71, v71
  s_waitcnt vmcnt(8) lgkmcnt(0)
  v_mfma_f32_32x32x16_bf16 v[128:143], a[144:147], a[168:171], v[128:143]
  v_xor_b32 v36, 384, v34
  ds_read_b64_tr_b16 a[128:129], v24 offset:0
  ds_read_b64_tr_b16 a[130:131], v24 offset:1024
  s_add_u32 m0, s52, 12288
  s_xor_b32 s54, s56, 1966080
  v_mfma_f32_32x32x16_bf16 v[144:159], a[144:147], a[172:175], v[144:159]
  ds_read_b128 a[160:163], v36 offset:0
  ds_read_b128 a[164:167], v36 offset:32768
  buffer_load_dwordx4 v38, s[20:23], s54 offen offset:0 lds
  v_mul_f32 v72, v72, v64
  v_mul_f32 v73, v73, v65
  v_mfma_f32_32x32x16_bf16 v[160:175], a[148:151], a[168:171], v[160:175]
  ds_read_b64_tr_b16 a[132:133], v25 offset:0
  ds_read_b64_tr_b16 a[134:135], v25 offset:1024
  v_mul_f32 v74, v74, v66
  v_mul_f32 v75, v75, v67
  v_mul_f32 v76, v76, v68
  v_mfma_f32_32x32x16_bf16 v[176:191], a[148:151], a[172:175], v[176:191]
  ds_read_b64_tr_b16 a[136:137], v26 offset:0
  ds_read_b64_tr_b16 a[138:139], v26 offset:1024
  buffer_load_dwordx4 v39, s[20:23], s54 offen offset:1024 lds
  v_mul_f32 v77, v77, v69
  v_mul_f32 v78, v78, v70
  v_mfma_f32_32x32x16_bf16 v[192:207], a[152:155], a[168:171], v[192:207]
  ds_read_b64_tr_b16 a[140:141], v27 offset:0
  ds_read_b64_tr_b16 a[142:143], v27 offset:1024
  v_mul_f32 v79, v79, v71
  v_cvt_pk_bf16_f32 v104, v72, v73
  v_cvt_pk_bf16_f32 v105, v74, v75
  v_mfma_f32_32x32x16_bf16 v[208:223], a[152:155], a[172:175], v[208:223]
  buffer_load_dwordx4 v40, s[20:23], s54 offen offset:2048 lds
  v_cvt_pk_bf16_f32 v106, v76, v77
  v_cvt_pk_bf16_f32 v107, v78, v79
  v_accvgpr_read_b32 v80, a24
  v_accvgpr_read_b32 v81, a25
  v_mfma_f32_32x32x16_bf16 v[224:239], a[156:159], a[168:171], v[224:239]
  v_accvgpr_read_b32 v82, a26
  v_accvgpr_read_b32 v83, a27
  v_accvgpr_read_b32 v84, a28
  v_accvgpr_read_b32 v85, a29
  v_accvgpr_read_b32 v86, a30
  v_mfma_f32_32x32x16_bf16 v[240:255], a[156:159], a[172:175], v[240:255]
  buffer_load_dwordx4 v41, s[20:23], s54 offen offset:3072 lds
  v_accvgpr_read_b32 v87, a31
  v_mul_f32 v80, v80, v9
  v_mul_f32 v81, v81, v9
  v_mul_f32 v82, v82, v9
  s_waitcnt vmcnt(8) lgkmcnt(0)
  v_mfma_f32_32x32x16_bf16 v[128:143], a[128:131], a[160:163], v[128:143]
  v_xor_b32 v36, 416, v34
  ds_read_b64_tr_b16 a[144:145], v24 offset:4096
  ds_read_b64_tr_b16 a[146:147], v24 offset:5120
  s_add_u32 m0, s52, 0
  s_xor_b32 s54, s56, 2097152
  v_mfma_f32_32x32x16_bf16 v[144:159], a[128:131], a[164:167], v[144:159]
  ds_read_b128 a[168:171], v36 offset:0
  ds_read_b128 a[172:175], v36 offset:32768
  buffer_load_dwordx4 v38, s[20:23], s54 offen offset:0 lds
  v_mul_f32 v83, v83, v9
  v_mul_f32 v84, v84, v9
  v_mfma_f32_32x32x16_bf16 v[160:175], a[132:135], a[160:163], v[160:175]
  ds_read_b64_tr_b16 a[148:149], v25 offset:4096
  ds_read_b64_tr_b16 a[150:151], v25 offset:5120
  v_mul_f32 v85, v85, v9
  v_mul_f32 v86, v86, v9
  v_mul_f32 v87, v87, v9
  v_mfma_f32_32x32x16_bf16 v[176:191], a[132:135], a[164:167], v[176:191]
  ds_read_b64_tr_b16 a[152:153], v26 offset:4096
  ds_read_b64_tr_b16 a[154:155], v26 offset:5120
  buffer_load_dwordx4 v39, s[20:23], s54 offen offset:1024 lds
  v_exp_f32 v80, v80
  v_mfma_f32_32x32x16_bf16 v[192:207], a[136:139], a[160:163], v[192:207]
  ds_read_b64_tr_b16 a[156:157], v27 offset:4096
  ds_read_b64_tr_b16 a[158:159], v27 offset:5120
  v_exp_f32 v81, v81
  v_mfma_f32_32x32x16_bf16 v[208:223], a[136:139], a[164:167], v[208:223]
  buffer_load_dwordx4 v40, s[20:23], s54 offen offset:2048 lds
  v_exp_f32 v82, v82
  v_exp_f32 v83, v83
  v_mfma_f32_32x32x16_bf16 v[224:239], a[140:143], a[160:163], v[224:239]
  v_exp_f32 v84, v84
  v_exp_f32 v85, v85
  v_mfma_f32_32x32x16_bf16 v[240:255], a[140:143], a[164:167], v[240:255]
  buffer_load_dwordx4 v41, s[20:23], s54 offen offset:3072 lds
  v_exp_f32 v86, v86
  v_exp_f32 v87, v87
  s_waitcnt vmcnt(8) lgkmcnt(0)
  v_mfma_f32_32x32x16_bf16 v[128:143], a[144:147], a[168:171], v[128:143]
  v_xor_b32 v36, 448, v34
  ds_read_b64_tr_b16 a[128:129], v24 offset:8192
  ds_read_b64_tr_b16 a[130:131], v24 offset:9216
  s_add_u32 m0, s52, 4096
  s_xor_b32 s54, s56, 2228224
  v_mfma_f32_32x32x16_bf16 v[144:159], a[144:147], a[172:175], v[144:159]
  ds_read_b128 a[160:163], v36 offset:0
  ds_read_b128 a[164:167], v36 offset:32768
  buffer_load_dwordx4 v38, s[20:23], s54 offen offset:0 lds
  v_accvgpr_read_b32 v88, a88
  v_accvgpr_read_b32 v89, a89
  v_mfma_f32_32x32x16_bf16 v[160:175], a[148:151], a[168:171], v[160:175]
  ds_read_b64_tr_b16 a[132:133], v25 offset:8192
  ds_read_b64_tr_b16 a[134:135], v25 offset:9216
  v_accvgpr_read_b32 v90, a90
  v_accvgpr_read_b32 v91, a91
  v_accvgpr_read_b32 v92, a92
  v_mfma_f32_32x32x16_bf16 v[176:191], a[148:151], a[172:175], v[176:191]
  ds_read_b64_tr_b16 a[136:137], v26 offset:8192
  ds_read_b64_tr_b16 a[138:139], v26 offset:9216
  buffer_load_dwordx4 v39, s[20:23], s54 offen offset:1024 lds
  v_accvgpr_read_b32 v93, a93
  v_accvgpr_read_b32 v94, a94
  v_mfma_f32_32x32x16_bf16 v[192:207], a[152:155], a[168:171], v[192:207]
  ds_read_b64_tr_b16 a[140:141], v27 offset:8192
  ds_read_b64_tr_b16 a[142:143], v27 offset:9216
  v_accvgpr_read_b32 v95, a95
  v_fma_f32 v80, v80, v11, v11
  v_fma_f32 v81, v81, v11, v11
  v_mfma_f32_32x32x16_bf16 v[208:223], a[152:155], a[172:175], v[208:223]
  buffer_load_dwordx4 v40, s[20:23], s54 offen offset:2048 lds
  v_fma_f32 v82, v82, v11, v11
  v_fma_f32 v83, v83, v11, v11
  v_fma_f32 v84, v84, v11, v11
  v_fma_f32 v85, v85, v11, v11
  v_mfma_f32_32x32x16_bf16 v[224:239], a[156:159], a[168:171], v[224:239]
  v_fma_f32 v86, v86, v11, v11
  v_fma_f32 v87, v87, v11, v11
  v_rcp_f32 v80, v80
  v_mfma_f32_32x32x16_bf16 v[240:255], a[156:159], a[172:175], v[240:255]
  buffer_load_dwordx4 v41, s[20:23], s54 offen offset:3072 lds
  v_rcp_f32 v81, v81
  v_rcp_f32 v82, v82
  s_waitcnt vmcnt(8) lgkmcnt(0)
  v_mfma_f32_32x32x16_bf16 v[128:143], a[128:131], a[160:163], v[128:143]
  v_xor_b32 v36, 480, v34
  ds_read_b64_tr_b16 a[144:145], v24 offset:12288
  ds_read_b64_tr_b16 a[146:147], v24 offset:13312
  s_add_u32 m0, s52, 8192
  s_xor_b32 s54, s56, 2359296
  v_mfma_f32_32x32x16_bf16 v[144:159], a[128:131], a[164:167], v[144:159]
  ds_read_b128 a[168:171], v36 offset:0
  ds_read_b128 a[172:175], v36 offset:32768
  buffer_load_dwordx4 v38, s[20:23], s54 offen offset:0 lds
  v_rcp_f32 v83, v83
  v_mfma_f32_32x32x16_bf16 v[160:175], a[132:135], a[160:163], v[160:175]
  ds_read_b64_tr_b16 a[148:149], v25 offset:12288
  ds_read_b64_tr_b16 a[150:151], v25 offset:13312
  v_rcp_f32 v84, v84
  v_mfma_f32_32x32x16_bf16 v[176:191], a[132:135], a[164:167], v[176:191]
  ds_read_b64_tr_b16 a[152:153], v26 offset:12288
  ds_read_b64_tr_b16 a[154:155], v26 offset:13312
  buffer_load_dwordx4 v39, s[20:23], s54 offen offset:1024 lds
  v_rcp_f32 v85, v85
  v_mfma_f32_32x32x16_bf16 v[192:207], a[136:139], a[160:163], v[192:207]
  ds_read_b64_tr_b16 a[156:157], v27 offset:12288
  ds_read_b64_tr_b16 a[158:159], v27 offset:13312
  v_rcp_f32 v86, v86
  v_mfma_f32_32x32x16_bf16 v[208:223], a[136:139], a[164:167], v[208:223]
  buffer_load_dwordx4 v40, s[20:23], s54 offen offset:2048 lds
  v_rcp_f32 v87, v87
  v_mul_f32 v88, v88, v80
  v_mul_f32 v89, v89, v81
  v_mfma_f32_32x32x16_bf16 v[224:239], a[140:143], a[160:163], v[224:239]
  v_mul_f32 v90, v90, v82
  v_mul_f32 v91, v91, v83
  v_mul_f32 v92, v92, v84
  v_mul_f32 v93, v93, v85
  v_mul_f32 v94, v94, v86
  v_mfma_f32_32x32x16_bf16 v[240:255], a[140:143], a[164:167], v[240:255]
  buffer_load_dwordx4 v41, s[20:23], s54 offen offset:3072 lds
  v_mul_f32 v95, v95, v87
  v_cvt_pk_bf16_f32 v108, v88, v89
  v_cvt_pk_bf16_f32 v109, v90, v91
  v_cvt_pk_bf16_f32 v110, v92, v93
  s_waitcnt vmcnt(8) lgkmcnt(0)
  v_mfma_f32_32x32x16_bf16 v[128:143], a[144:147], a[168:171], v[128:143]
  v_xor_b32 v36, 512, v34
  ds_read_b64_tr_b16 a[128:129], v24 offset:0
  ds_read_b64_tr_b16 a[130:131], v24 offset:1024
  s_add_u32 m0, s52, 12288
  s_xor_b32 s54, s56, 2490368
  v_mfma_f32_32x32x16_bf16 v[144:159], a[144:147], a[172:175], v[144:159]
  ds_read_b128 a[160:163], v36 offset:0
  ds_read_b128 a[164:167], v36 offset:32768
  buffer_load_dwordx4 v38, s[20:23], s54 offen offset:0 lds
  v_cvt_pk_bf16_f32 v111, v94, v95
  v_accvgpr_read_b32 v64, a32
  v_mfma_f32_32x32x16_bf16 v[160:175], a[148:151], a[168:171], v[160:175]
  ds_read_b64_tr_b16 a[132:133], v25 offset:0
  ds_read_b64_tr_b16 a[134:135], v25 offset:1024
  v_accvgpr_read_b32 v65, a33
  v_accvgpr_read_b32 v66, a34
  v_accvgpr_read_b32 v67, a35
  v_mfma_f32_32x32x16_bf16 v[176:191], a[148:151], a[172:175], v[176:191]
  ds_read_b64_tr_b16 a[136:137], v26 offset:0
  ds_read_b64_tr_b16 a[138:139], v26 offset:1024
  buffer_load_dwordx4 v39, s[20:23], s54 offen offset:1024 lds
  v_accvgpr_read_b32 v68, a36
  v_accvgpr_read_b32 v69, a37
  v_mfma_f32_32x32x16_bf16 v[192:207], a[152:155], a[168:171], v[192:207]
  ds_read_b64_tr_b16 a[140:141], v27 offset:0
  ds_read_b64_tr_b16 a[142:143], v27 offset:1024
  v_accvgpr_read_b32 v70, a38
  v_accvgpr_read_b32 v71, a39
  v_mul_f32 v64, v64, v8
  v_mfma_f32_32x32x16_bf16 v[208:223], a[152:155], a[172:175], v[208:223]
  buffer_load_dwordx4 v40, s[20:23], s54 offen offset:2048 lds
  v_mul_f32 v65, v65, v8
  v_mul_f32 v66, v66, v8
  v_mul_f32 v67, v67, v8
  v_mul_f32 v68, v68, v8
  v_mfma_f32_32x32x16_bf16 v[224:239], a[156:159], a[168:171], v[224:239]
  v_mul_f32 v69, v69, v8
  v_mul_f32 v70, v70, v8
  v_mul_f32 v71, v71, v8
  v_exp_f32 v64, v64
  v_mfma_f32_32x32x16_bf16 v[240:255], a[156:159], a[172:175], v[240:255]
  buffer_load_dwordx4 v41, s[20:23], s54 offen offset:3072 lds
  v_exp_f32 v65, v65
  v_exp_f32 v66, v66
  s_waitcnt vmcnt(8) lgkmcnt(0)
  v_mfma_f32_32x32x16_bf16 v[128:143], a[128:131], a[160:163], v[128:143]
  v_xor_b32 v36, 544, v34
  ds_read_b64_tr_b16 a[144:145], v24 offset:4096
  ds_read_b64_tr_b16 a[146:147], v24 offset:5120
  s_add_u32 m0, s52, 0
  s_xor_b32 s54, s56, 2621440
  v_mfma_f32_32x32x16_bf16 v[144:159], a[128:131], a[164:167], v[144:159]
  ds_read_b128 a[168:171], v36 offset:0
  ds_read_b128 a[172:175], v36 offset:32768
  buffer_load_dwordx4 v38, s[20:23], s54 offen offset:0 lds
  v_exp_f32 v67, v67
  v_mfma_f32_32x32x16_bf16 v[160:175], a[132:135], a[160:163], v[160:175]
  ds_read_b64_tr_b16 a[148:149], v25 offset:4096
  ds_read_b64_tr_b16 a[150:151], v25 offset:5120
  v_exp_f32 v68, v68
  v_mfma_f32_32x32x16_bf16 v[176:191], a[132:135], a[164:167], v[176:191]
  ds_read_b64_tr_b16 a[152:153], v26 offset:4096
  ds_read_b64_tr_b16 a[154:155], v26 offset:5120
  buffer_load_dwordx4 v39, s[20:23], s54 offen offset:1024 lds
  v_exp_f32 v69, v69
  v_mfma_f32_32x32x16_bf16 v[192:207], a[136:139], a[160:163], v[192:207]
  ds_read_b64_tr_b16 a[156:157], v27 offset:4096
  ds_read_b64_tr_b16 a[158:159], v27 offset:5120
  v_exp_f32 v70, v70
  v_mfma_f32_32x32x16_bf16 v[208:223], a[136:139], a[164:167], v[208:223]
  buffer_load_dwordx4 v40, s[20:23], s54 offen offset:2048 lds
  v_exp_f32 v71, v71
  v_accvgpr_read_b32 v72, a96
  v_accvgpr_read_b32 v73, a97
  v_mfma_f32_32x32x16_bf16 v[224:239], a[140:143], a[160:163], v[224:239]
  v_accvgpr_read_b32 v74, a98
  v_accvgpr_read_b32 v75, a99
  v_accvgpr_read_b32 v76, a100
  v_accvgpr_read_b32 v77, a101
  v_accvgpr_read_b32 v78, a102
  v_mfma_f32_32x32x16_bf16 v[240:255], a[140:143], a[164:167], v[240:255]
  buffer_load_dwordx4 v41, s[20:23], s54 offen offset:3072 lds
  v_accvgpr_read_b32 v79, a103
  v_fma_f32 v64, v64, v10, v10
  v_fma_f32 v65, v65, v10, v10
  v_fma_f32 v66, v66, v10, v10
  s_waitcnt vmcnt(8) lgkmcnt(0)
  v_mfma_f32_32x32x16_bf16 v[128:143], a[144:147], a[168:171], v[128:143]
  v_xor_b32 v36, 576, v34
  ds_read_b64_tr_b16 a[128:129], v24 offset:8192
  ds_read_b64_tr_b16 a[130:131], v24 offset:9216
  s_add_u32 m0, s52, 4096
  s_xor_b32 s54, s56, 2752512
  v_mfma_f32_32x32x16_bf16 v[144:159], a[144:147], a[172:175], v[144:159]
  ds_read_b128 a[160:163], v36 offset:0
  ds_read_b128 a[164:167], v36 offset:32768
  buffer_load_dwordx4 v38, s[20:23], s54 offen offset:0 lds
  v_fma_f32 v67, v67, v10, v10
  v_fma_f32 v68, v68, v10, v10
  v_mfma_f32_32x32x16_bf16 v[160:175], a[148:151], a[168:171], v[160:175]
  ds_read_b64_tr_b16 a[132:133], v25 offset:8192
  ds_read_b64_tr_b16 a[134:135], v25 offset:9216
  v_fma_f32 v69, v69, v10, v10
  v_fma_f32 v70, v70, v10, v10
  v_fma_f32 v71, v71, v10, v10
  v_mfma_f32_32x32x16_bf16 v[176:191], a[148:151], a[172:175], v[176:191]
  ds_read_b64_tr_b16 a[136:137], v26 offset:8192
  ds_read_b64_tr_b16 a[138:139], v26 offset:9216
  buffer_load_dwordx4 v39, s[20:23], s54 offen offset:1024 lds
  v_rcp_f32 v64, v64
  v_mfma_f32_32x32x16_bf16 v[192:207], a[152:155], a[168:171], v[192:207]
  ds_read_b64_tr_b16 a[140:141], v27 offset:8192
  ds_read_b64_tr_b16 a[142:143], v27 offset:9216
  v_rcp_f32 v65, v65
  v_mfma_f32_32x32x16_bf16 v[208:223], a[152:155], a[172:175], v[208:223]
  buffer_load_dwordx4 v40, s[20:23], s54 offen offset:2048 lds
  v_rcp_f32 v66, v66
  v_rcp_f32 v67, v67
  v_mfma_f32_32x32x16_bf16 v[224:239], a[156:159], a[168:171], v[224:239]
  v_rcp_f32 v68, v68
  v_rcp_f32 v69, v69
  v_mfma_f32_32x32x16_bf16 v[240:255], a[156:159], a[172:175], v[240:255]
  buffer_load_dwordx4 v41, s[20:23], s54 offen offset:3072 lds
  v_rcp_f32 v70, v70
  v_rcp_f32 v71, v71
  s_waitcnt vmcnt(8) lgkmcnt(0)
  v_mfma_f32_32x32x16_bf16 v[128:143], a[128:131], a[160:163], v[128:143]
  v_xor_b32 v36, 608, v34
  ds_read_b64_tr_b16 a[144:145], v24 offset:12288
  ds_read_b64_tr_b16 a[146:147], v24 offset:13312
  s_add_u32 m0, s52, 8192
  s_xor_b32 s54, s56, 2883584
  v_mfma_f32_32x32x16_bf16 v[144:159], a[128:131], a[164:167], v[144:159]
  ds_read_b128 a[168:171], v36 offset:0
  ds_read_b128 a[172:175], v36 offset:32768
  buffer_load_dwordx4 v38, s[20:23], s54 offen offset:0 lds
  v_mul_f32 v72, v72, v64
  v_mul_f32 v73, v73, v65
  v_mfma_f32_32x32x16_bf16 v[160:175], a[132:135], a[160:163], v[160:175]
  ds_read_b64_tr_b16 a[148:149], v25 offset:12288
  ds_read_b64_tr_b16 a[150:151], v25 offset:13312
  v_mul_f32 v74, v74, v66
  v_mul_f32 v75, v75, v67
  v_mul_f32 v76, v76, v68
  v_mfma_f32_32x32x16_bf16 v[176:191], a[132:135], a[164:167], v[176:191]
  ds_read_b64_tr_b16 a[152:153], v26 offset:12288
  ds_read_b64_tr_b16 a[154:155], v26 offset:13312
  buffer_load_dwordx4 v39, s[20:23], s54 offen offset:1024 lds
  v_mul_f32 v77, v77, v69
  v_mul_f32 v78, v78, v70
  v_mfma_f32_32x32x16_bf16 v[192:207], a[136:139], a[160:163], v[192:207]
  ds_read_b64_tr_b16 a[156:157], v27 offset:12288
  ds_read_b64_tr_b16 a[158:159], v27 offset:13312
  v_mul_f32 v79, v79, v71
  v_cvt_pk_bf16_f32 v112, v72, v73
  v_cvt_pk_bf16_f32 v113, v74, v75
  v_mfma_f32_32x32x16_bf16 v[208:223], a[136:139], a[164:167], v[208:223]
  buffer_load_dwordx4 v40, s[20:23], s54 offen offset:2048 lds
  v_cvt_pk_bf16_f32 v114, v76, v77
  v_cvt_pk_bf16_f32 v115, v78, v79
  v_accvgpr_read_b32 v80, a40
  v_accvgpr_read_b32 v81, a41
  v_mfma_f32_32x32x16_bf16 v[224:239], a[140:143], a[160:163], v[224:239]
  v_accvgpr_read_b32 v82, a42
  v_accvgpr_read_b32 v83, a43
  v_accvgpr_read_b32 v84, a44
  v_accvgpr_read_b32 v85, a45
  v_accvgpr_read_b32 v86, a46
  v_mfma_f32_32x32x16_bf16 v[240:255], a[140:143], a[164:167], v[240:255]
  buffer_load_dwordx4 v41, s[20:23], s54 offen offset:3072 lds
  v_accvgpr_read_b32 v87, a47
  v_mul_f32 v80, v80, v8
  v_mul_f32 v81, v81, v8
  v_mul_f32 v82, v82, v8
  s_waitcnt vmcnt(8) lgkmcnt(0)
  v_mfma_f32_32x32x16_bf16 v[128:143], a[144:147], a[168:171], v[128:143]
  v_xor_b32 v36, 640, v34
  ds_read_b64_tr_b16 a[128:129], v24 offset:0
  ds_read_b64_tr_b16 a[130:131], v24 offset:1024
  s_add_u32 m0, s52, 12288
  s_xor_b32 s54, s56, 3014656
  v_mfma_f32_32x32x16_bf16 v[144:159], a[144:147], a[172:175], v[144:159]
  ds_read_b128 a[160:163], v36 offset:0
  ds_read_b128 a[164:167], v36 offset:32768
  buffer_load_dwordx4 v38, s[20:23], s54 offen offset:0 lds
  v_mul_f32 v83, v83, v8
  v_mul_f32 v84, v84, v8
  v_mfma_f32_32x32x16_bf16 v[160:175], a[148:151], a[168:171], v[160:175]
  ds_read_b64_tr_b16 a[132:133], v25 offset:0
  ds_read_b64_tr_b16 a[134:135], v25 offset:1024
  v_mul_f32 v85, v85, v8
  v_mul_f32 v86, v86, v8
  v_mul_f32 v87, v87, v8
  v_mfma_f32_32x32x16_bf16 v[176:191], a[148:151], a[172:175], v[176:191]
  ds_read_b64_tr_b16 a[136:137], v26 offset:0
  ds_read_b64_tr_b16 a[138:139], v26 offset:1024
  buffer_load_dwordx4 v39, s[20:23], s54 offen offset:1024 lds
  v_exp_f32 v80, v80
  v_mfma_f32_32x32x16_bf16 v[192:207], a[152:155], a[168:171], v[192:207]
  ds_read_b64_tr_b16 a[140:141], v27 offset:0
  ds_read_b64_tr_b16 a[142:143], v27 offset:1024
  v_exp_f32 v81, v81
  v_mfma_f32_32x32x16_bf16 v[208:223], a[152:155], a[172:175], v[208:223]
  buffer_load_dwordx4 v40, s[20:23], s54 offen offset:2048 lds
  v_exp_f32 v82, v82
  v_exp_f32 v83, v83
  v_mfma_f32_32x32x16_bf16 v[224:239], a[156:159], a[168:171], v[224:239]
  v_exp_f32 v84, v84
  v_exp_f32 v85, v85
  v_mfma_f32_32x32x16_bf16 v[240:255], a[156:159], a[172:175], v[240:255]
  buffer_load_dwordx4 v41, s[20:23], s54 offen offset:3072 lds
  v_exp_f32 v86, v86
  v_exp_f32 v87, v87
  s_waitcnt vmcnt(8) lgkmcnt(0)
  v_mfma_f32_32x32x16_bf16 v[128:143], a[128:131], a[160:163], v[128:143]
  v_xor_b32 v36, 672, v34
  ds_read_b64_tr_b16 a[144:145], v24 offset:4096
  ds_read_b64_tr_b16 a[146:147], v24 offset:5120
  s_add_u32 m0, s52, 0
  s_xor_b32 s54, s56, 3145728
  v_mfma_f32_32x32x16_bf16 v[144:159], a[128:131], a[164:167], v[144:159]
  ds_read_b128 a[168:171], v36 offset:0
  ds_read_b128 a[172:175], v36 offset:32768
  buffer_load_dwordx4 v38, s[20:23], s54 offen offset:0 lds
  v_accvgpr_read_b32 v88, a104
  v_accvgpr_read_b32 v89, a105
  v_mfma_f32_32x32x16_bf16 v[160:175], a[132:135], a[160:163], v[160:175]
  ds_read_b64_tr_b16 a[148:149], v25 offset:4096
  ds_read_b64_tr_b16 a[150:151], v25 offset:5120
  v_accvgpr_read_b32 v90, a106
  v_accvgpr_read_b32 v91, a107
  v_accvgpr_read_b32 v92, a108
  v_mfma_f32_32x32x16_bf16 v[176:191], a[132:135], a[164:167], v[176:191]
  ds_read_b64_tr_b16 a[152:153], v26 offset:4096
  ds_read_b64_tr_b16 a[154:155], v26 offset:5120
  buffer_load_dwordx4 v39, s[20:23], s54 offen offset:1024 lds
  v_accvgpr_read_b32 v93, a109
  v_accvgpr_read_b32 v94, a110
  v_mfma_f32_32x32x16_bf16 v[192:207], a[136:139], a[160:163], v[192:207]
  ds_read_b64_tr_b16 a[156:157], v27 offset:4096
  ds_read_b64_tr_b16 a[158:159], v27 offset:5120
  v_accvgpr_read_b32 v95, a111
  v_fma_f32 v80, v80, v10, v10
  v_fma_f32 v81, v81, v10, v10
  v_mfma_f32_32x32x16_bf16 v[208:223], a[136:139], a[164:167], v[208:223]
  buffer_load_dwordx4 v40, s[20:23], s54 offen offset:2048 lds
  v_fma_f32 v82, v82, v10, v10
  v_fma_f32 v83, v83, v10, v10
  v_fma_f32 v84, v84, v10, v10
  v_fma_f32 v85, v85, v10, v10
  v_mfma_f32_32x32x16_bf16 v[224:239], a[140:143], a[160:163], v[224:239]
  v_fma_f32 v86, v86, v10, v10
  v_fma_f32 v87, v87, v10, v10
  v_rcp_f32 v80, v80
  v_mfma_f32_32x32x16_bf16 v[240:255], a[140:143], a[164:167], v[240:255]
  buffer_load_dwordx4 v41, s[20:23], s54 offen offset:3072 lds
  v_rcp_f32 v81, v81
  v_rcp_f32 v82, v82
  s_waitcnt vmcnt(8) lgkmcnt(0)
  v_mfma_f32_32x32x16_bf16 v[128:143], a[144:147], a[168:171], v[128:143]
  v_xor_b32 v36, 704, v34
  ds_read_b64_tr_b16 a[128:129], v24 offset:8192
  ds_read_b64_tr_b16 a[130:131], v24 offset:9216
  s_add_u32 m0, s52, 4096
  s_xor_b32 s54, s56, 3276800
  v_mfma_f32_32x32x16_bf16 v[144:159], a[144:147], a[172:175], v[144:159]
  ds_read_b128 a[160:163], v36 offset:0
  ds_read_b128 a[164:167], v36 offset:32768
  buffer_load_dwordx4 v38, s[20:23], s54 offen offset:0 lds
  v_rcp_f32 v83, v83
  v_mfma_f32_32x32x16_bf16 v[160:175], a[148:151], a[168:171], v[160:175]
  ds_read_b64_tr_b16 a[132:133], v25 offset:8192
  ds_read_b64_tr_b16 a[134:135], v25 offset:9216
  v_rcp_f32 v84, v84
  v_mfma_f32_32x32x16_bf16 v[176:191], a[148:151], a[172:175], v[176:191]
  ds_read_b64_tr_b16 a[136:137], v26 offset:8192
  ds_read_b64_tr_b16 a[138:139], v26 offset:9216
  buffer_load_dwordx4 v39, s[20:23], s54 offen offset:1024 lds
  v_rcp_f32 v85, v85
  v_mfma_f32_32x32x16_bf16 v[192:207], a[152:155], a[168:171], v[192:207]
  ds_read_b64_tr_b16 a[140:141], v27 offset:8192
  ds_read_b64_tr_b16 a[142:143], v27 offset:9216
  v_rcp_f32 v86, v86
  v_mfma_f32_32x32x16_bf16 v[208:223], a[152:155], a[172:175], v[208:223]
  buffer_load_dwordx4 v40, s[20:23], s54 offen offset:2048 lds
  v_rcp_f32 v87, v87
  v_mul_f32 v88, v88, v80
  v_mul_f32 v89, v89, v81
  v_mfma_f32_32x32x16_bf16 v[224:239], a[156:159], a[168:171], v[224:239]
  v_mul_f32 v90, v90, v82
  v_mul_f32 v91, v91, v83
  v_mul_f32 v92, v92, v84
  v_mul_f32 v93, v93, v85
  v_mul_f32 v94, v94, v86
  v_mfma_f32_32x32x16_bf16 v[240:255], a[156:159], a[172:175], v[240:255]
  buffer_load_dwordx4 v41, s[20:23], s54 offen offset:3072 lds
  v_mul_f32 v95, v95, v87
  v_cvt_pk_bf16_f32 v116, v88, v89
  v_cvt_pk_bf16_f32 v117, v90, v91
  v_cvt_pk_bf16_f32 v118, v92, v93
  s_waitcnt vmcnt(8) lgkmcnt(0)
  v_mfma_f32_32x32x16_bf16 v[128:143], a[128:131], a[160:163], v[128:143]
  v_xor_b32 v36, 736, v34
  ds_read_b64_tr_b16 a[144:145], v24 offset:12288
  ds_read_b64_tr_b16 a[146:147], v24 offset:13312
  s_add_u32 m0, s52, 8192
  s_xor_b32 s54, s56, 3407872
  v_mfma_f32_32x32x16_bf16 v[144:159], a[128:131], a[164:167], v[144:159]
  ds_read_b128 a[168:171], v36 offset:0
  ds_read_b128 a[172:175], v36 offset:32768
  buffer_load_dwordx4 v38, s[20:23], s54 offen offset:0 lds
  v_cvt_pk_bf16_f32 v119, v94, v95
  v_accvgpr_read_b32 v64, a48
  v_mfma_f32_32x32x16_bf16 v[160:175], a[132:135], a[160:163], v[160:175]
  ds_read_b64_tr_b16 a[148:149], v25 offset:12288
  ds_read_b64_tr_b16 a[150:151], v25 offset:13312
  v_accvgpr_read_b32 v65, a49
  v_accvgpr_read_b32 v66, a50
  v_accvgpr_read_b32 v67, a51
  v_mfma_f32_32x32x16_bf16 v[176:191], a[132:135], a[164:167], v[176:191]
  ds_read_b64_tr_b16 a[152:153], v26 offset:12288
  ds_read_b64_tr_b16 a[154:155], v26 offset:13312
  buffer_load_dwordx4 v39, s[20:23], s54 offen offset:1024 lds
  v_accvgpr_read_b32 v68, a52
  v_accvgpr_read_b32 v69, a53
  v_mfma_f32_32x32x16_bf16 v[192:207], a[136:139], a[160:163], v[192:207]
  ds_read_b64_tr_b16 a[156:157], v27 offset:12288
  ds_read_b64_tr_b16 a[158:159], v27 offset:13312
  v_accvgpr_read_b32 v70, a54
  v_accvgpr_read_b32 v71, a55
  v_mul_f32 v64, v64, v9
  v_mfma_f32_32x32x16_bf16 v[208:223], a[136:139], a[164:167], v[208:223]
  buffer_load_dwordx4 v40, s[20:23], s54 offen offset:2048 lds
  v_mul_f32 v65, v65, v9
  v_mul_f32 v66, v66, v9
  v_mul_f32 v67, v67, v9
  v_mul_f32 v68, v68, v9
  v_mfma_f32_32x32x16_bf16 v[224:239], a[140:143], a[160:163], v[224:239]
  v_mul_f32 v69, v69, v9
  v_mul_f32 v70, v70, v9
  v_mul_f32 v71, v71, v9
  v_exp_f32 v64, v64
  v_mfma_f32_32x32x16_bf16 v[240:255], a[140:143], a[164:167], v[240:255]
  buffer_load_dwordx4 v41, s[20:23], s54 offen offset:3072 lds
  v_exp_f32 v65, v65
  v_exp_f32 v66, v66
  s_waitcnt vmcnt(8) lgkmcnt(0)
  v_mfma_f32_32x32x16_bf16 v[128:143], a[144:147], a[168:171], v[128:143]
  v_xor_b32 v36, 768, v34
  ds_read_b64_tr_b16 a[128:129], v24 offset:0
  ds_read_b64_tr_b16 a[130:131], v24 offset:1024
  s_add_u32 m0, s52, 12288
  s_xor_b32 s54, s56, 3538944
  v_mfma_f32_32x32x16_bf16 v[144:159], a[144:147], a[172:175], v[144:159]
  ds_read_b128 a[160:163], v36 offset:0
  ds_read_b128 a[164:167], v36 offset:32768
  buffer_load_dwordx4 v38, s[20:23], s54 offen offset:0 lds
  v_exp_f32 v67, v67
  v_mfma_f32_32x32x16_bf16 v[160:175], a[148:151], a[168:171], v[160:175]
  ds_read_b64_tr_b16 a[132:133], v25 offset:0
  ds_read_b64_tr_b16 a[134:135], v25 offset:1024
  v_exp_f32 v68, v68
  v_mfma_f32_32x32x16_bf16 v[176:191], a[148:151], a[172:175], v[176:191]
  ds_read_b64_tr_b16 a[136:137], v26 offset:0
  ds_read_b64_tr_b16 a[138:139], v26 offset:1024
  buffer_load_dwordx4 v39, s[20:23], s54 offen offset:1024 lds
  v_exp_f32 v69, v69
  v_mfma_f32_32x32x16_bf16 v[192:207], a[152:155], a[168:171], v[192:207]
  ds_read_b64_tr_b16 a[140:141], v27 offset:0
  ds_read_b64_tr_b16 a[142:143], v27 offset:1024
  v_exp_f32 v70, v70
  v_mfma_f32_32x32x16_bf16 v[208:223], a[152:155], a[172:175], v[208:223]
  buffer_load_dwordx4 v40, s[20:23], s54 offen offset:2048 lds
  v_exp_f32 v71, v71
  v_accvgpr_read_b32 v72, a112
  v_accvgpr_read_b32 v73, a113
  v_mfma_f32_32x32x16_bf16 v[224:239], a[156:159], a[168:171], v[224:239]
  v_accvgpr_read_b32 v74, a114
  v_accvgpr_read_b32 v75, a115
  v_accvgpr_read_b32 v76, a116
  v_accvgpr_read_b32 v77, a117
  v_accvgpr_read_b32 v78, a118
  v_mfma_f32_32x32x16_bf16 v[240:255], a[156:159], a[172:175], v[240:255]
  buffer_load_dwordx4 v41, s[20:23], s54 offen offset:3072 lds
  v_accvgpr_read_b32 v79, a119
  v_fma_f32 v64, v64, v11, v11
  v_fma_f32 v65, v65, v11, v11
  v_fma_f32 v66, v66, v11, v11
  s_waitcnt vmcnt(8) lgkmcnt(0)
  v_mfma_f32_32x32x16_bf16 v[128:143], a[128:131], a[160:163], v[128:143]
  v_xor_b32 v36, 800, v34
  ds_read_b64_tr_b16 a[144:145], v24 offset:4096
  ds_read_b64_tr_b16 a[146:147], v24 offset:5120
  s_add_u32 m0, s52, 0
  s_xor_b32 s54, s56, 3670016
  v_mfma_f32_32x32x16_bf16 v[144:159], a[128:131], a[164:167], v[144:159]
  ds_read_b128 a[168:171], v36 offset:0
  ds_read_b128 a[172:175], v36 offset:32768
  buffer_load_dwordx4 v38, s[20:23], s54 offen offset:0 lds
  v_fma_f32 v67, v67, v11, v11
  v_fma_f32 v68, v68, v11, v11
  v_mfma_f32_32x32x16_bf16 v[160:175], a[132:135], a[160:163], v[160:175]
  ds_read_b64_tr_b16 a[148:149], v25 offset:4096
  ds_read_b64_tr_b16 a[150:151], v25 offset:5120
  v_fma_f32 v69, v69, v11, v11
  v_fma_f32 v70, v70, v11, v11
  v_fma_f32 v71, v71, v11, v11
  v_mfma_f32_32x32x16_bf16 v[176:191], a[132:135], a[164:167], v[176:191]
  ds_read_b64_tr_b16 a[152:153], v26 offset:4096
  ds_read_b64_tr_b16 a[154:155], v26 offset:5120
  buffer_load_dwordx4 v39, s[20:23], s54 offen offset:1024 lds
  v_rcp_f32 v64, v64
  v_mfma_f32_32x32x16_bf16 v[192:207], a[136:139], a[160:163], v[192:207]
  ds_read_b64_tr_b16 a[156:157], v27 offset:4096
  ds_read_b64_tr_b16 a[158:159], v27 offset:5120
  v_rcp_f32 v65, v65
  v_mfma_f32_32x32x16_bf16 v[208:223], a[136:139], a[164:167], v[208:223]
  buffer_load_dwordx4 v40, s[20:23], s54 offen offset:2048 lds
  v_rcp_f32 v66, v66
  v_rcp_f32 v67, v67
  v_mfma_f32_32x32x16_bf16 v[224:239], a[140:143], a[160:163], v[224:239]
  v_rcp_f32 v68, v68
  v_rcp_f32 v69, v69
  v_mfma_f32_32x32x16_bf16 v[240:255], a[140:143], a[164:167], v[240:255]
  buffer_load_dwordx4 v41, s[20:23], s54 offen offset:3072 lds
  v_rcp_f32 v70, v70
  v_rcp_f32 v71, v71
  s_waitcnt vmcnt(8) lgkmcnt(0)
  v_mfma_f32_32x32x16_bf16 v[128:143], a[144:147], a[168:171], v[128:143]
  v_xor_b32 v36, 832, v34
  ds_read_b64_tr_b16 a[128:129], v24 offset:8192
  ds_read_b64_tr_b16 a[130:131], v24 offset:9216
  s_add_u32 m0, s52, 4096
  s_xor_b32 s54, s56, 3801088
  v_mfma_f32_32x32x16_bf16 v[144:159], a[144:147], a[172:175], v[144:159]
  ds_read_b128 a[160:163], v36 offset:0
  ds_read_b128 a[164:167], v36 offset:32768
  buffer_load_dwordx4 v38, s[20:23], s54 offen offset:0 lds
  v_mul_f32 v72, v72, v64
  v_mul_f32 v73, v73, v65
  v_mfma_f32_32x32x16_bf16 v[160:175], a[148:151], a[168:171], v[160:175]
  ds_read_b64_tr_b16 a[132:133], v25 offset:8192
  ds_read_b64_tr_b16 a[134:135], v25 offset:9216
  v_mul_f32 v74, v74, v66
  v_mul_f32 v75, v75, v67
  v_mul_f32 v76, v76, v68
  v_mfma_f32_32x32x16_bf16 v[176:191], a[148:151], a[172:175], v[176:191]
  ds_read_b64_tr_b16 a[136:137], v26 offset:8192
  ds_read_b64_tr_b16 a[138:139], v26 offset:9216
  buffer_load_dwordx4 v39, s[20:23], s54 offen offset:1024 lds
  v_mul_f32 v77, v77, v69
  v_mul_f32 v78, v78, v70
  v_mfma_f32_32x32x16_bf16 v[192:207], a[152:155], a[168:171], v[192:207]
  ds_read_b64_tr_b16 a[140:141], v27 offset:8192
  ds_read_b64_tr_b16 a[142:143], v27 offset:9216
  v_mul_f32 v79, v79, v71
  v_cvt_pk_bf16_f32 v120, v72, v73
  v_cvt_pk_bf16_f32 v121, v74, v75
  v_mfma_f32_32x32x16_bf16 v[208:223], a[152:155], a[172:175], v[208:223]
  buffer_load_dwordx4 v40, s[20:23], s54 offen offset:2048 lds
  v_cvt_pk_bf16_f32 v122, v76, v77
  v_cvt_pk_bf16_f32 v123, v78, v79
  v_accvgpr_read_b32 v80, a56
  v_accvgpr_read_b32 v81, a57
  v_mfma_f32_32x32x16_bf16 v[224:239], a[156:159], a[168:171], v[224:239]
  v_accvgpr_read_b32 v82, a58
  v_accvgpr_read_b32 v83, a59
  v_accvgpr_read_b32 v84, a60
  v_accvgpr_read_b32 v85, a61
  v_accvgpr_read_b32 v86, a62
  v_mfma_f32_32x32x16_bf16 v[240:255], a[156:159], a[172:175], v[240:255]
  buffer_load_dwordx4 v41, s[20:23], s54 offen offset:3072 lds
  v_accvgpr_read_b32 v87, a63
  v_mul_f32 v80, v80, v9
  v_mul_f32 v81, v81, v9
  v_mul_f32 v82, v82, v9
  s_waitcnt vmcnt(8) lgkmcnt(0)
  v_mfma_f32_32x32x16_bf16 v[128:143], a[128:131], a[160:163], v[128:143]
  v_xor_b32 v36, 864, v34
  ds_read_b64_tr_b16 a[144:145], v24 offset:12288
  ds_read_b64_tr_b16 a[146:147], v24 offset:13312
  s_add_u32 m0, s52, 8192
  s_xor_b32 s54, s56, 3932160
  v_mfma_f32_32x32x16_bf16 v[144:159], a[128:131], a[164:167], v[144:159]
  ds_read_b128 a[168:171], v36 offset:0
  ds_read_b128 a[172:175], v36 offset:32768
  buffer_load_dwordx4 v38, s[20:23], s54 offen offset:0 lds
  v_mul_f32 v83, v83, v9
  v_mul_f32 v84, v84, v9
  v_mfma_f32_32x32x16_bf16 v[160:175], a[132:135], a[160:163], v[160:175]
  ds_read_b64_tr_b16 a[148:149], v25 offset:12288
  ds_read_b64_tr_b16 a[150:151], v25 offset:13312
  v_mul_f32 v85, v85, v9
  v_mul_f32 v86, v86, v9
  v_mul_f32 v87, v87, v9
  v_mfma_f32_32x32x16_bf16 v[176:191], a[132:135], a[164:167], v[176:191]
  ds_read_b64_tr_b16 a[152:153], v26 offset:12288
  ds_read_b64_tr_b16 a[154:155], v26 offset:13312
  buffer_load_dwordx4 v39, s[20:23], s54 offen offset:1024 lds
  v_exp_f32 v80, v80
  v_mfma_f32_32x32x16_bf16 v[192:207], a[136:139], a[160:163], v[192:207]
  ds_read_b64_tr_b16 a[156:157], v27 offset:12288
  ds_read_b64_tr_b16 a[158:159], v27 offset:13312
  v_exp_f32 v81, v81
  v_mfma_f32_32x32x16_bf16 v[208:223], a[136:139], a[164:167], v[208:223]
  buffer_load_dwordx4 v40, s[20:23], s54 offen offset:2048 lds
  v_exp_f32 v82, v82
  v_exp_f32 v83, v83
  v_mfma_f32_32x32x16_bf16 v[224:239], a[140:143], a[160:163], v[224:239]
  v_exp_f32 v84, v84
  v_exp_f32 v85, v85
  v_mfma_f32_32x32x16_bf16 v[240:255], a[140:143], a[164:167], v[240:255]
  buffer_load_dwordx4 v41, s[20:23], s54 offen offset:3072 lds
  v_exp_f32 v86, v86
  v_exp_f32 v87, v87
  s_waitcnt vmcnt(8) lgkmcnt(0)
  v_mfma_f32_32x32x16_bf16 v[128:143], a[144:147], a[168:171], v[128:143]
  v_xor_b32 v36, 896, v34
  ds_read_b64_tr_b16 a[128:129], v24 offset:0
  ds_read_b64_tr_b16 a[130:131], v24 offset:1024
  s_add_u32 m0, s52, 12288
  s_xor_b32 s54, s56, 4063232
  v_mfma_f32_32x32x16_bf16 v[144:159], a[144:147], a[172:175], v[144:159]
  ds_read_b128 a[160:163], v36 offset:0
  ds_read_b128 a[164:167], v36 offset:32768
  buffer_load_dwordx4 v38, s[20:23], s54 offen offset:0 lds
  v_accvgpr_read_b32 v88, a120
  v_accvgpr_read_b32 v89, a121
  v_mfma_f32_32x32x16_bf16 v[160:175], a[148:151], a[168:171], v[160:175]
  ds_read_b64_tr_b16 a[132:133], v25 offset:0
  ds_read_b64_tr_b16 a[134:135], v25 offset:1024
  v_accvgpr_read_b32 v90, a122
  v_accvgpr_read_b32 v91, a123
  v_accvgpr_read_b32 v92, a124
  v_mfma_f32_32x32x16_bf16 v[176:191], a[148:151], a[172:175], v[176:191]
  ds_read_b64_tr_b16 a[136:137], v26 offset:0
  ds_read_b64_tr_b16 a[138:139], v26 offset:1024
  buffer_load_dwordx4 v39, s[20:23], s54 offen offset:1024 lds
  v_accvgpr_read_b32 v93, a125
  v_accvgpr_read_b32 v94, a126
  v_mfma_f32_32x32x16_bf16 v[192:207], a[152:155], a[168:171], v[192:207]
  ds_read_b64_tr_b16 a[140:141], v27 offset:0
  ds_read_b64_tr_b16 a[142:143], v27 offset:1024
  v_accvgpr_read_b32 v95, a127
  v_fma_f32 v80, v80, v11, v11
  v_fma_f32 v81, v81, v11, v11
  v_mfma_f32_32x32x16_bf16 v[208:223], a[152:155], a[172:175], v[208:223]
  buffer_load_dwordx4 v40, s[20:23], s54 offen offset:2048 lds
  v_fma_f32 v82, v82, v11, v11
  v_fma_f32 v83, v83, v11, v11
  v_fma_f32 v84, v84, v11, v11
  v_fma_f32 v85, v85, v11, v11
  v_mfma_f32_32x32x16_bf16 v[224:239], a[156:159], a[168:171], v[224:239]
  v_fma_f32 v86, v86, v11, v11
  v_fma_f32 v87, v87, v11, v11
  v_rcp_f32 v80, v80
  v_mfma_f32_32x32x16_bf16 v[240:255], a[156:159], a[172:175], v[240:255]
  buffer_load_dwordx4 v41, s[20:23], s54 offen offset:3072 lds
  v_rcp_f32 v81, v81
  v_rcp_f32 v82, v82
  s_waitcnt vmcnt(8) lgkmcnt(0)
  v_mfma_f32_32x32x16_bf16 v[128:143], a[128:131], a[160:163], v[128:143]
  v_xor_b32 v36, 928, v34
  ds_read_b64_tr_b16 a[144:145], v24 offset:4096
  ds_read_b64_tr_b16 a[146:147], v24 offset:5120
  s_add_u32 m0, s52, 0
  s_xor_b32 s54, s60, 0
  v_mfma_f32_32x32x16_bf16 v[144:159], a[128:131], a[164:167], v[144:159]
  ds_read_b128 a[168:171], v36 offset:0
  ds_read_b128 a[172:175], v36 offset:32768
  buffer_load_dwordx4 v16, s[12:15], s54 offen offset:0 lds
  v_rcp_f32 v83, v83
  v_mfma_f32_32x32x16_bf16 v[160:175], a[132:135], a[160:163], v[160:175]
  ds_read_b64_tr_b16 a[148:149], v25 offset:4096
  ds_read_b64_tr_b16 a[150:151], v25 offset:5120
  v_rcp_f32 v84, v84
  v_mfma_f32_32x32x16_bf16 v[176:191], a[132:135], a[164:167], v[176:191]
  ds_read_b64_tr_b16 a[152:153], v26 offset:4096
  ds_read_b64_tr_b16 a[154:155], v26 offset:5120
  buffer_load_dwordx4 v17, s[12:15], s54 offen offset:1024 lds
  v_rcp_f32 v85, v85
  v_mfma_f32_32x32x16_bf16 v[192:207], a[136:139], a[160:163], v[192:207]
  ds_read_b64_tr_b16 a[156:157], v27 offset:4096
  ds_read_b64_tr_b16 a[158:159], v27 offset:5120
  v_rcp_f32 v86, v86
  v_mfma_f32_32x32x16_bf16 v[208:223], a[136:139], a[164:167], v[208:223]
  buffer_load_dwordx4 v18, s[12:15], s54 offen offset:2048 lds
  v_rcp_f32 v87, v87
  v_mul_f32 v88, v88, v80
  v_mul_f32 v89, v89, v81
  v_mfma_f32_32x32x16_bf16 v[224:239], a[140:143], a[160:163], v[224:239]
  v_mul_f32 v90, v90, v82
  v_mul_f32 v91, v91, v83
  v_mul_f32 v92, v92, v84
  v_mul_f32 v93, v93, v85
  v_mul_f32 v94, v94, v86
  v_mfma_f32_32x32x16_bf16 v[240:255], a[140:143], a[164:167], v[240:255]
  buffer_load_dwordx4 v19, s[12:15], s54 offen offset:3072 lds
  v_mul_f32 v95, v95, v87
  v_cvt_pk_bf16_f32 v124, v88, v89
  v_cvt_pk_bf16_f32 v125, v90, v91
  v_cvt_pk_bf16_f32 v126, v92, v93
  s_waitcnt vmcnt(8) lgkmcnt(0)
  v_mfma_f32_32x32x16_bf16 v[128:143], a[144:147], a[168:171], v[128:143]
  v_xor_b32 v36, 960, v34
  ds_read_b64_tr_b16 a[128:129], v24 offset:8192
  ds_read_b64_tr_b16 a[130:131], v24 offset:9216
  s_add_u32 m0, s52, 4096
  s_xor_b32 s54, s60, 0
  v_mfma_f32_32x32x16_bf16 v[144:159], a[144:147], a[172:175], v[144:159]
  ds_read_b128 a[160:163], v36 offset:0
  ds_read_b128 a[164:167], v36 offset:32768
  buffer_load_dwordx4 v48, s[16:19], s54 offen offset:0 lds
  v_cvt_pk_bf16_f32 v127, v94, v95
  s_lshl_b32 s3, s4, 11
  v_mfma_f32_32x32x16_bf16 v[160:175], a[148:151], a[168:171], v[160:175]
  ds_read_b64_tr_b16 a[132:133], v25 offset:8192
  ds_read_b64_tr_b16 a[134:135], v25 offset:9216
  v_lshlrev_b32 v46, 4, v1
  v_add_u32 v46, s3, v46
  v_and_b32 v47, 15, v1
  v_mfma_f32_32x32x16_bf16 v[176:191], a[148:151], a[172:175], v[176:191]
  ds_read_b64_tr_b16 a[136:137], v26 offset:8192
  ds_read_b64_tr_b16 a[138:139], v26 offset:9216
  buffer_load_dwordx4 v48, s[16:19], s54 offen offset:1024 lds
  s_lshl_b32 s3, s4, 14
  v_lshlrev_b32 v47, 10, v47
  v_mfma_f32_32x32x16_bf16 v[192:207], a[152:155], a[168:171], v[192:207]
  ds_read_b64_tr_b16 a[140:141], v27 offset:8192
  ds_read_b64_tr_b16 a[142:143], v27 offset:9216
  v_lshrrev_b32 v2, 4, v1
  v_lshl_add_u32 v47, v2, 3, v47
  v_add_u32 v47, s3, v47
  v_mfma_f32_32x32x16_bf16 v[208:223], a[152:155], a[172:175], v[208:223]
  buffer_load_dwordx4 v48, s[16:19], s54 offen offset:2048 lds
  s_lshl_b32 s69, s4, 13
  s_add_u32 s69, s69, 65536
  v_bfe_u32 v6, v1, 4, 1
  v_and_b32 v52, 47, v1
  v_mfma_f32_32x32x16_bf16 v[224:239], a[156:159], a[168:171], v[224:239]
  v_lshrrev_b32 v7, 5, v1
  v_lshl_add_u32 v52, v7, 4, v52
  v_and_b32 v52, 31, v52
  v_lshlrev_b32 v52, 4, v52
  v_lshl_add_u32 v52, v6, 10, v52
  v_mfma_f32_32x32x16_bf16 v[240:255], a[156:159], a[172:175], v[240:255]
  buffer_load_dwordx4 v48, s[16:19], s54 offen offset:3072 lds
  v_min_u32 v55, 1, v1
  v_lshlrev_b32 v55, 20, v55
  v_min_u32 v54, 1, v0
  v_lshlrev_b32 v54, 20, v54
  s_waitcnt vmcnt(8) lgkmcnt(0)
  v_mfma_f32_32x32x16_bf16 v[128:143], a[128:131], a[160:163], v[128:143]
  v_xor_b32 v36, 992, v34
  ds_read_b64_tr_b16 a[144:145], v24 offset:12288
  ds_read_b64_tr_b16 a[146:147], v24 offset:13312
  s_add_u32 m0, s52, 8192
  s_xor_b32 s54, s60, 16384
  v_mfma_f32_32x32x16_bf16 v[144:159], a[128:131], a[164:167], v[144:159]
  ds_read_b128 a[168:171], v36 offset:0
  ds_read_b128 a[172:175], v36 offset:32768
  buffer_load_dwordx4 v16, s[12:15], s54 offen offset:0 lds
  v_and_b32 v6, 15, v1
  v_xor_b32 v7, v6, v2
  v_mfma_f32_32x32x16_bf16 v[160:175], a[132:135], a[160:163], v[160:175]
  ds_read_b64_tr_b16 a[148:149], v25 offset:12288
  ds_read_b64_tr_b16 a[150:151], v25 offset:13312
  v_lshlrev_b32 v7, 4, v7
  v_lshl_add_u32 v35, v6, 10, v7
  s_lshl_b32 s3, s57, 5
  v_mfma_f32_32x32x16_bf16 v[176:191], a[132:135], a[164:167], v[176:191]
  ds_read_b64_tr_b16 a[152:153], v26 offset:12288
  ds_read_b64_tr_b16 a[154:155], v26 offset:13312
  buffer_load_dwordx4 v17, s[12:15], s54 offen offset:1024 lds
  v_xor_b32 v35, s3, v35
  v_lshrrev_b32 v2, 5, v1
  v_mfma_f32_32x32x16_bf16 v[192:207], a[136:139], a[160:163], v[192:207]
  ds_read_b64_tr_b16 a[156:157], v27 offset:12288
  ds_read_b64_tr_b16 a[158:159], v27 offset:13312
  v_and_b32 v6, 19, v1
  v_bfe_u32 v7, v1, 2, 1
  v_lshl_add_u32 v6, v7, 3, v6
  v_mfma_f32_32x32x16_bf16 v[208:223], a[136:139], a[164:167], v[208:223]
  buffer_load_dwordx4 v18, s[12:15], s54 offen offset:2048 lds
  v_bfe_u32 v7, v1, 3, 1
  v_lshl_add_u32 v6, v7, 2, v6
  v_and_b32 v7, 15, v6
  v_lshrrev_b32 v6, 4, v6
  v_mfma_f32_32x32x16_bf16 v[224:239], a[140:143], a[160:163], v[224:239]
  v_lshlrev_b32 v6, 14, v6
  v_lshl_add_u32 v6, v7, 8, v6
  v_xor_b32 v7, v7, v2
  v_lshl_add_u32 v6, v7, 4, v6
  v_add_u32 v8, 98304, v6
  v_mfma_f32_32x32x16_bf16 v[240:255], a[140:143], a[164:167], v[240:255]
  buffer_load_dwordx4 v19, s[12:15], s54 offen offset:3072 lds
  v_xor_b32 v9, 32, v8
  v_xor_b32 v10, 64, v8
  v_xor_b32 v11, 96, v8
  v_xor_b32 v12, 128, v8
  v_xor_b32 v13, 160, v8
  v_xor_b32 v14, 192, v8
  v_xor_b32 v15, 224, v8
  v_bfe_u32 v7, v1, 4, 1
  v_lshlrev_b32 v7, 1, v7
  v_and_b32 v38, 7, v1
  v_xor_b32 v38, v38, v7
  v_lshrrev_b32 v6, 3, v1
  v_lshlrev_b32 v6, 10, v6
  v_lshl_add_u32 v38, v38, 4, v6
  s_lshl_b32 s3, s7, 7
  s_mul_i32 s55, s4, 458752
  s_add_u32 s3, s3, s55
  v_add_u32 v38, s3, v38
  v_xor_b32 v39, 64, v38
  v_add_u32 v40, 14336, v38
  v_add_u32 v41, 21504, v39
  v_add_u32 v39, 7168, v39
  s_waitcnt lgkmcnt(0)
  v_mfma_f32_32x32x16_bf16 v[128:143], a[144:147], a[168:171], v[128:143]
  s_add_u32 m0, s52, 12288
  s_xor_b32 s54, s60, 16384
  v_mfma_f32_32x32x16_bf16 v[144:159], a[144:147], a[172:175], v[144:159]
  buffer_load_dwordx4 v48, s[16:19], s54 offen offset:0 lds
  v_mfma_f32_32x32x16_bf16 v[160:175], a[148:151], a[168:171], v[160:175]
  v_mfma_f32_32x32x16_bf16 v[176:191], a[148:151], a[172:175], v[176:191]
  buffer_load_dwordx4 v48, s[16:19], s54 offen offset:1024 lds
  s_waitcnt vmcnt(6)
  s_barrier
  v_mfma_f32_32x32x16_bf16 v[192:207], a[152:155], a[168:171], v[192:207]
  ds_read_b128 a[176:179], v8 offset:0
  ds_read_b128 a[180:183], v9 offset:0
  v_mfma_f32_32x32x16_bf16 v[208:223], a[152:155], a[172:175], v[208:223]
  buffer_load_dwordx4 v48, s[16:19], s54 offen offset:2048 lds
  ds_read_b128 a[184:187], v10 offset:0
  ds_read_b128 a[188:191], v11 offset:0
  v_mfma_f32_32x32x16_bf16 v[224:239], a[156:159], a[168:171], v[224:239]
  ds_read_b128 a[192:195], v12 offset:0
  ds_read_b128 a[196:199], v13 offset:0
  v_mfma_f32_32x32x16_bf16 v[240:255], a[156:159], a[172:175], v[240:255]
  buffer_load_dwordx4 v48, s[16:19], s54 offen offset:3072 lds
  ds_read_b128 a[200:203], v14 offset:0
  ds_read_b128 a[204:207], v15 offset:0
  buffer_store_dwordx4 v[96:99], v52, s[44:47], s66 offen offset:0 sc1
  v_mul_f32 v128, v128, v58
  v_mul_f32 v129, v129, v58
  v_mul_f32 v130, v130, v58
  v_mul_f32 v131, v131, v58
  v_mul_f32 v132, v132, v58
  v_mul_f32 v133, v133, v58
  v_mul_f32 v134, v134, v58
  v_mul_f32 v135, v135, v58
  v_mul_f32 v136, v136, v58
  v_mul_f32 v137, v137, v58
  v_mul_f32 v138, v138, v58
  v_mul_f32 v139, v139, v58
  v_mul_f32 v140, v140, v58
  v_mul_f32 v141, v141, v58
  v_mul_f32 v142, v142, v58
  v_mul_f32 v143, v143, v58
  s_add_u32 m0, s53, 0
  s_xor_b32 s54, s60, 32768
  buffer_load_dwordx4 v16, s[12:15], s54 offen offset:0 lds
  v_cvt_pk_bf16_f32 v128, v128, v129
  v_cvt_pk_bf16_f32 v129, v130, v131
  v_cvt_pk_bf16_f32 v130, v132, v133
  v_cvt_pk_bf16_f32 v131, v134, v135
  v_cvt_pk_bf16_f32 v132, v136, v137
  v_cvt_pk_bf16_f32 v133, v138, v139
  v_cvt_pk_bf16_f32 v134, v140, v141
  v_cvt_pk_bf16_f32 v135, v142, v143
  buffer_store_dwordx4 v[100:103], v52, s[44:47], s66 offen offset:512 sc1
  v_mul_f32 v144, v144, v59
  v_mul_f32 v145, v145, v59
  v_mul_f32 v146, v146, v59
  v_mul_f32 v147, v147, v59
  v_mul_f32 v148, v148, v59
  v_mul_f32 v149, v149, v59
  v_mul_f32 v150, v150, v59
  v_mul_f32 v151, v151, v59
  v_mul_f32 v152, v152, v59
  v_mul_f32 v153, v153, v59
  v_mul_f32 v154, v154, v59
  v_mul_f32 v155, v155, v59
  v_mul_f32 v156, v156, v59
  v_mul_f32 v157, v157, v59
  v_mul_f32 v158, v158, v59
  v_mul_f32 v159, v159, v59
  buffer_load_dwordx4 v17, s[12:15], s54 offen offset:1024 lds
  v_cvt_pk_bf16_f32 v136, v144, v145
  v_cvt_pk_bf16_f32 v137, v146, v147
  v_cvt_pk_bf16_f32 v138, v148, v149
  v_cvt_pk_bf16_f32 v139, v150, v151
  v_cvt_pk_bf16_f32 v140, v152, v153
  v_cvt_pk_bf16_f32 v141, v154, v155
  v_cvt_pk_bf16_f32 v142, v156, v157
  v_cvt_pk_bf16_f32 v143, v158, v159
  s_waitcnt lgkmcnt(7)
  v_mfma_f32_32x32x16_bf16 v[64:79], a[176:179], v[128:131], 0
  v_mfma_f32_32x32x16_bf16 v[80:95], a[176:179], v[136:139], 0
  buffer_store_dwordx4 v[104:107], v52, s[44:47], s66 offen offset:2048 sc1
  v_mul_f32 v160, v160, v58
  v_mul_f32 v161, v161, v58
  v_mul_f32 v162, v162, v58
  v_mul_f32 v163, v163, v58
  v_mul_f32 v164, v164, v58
  v_mul_f32 v165, v165, v58
  v_mul_f32 v166, v166, v58
  v_mul_f32 v167, v167, v58
  v_mul_f32 v168, v168, v58
  v_mul_f32 v169, v169, v58
  v_mul_f32 v170, v170, v58
  v_mul_f32 v171, v171, v58
  v_mul_f32 v172, v172, v58
  v_mul_f32 v173, v173, v58
  v_mul_f32 v174, v174, v58
  v_mul_f32 v175, v175, v58
  buffer_load_dwordx4 v18, s[12:15], s54 offen offset:2048 lds
  v_cvt_pk_bf16_f32 v144, v160, v161
  v_cvt_pk_bf16_f32 v145, v162, v163
  v_cvt_pk_bf16_f32 v146, v164, v165
  v_cvt_pk_bf16_f32 v147, v166, v167
  v_cvt_pk_bf16_f32 v148, v168, v169
  v_cvt_pk_bf16_f32 v149, v170, v171
  v_cvt_pk_bf16_f32 v150, v172, v173
  v_cvt_pk_bf16_f32 v151, v174, v175
  s_waitcnt lgkmcnt(6)
  v_mfma_f32_32x32x16_bf16 v[64:79], a[180:183], v[132:135], v[64:79]
  v_mfma_f32_32x32x16_bf16 v[80:95], a[180:183], v[140:143], v[80:95]
  buffer_store_dwordx4 v[108:111], v52, s[44:47], s66 offen offset:2560 sc1
  v_mul_f32 v176, v176, v59
  v_mul_f32 v177, v177, v59
  v_mul_f32 v178, v178, v59
  v_mul_f32 v179, v179, v59
  v_mul_f32 v180, v180, v59
  v_mul_f32 v181, v181, v59
  v_mul_f32 v182, v182, v59
  v_mul_f32 v183, v183, v59
  v_mul_f32 v184, v184, v59
  v_mul_f32 v185, v185, v59
  v_mul_f32 v186, v186, v59
  v_mul_f32 v187, v187, v59
  v_mul_f32 v188, v188, v59
  v_mul_f32 v189, v189, v59
  v_mul_f32 v190, v190, v59
  v_mul_f32 v191, v191, v59
  buffer_load_dwordx4 v19, s[12:15], s54 offen offset:3072 lds
  v_cvt_pk_bf16_f32 v152, v176, v177
  v_cvt_pk_bf16_f32 v153, v178, v179
  v_cvt_pk_bf16_f32 v154, v180, v181
  v_cvt_pk_bf16_f32 v155, v182, v183
  v_cvt_pk_bf16_f32 v156, v184, v185
  v_cvt_pk_bf16_f32 v157, v186, v187
  v_cvt_pk_bf16_f32 v158, v188, v189
  v_cvt_pk_bf16_f32 v159, v190, v191
  s_waitcnt lgkmcnt(5)
  v_mfma_f32_32x32x16_bf16 v[64:79], a[184:187], v[144:147], v[64:79]
  v_mfma_f32_32x32x16_bf16 v[80:95], a[184:187], v[152:155], v[80:95]
  buffer_store_dwordx4 v[112:115], v52, s[44:47], s67 offen offset:0 sc1
  v_mul_f32 v192, v192, v58
  v_mul_f32 v193, v193, v58
  v_mul_f32 v194, v194, v58
  v_mul_f32 v195, v195, v58
  v_mul_f32 v196, v196, v58
  v_mul_f32 v197, v197, v58
  v_mul_f32 v198, v198, v58
  v_mul_f32 v199, v199, v58
  v_mul_f32 v200, v200, v58
  v_mul_f32 v201, v201, v58
  v_mul_f32 v202, v202, v58
  v_mul_f32 v203, v203, v58
  v_mul_f32 v204, v204, v58
  v_mul_f32 v205, v205, v58
  v_mul_f32 v206, v206, v58
  v_mul_f32 v207, v207, v58
  s_add_u32 m0, s53, 4096
  s_xor_b32 s54, s60, 32768
  buffer_load_dwordx4 v48, s[16:19], s54 offen offset:0 lds
  v_cvt_pk_bf16_f32 v160, v192, v193
  v_cvt_pk_bf16_f32 v161, v194, v195
  v_cvt_pk_bf16_f32 v162, v196, v197
  v_cvt_pk_bf16_f32 v163, v198, v199
  v_cvt_pk_bf16_f32 v164, v200, v201
  v_cvt_pk_bf16_f32 v165, v202, v203
  v_cvt_pk_bf16_f32 v166, v204, v205
  v_cvt_pk_bf16_f32 v167, v206, v207
  s_waitcnt lgkmcnt(4)
  v_mfma_f32_32x32x16_bf16 v[64:79], a[188:191], v[148:151], v[64:79]
  v_mfma_f32_32x32x16_bf16 v[80:95], a[188:191], v[156:159], v[80:95]
  buffer_store_dwordx4 v[116:119], v52, s[44:47], s67 offen offset:512 sc1
  v_mul_f32 v208, v208, v59
  v_mul_f32 v209, v209, v59
  v_mul_f32 v210, v210, v59
  v_mul_f32 v211, v211, v59
  v_mul_f32 v212, v212, v59
  v_mul_f32 v213, v213, v59
  v_mul_f32 v214, v214, v59
  v_mul_f32 v215, v215, v59
  v_mul_f32 v216, v216, v59
  v_mul_f32 v217, v217, v59
  v_mul_f32 v218, v218, v59
  v_mul_f32 v219, v219, v59
  v_mul_f32 v220, v220, v59
  v_mul_f32 v221, v221, v59
  v_mul_f32 v222, v222, v59
  v_mul_f32 v223, v223, v59
  buffer_load_dwordx4 v48, s[16:19], s54 offen offset:1024 lds
  v_cvt_pk_bf16_f32 v168, v208, v209
  v_cvt_pk_bf16_f32 v169, v210, v211
  v_cvt_pk_bf16_f32 v170, v212, v213
  v_cvt_pk_bf16_f32 v171, v214, v215
  v_cvt_pk_bf16_f32 v172, v216, v217
  v_cvt_pk_bf16_f32 v173, v218, v219
  v_cvt_pk_bf16_f32 v174, v220, v221
  v_cvt_pk_bf16_f32 v175, v222, v223
  s_waitcnt lgkmcnt(3)
  v_mfma_f32_32x32x16_bf16 v[64:79], a[192:195], v[160:163], v[64:79]
  v_mfma_f32_32x32x16_bf16 v[80:95], a[192:195], v[168:171], v[80:95]
  buffer_store_dwordx4 v[120:123], v52, s[44:47], s67 offen offset:2048 sc1
  v_mul_f32 v224, v224, v58
  v_mul_f32 v225, v225, v58
  v_mul_f32 v226, v226, v58
  v_mul_f32 v227, v227, v58
  v_mul_f32 v228, v228, v58
  v_mul_f32 v229, v229, v58
  v_mul_f32 v230, v230, v58
  v_mul_f32 v231, v231, v58
  v_mul_f32 v232, v232, v58
  v_mul_f32 v233, v233, v58
  v_mul_f32 v234, v234, v58
  v_mul_f32 v235, v235, v58
  v_mul_f32 v236, v236, v58
  v_mul_f32 v237, v237, v58
  v_mul_f32 v238, v238, v58
  v_mul_f32 v239, v239, v58
  buffer_load_dwordx4 v48, s[16:19], s54 offen offset:2048 lds
  v_cvt_pk_bf16_f32 v176, v224, v225
  v_cvt_pk_bf16_f32 v177, v226, v227
  v_cvt_pk_bf16_f32 v178, v228, v229
  v_cvt_pk_bf16_f32 v179, v230, v231
  v_cvt_pk_bf16_f32 v180, v232, v233
  v_cvt_pk_bf16_f32 v181, v234, v235
  v_cvt_pk_bf16_f32 v182, v236, v237
  v_cvt_pk_bf16_f32 v183, v238, v239
  s_waitcnt lgkmcnt(2)
  v_mfma_f32_32x32x16_bf16 v[64:79], a[196:199], v[164:167], v[64:79]
  v_mfma_f32_32x32x16_bf16 v[80:95], a[196:199], v[172:175], v[80:95]
  buffer_store_dwordx4 v[124:127], v52, s[44:47], s67 offen offset:2560 sc1
  v_mul_f32 v240, v240, v59
  v_mul_f32 v241, v241, v59
  v_mul_f32 v242, v242, v59
  v_mul_f32 v243, v243, v59
  v_mul_f32 v244, v244, v59
  v_mul_f32 v245, v245, v59
  v_mul_f32 v246, v246, v59
  v_mul_f32 v247, v247, v59
  v_mul_f32 v248, v248, v59
  v_mul_f32 v249, v249, v59
  v_mul_f32 v250, v250, v59
  v_mul_f32 v251, v251, v59
  v_mul_f32 v252, v252, v59
  v_mul_f32 v253, v253, v59
  v_mul_f32 v254, v254, v59
  v_mul_f32 v255, v255, v59
  buffer_load_dwordx4 v48, s[16:19], s54 offen offset:3072 lds
  v_cvt_pk_bf16_f32 v184, v240, v241
  v_cvt_pk_bf16_f32 v185, v242, v243
  v_cvt_pk_bf16_f32 v186, v244, v245
  v_cvt_pk_bf16_f32 v187, v246, v247
  v_cvt_pk_bf16_f32 v188, v248, v249
  v_cvt_pk_bf16_f32 v189, v250, v251
  v_cvt_pk_bf16_f32 v190, v252, v253
  v_cvt_pk_bf16_f32 v191, v254, v255
  s_waitcnt lgkmcnt(1)
  v_mfma_f32_32x32x16_bf16 v[64:79], a[200:203], v[176:179], v[64:79]
  v_mfma_f32_32x32x16_bf16 v[80:95], a[200:203], v[184:187], v[80:95]
  s_waitcnt lgkmcnt(0)
  v_mfma_f32_32x32x16_bf16 v[64:79], a[204:207], v[180:183], v[64:79]
  v_mfma_f32_32x32x16_bf16 v[80:95], a[204:207], v[188:191], v[80:95]
  ds_read_b128 a[176:179], v8 offset:32768
  ds_read_b128 a[180:183], v9 offset:32768
  ds_read_b128 a[184:187], v10 offset:32768
  ds_read_b128 a[188:191], v11 offset:32768
  ds_read_b128 a[192:195], v12 offset:32768
  ds_read_b128 a[196:199], v13 offset:32768
  ds_read_b128 a[200:203], v14 offset:32768
  ds_read_b128 a[204:207], v15 offset:32768
  s_nop 2
  v_max3_f32 v2, v64, v65, v66
  v_max3_f32 v3, v80, v81, v82
  v_max3_f32 v2, v67, v68, v2
  v_max3_f32 v3, v83, v84, v3
  v_max3_f32 v2, v69, v70, v2
  v_max3_f32 v3, v85, v86, v3
  v_max3_f32 v2, v71, v72, v2
  v_max3_f32 v3, v87, v88, v3
  v_max3_f32 v2, v73, v74, v2
  v_max3_f32 v3, v89, v90, v3
  v_max3_f32 v2, v75, v76, v2
  v_max3_f32 v3, v91, v92, v3
  v_max3_f32 v2, v77, v78, v2
  v_max3_f32 v3, v93, v94, v3
  v_max_f32 v32, v79, v2
  v_max_f32 v33, v95, v3
  v_mov_b32 v2, v32
  v_mov_b32 v3, v33
  s_nop 0
  v_permlane32_swap_b32 v2, v32
  v_permlane32_swap_b32 v3, v33
  v_max_f32 v32, v32, v2
  v_max_f32 v33, v33, v3
  v_sub_f32 v224, 0, v32
  v_sub_f32 v225, 0, v32
  v_sub_f32 v226, 0, v32
  v_sub_f32 v227, 0, v32
  v_sub_f32 v228, 0, v32
  v_sub_f32 v229, 0, v32
  v_sub_f32 v230, 0, v32
  v_sub_f32 v231, 0, v32
  v_sub_f32 v232, 0, v32
  v_sub_f32 v233, 0, v32
  v_sub_f32 v234, 0, v32
  v_sub_f32 v235, 0, v32
  v_sub_f32 v236, 0, v32
  v_sub_f32 v237, 0, v32
  v_sub_f32 v238, 0, v32
  v_sub_f32 v239, 0, v32
  v_sub_f32 v240, 0, v33
  v_sub_f32 v241, 0, v33
  v_sub_f32 v242, 0, v33
  v_sub_f32 v243, 0, v33
  v_sub_f32 v244, 0, v33
  v_sub_f32 v245, 0, v33
  v_sub_f32 v246, 0, v33
  v_sub_f32 v247, 0, v33
  v_sub_f32 v248, 0, v33
  v_sub_f32 v249, 0, v33
  v_sub_f32 v250, 0, v33
  v_sub_f32 v251, 0, v33
  v_sub_f32 v252, 0, v33
  v_sub_f32 v253, 0, v33
  v_sub_f32 v254, 0, v33
  v_sub_f32 v255, 0, v33
  s_waitcnt lgkmcnt(4)
  v_mfma_f32_32x32x16_bf16 v[96:111], a[176:179], v[128:131], v[224:239]
  v_add_f32 v64, v64, v224
  v_add_f32 v65, v65, v224
  v_exp_f32 v64, v64
  v_add_f32 v66, v66, v224
  v_exp_f32 v65, v65
  v_mfma_f32_32x32x16_bf16 v[112:127], a[176:179], v[136:139], v[240:255]
  ds_read_b64_tr_b16 a[176:177], v20 offset:4096
  v_mov_b32 v60, v64
  v_add_f32 v67, v67, v224
  v_exp_f32 v66, v66
  v_add_f32 v60, v60, v65
  v_cvt_pk_bf16_f32 v64, v64, v65
  v_mfma_f32_32x32x16_bf16 v[96:111], a[180:183], v[132:135], v[96:111]
  ds_read_b64_tr_b16 a[178:179], v20 offset:5120
  v_add_f32 v68, v68, v224
  v_exp_f32 v67, v67
  v_add_f32 v60, v60, v66
  v_add_f32 v69, v69, v224
  v_mfma_f32_32x32x16_bf16 v[112:127], a[180:183], v[140:143], v[112:127]
  ds_read_b64_tr_b16 a[180:181], v21 offset:4096
  v_exp_f32 v68, v68
  v_add_f32 v60, v60, v67
  v_cvt_pk_bf16_f32 v65, v66, v67
  v_add_f32 v70, v70, v224
  v_mfma_f32_32x32x16_bf16 v[96:111], a[184:187], v[144:147], v[96:111]
  ds_read_b64_tr_b16 a[182:183], v21 offset:5120
  v_exp_f32 v69, v69
  v_add_f32 v60, v60, v68
  v_add_f32 v71, v71, v224
  v_exp_f32 v70, v70
  v_mfma_f32_32x32x16_bf16 v[112:127], a[184:187], v[152:155], v[112:127]
  ds_read_b64_tr_b16 a[184:185], v22 offset:4096
  v_add_f32 v60, v60, v69
  v_cvt_pk_bf16_f32 v66, v68, v69
  v_add_f32 v80, v80, v240
  v_exp_f32 v71, v71
  v_add_f32 v60, v60, v70
  v_mfma_f32_32x32x16_bf16 v[96:111], a[188:191], v[148:151], v[96:111]
  ds_read_b64_tr_b16 a[186:187], v22 offset:5120
  v_add_f32 v81, v81, v240
  v_exp_f32 v80, v80
  v_add_f32 v60, v60, v71
  v_cvt_pk_bf16_f32 v67, v70, v71
  v_add_f32 v82, v82, v240
  v_mfma_f32_32x32x16_bf16 v[112:127], a[188:191], v[156:159], v[112:127]
  ds_read_b64_tr_b16 a[188:189], v23 offset:4096
  v_exp_f32 v81, v81
  v_mov_b32 v61, v80
  v_add_f32 v83, v83, v240
  v_exp_f32 v82, v82
  s_waitcnt lgkmcnt(7)
  v_mfma_f32_32x32x16_bf16 v[96:111], a[192:195], v[160:163], v[96:111]
  ds_read_b64_tr_b16 a[190:191], v23 offset:5120
  v_add_f32 v61, v61, v81
  v_cvt_pk_bf16_f32 v80, v80, v81
  v_add_f32 v84, v84, v240
  v_exp_f32 v83, v83
  v_add_f32 v61, v61, v82
  v_mfma_f32_32x32x16_bf16 v[112:127], a[192:195], v[168:171], v[112:127]
  ds_read_b64_tr_b16 a[192:193], v20 offset:20480
  v_add_f32 v85, v85, v240
  v_exp_f32 v84, v84
  v_add_f32 v61, v61, v83
  v_cvt_pk_bf16_f32 v81, v82, v83
  v_add_f32 v86, v86, v240
  v_mfma_f32_32x32x16_bf16 v[96:111], a[196:199], v[164:167], v[96:111]
  ds_read_b64_tr_b16 a[194:195], v20 offset:21504
  v_exp_f32 v85, v85
  v_add_f32 v61, v61, v84
  v_add_f32 v87, v87, v240
  v_exp_f32 v86, v86
  v_mfma_f32_32x32x16_bf16 v[112:127], a[196:199], v[172:175], v[112:127]
  ds_read_b64_tr_b16 a[196:197], v21 offset:20480
  v_add_f32 v61, v61, v85
  v_cvt_pk_bf16_f32 v82, v84, v85
  v_add_f32 v72, v72, v224
  v_exp_f32 v87, v87
  v_add_f32 v61, v61, v86
  v_mfma_f32_32x32x16_bf16 v[96:111], a[200:203], v[176:179], v[96:111]
  ds_read_b64_tr_b16 a[198:199], v21 offset:21504
  v_add_f32 v73, v73, v224
  v_exp_f32 v72, v72
  v_add_f32 v61, v61, v87
  v_cvt_pk_bf16_f32 v83, v86, v87
  v_add_f32 v74, v74, v224
  v_mfma_f32_32x32x16_bf16 v[112:127], a[200:203], v[184:187], v[112:127]
  ds_read_b64_tr_b16 a[200:201], v22 offset:20480
  v_exp_f32 v73, v73
  v_add_f32 v60, v60, v72
  v_add_f32 v75, v75, v224
  v_exp_f32 v74, v74
  v_mfma_f32_32x32x16_bf16 v[96:111], a[204:207], v[180:183], v[96:111]
  ds_read_b64_tr_b16 a[202:203], v22 offset:21504
  v_add_f32 v60, v60, v73
  v_cvt_pk_bf16_f32 v72, v72, v73
  v_add_f32 v76, v76, v224
  v_exp_f32 v75, v75
  v_add_f32 v60, v60, v74
  v_mfma_f32_32x32x16_bf16 v[112:127], a[204:207], v[188:191], v[112:127]
  ds_read_b64_tr_b16 a[204:205], v23 offset:20480
  ds_read_b64_tr_b16 a[206:207], v23 offset:21504
  v_add_f32 v77, v77, v224
  v_exp_f32 v76, v76
  v_add_f32 v60, v60, v75
  v_cvt_pk_bf16_f32 v73, v74, v75
  v_add_f32 v78, v78, v224
  v_exp_f32 v77, v77
  v_add_f32 v60, v60, v76
  v_add_f32 v79, v79, v224
  v_exp_f32 v78, v78
  v_add_f32 v60, v60, v77
  v_cvt_pk_bf16_f32 v74, v76, v77
  v_add_f32 v88, v88, v240
  v_exp_f32 v79, v79
  v_add_f32 v60, v60, v78
  v_add_f32 v89, v89, v240
  v_exp_f32 v88, v88
  v_add_f32 v60, v60, v79
  v_cvt_pk_bf16_f32 v75, v78, v79
  v_add_f32 v90, v90, v240
  v_exp_f32 v89, v89
  v_add_f32 v61, v61, v88
  v_add_f32 v91, v91, v240
  v_exp_f32 v90, v90
  v_add_f32 v61, v61, v89
  v_cvt_pk_bf16_f32 v88, v88, v89
  v_add_f32 v92, v92, v240
  v_exp_f32 v91, v91
  v_add_f32 v61, v61, v90
  v_add_f32 v93, v93, v240
  v_exp_f32 v92, v92
  v_add_f32 v61, v61, v91
  v_cvt_pk_bf16_f32 v89, v90, v91
  v_add_f32 v94, v94, v240
  v_exp_f32 v93, v93
  v_add_f32 v61, v61, v92
  v_add_f32 v95, v95, v240
  v_exp_f32 v94, v94
  v_add_f32 v61, v61, v93
  v_cvt_pk_bf16_f32 v90, v92, v93
  v_exp_f32 v95, v95
  v_add_f32 v61, v61, v94
  v_add_f32 v61, v61, v95
  v_cvt_pk_bf16_f32 v91, v94, v95
  s_waitcnt lgkmcnt(8)
  v_mfma_f32_32x32x16_bf16 a[0:15], a[176:179], v[64:67], 0
  s_waitcnt vmcnt(16)
  s_waitcnt vmcnt(1)
  s_barrier
  v_mfma_f32_32x32x16_bf16 a[16:31], a[176:179], v[80:83], 0
  v_mov_b32 v6, 1
  s_lshl2_add_u32 s3, s6, s94
  buffer_store_dword v6, v54, s[76:79], s3 offen sc1
  ds_read_b128 a[176:179], v8 offset:8192
  v_mfma_f32_32x32x16_bf16 a[32:47], a[180:183], v[64:67], 0
  s_add_u32 m0, s53, 8192
  s_xor_b32 s54, s60, 49152
  buffer_load_dwordx4 v16, s[12:15], s54 offen offset:0 lds
  v_mfma_f32_32x32x16_bf16 a[48:63], a[180:183], v[80:83], 0
  ds_read_b128 a[180:183], v9 offset:8192
  v_exp_f32 v96, v96
  v_exp_f32 v97, v97
  v_add_f32 v60, v60, v96
  v_mfma_f32_32x32x16_bf16 a[64:79], a[184:187], v[64:67], 0
  buffer_load_dwordx4 v17, s[12:15], s54 offen offset:1024 lds
  v_exp_f32 v98, v98
  v_add_f32 v60, v60, v97
  v_cvt_pk_bf16_f32 v96, v96, v97
  v_mfma_f32_32x32x16_bf16 a[80:95], a[184:187], v[80:83], 0
  ds_read_b128 a[184:187], v10 offset:8192
  v_exp_f32 v99, v99
  v_add_f32 v60, v60, v98
  v_exp_f32 v100, v100
  v_mfma_f32_32x32x16_bf16 a[96:111], a[188:191], v[64:67], 0
  buffer_load_dwordx4 v18, s[12:15], s54 offen offset:2048 lds
  v_add_f32 v60, v60, v99
  v_cvt_pk_bf16_f32 v97, v98, v99
  v_exp_f32 v101, v101
  v_add_f32 v60, v60, v100
  v_mfma_f32_32x32x16_bf16 a[112:127], a[188:191], v[80:83], 0
  ds_read_b128 a[188:191], v11 offset:8192
  v_exp_f32 v102, v102
  v_add_f32 v60, v60, v101
  v_cvt_pk_bf16_f32 v98, v100, v101
  s_waitcnt lgkmcnt(4)
  v_mfma_f32_32x32x16_bf16 a[0:15], a[192:195], v[72:75], a[0:15]
  buffer_load_dwordx4 v19, s[12:15], s54 offen offset:3072 lds
  v_exp_f32 v103, v103
  v_add_f32 v60, v60, v102
  v_exp_f32 v112, v112
  v_mfma_f32_32x32x16_bf16 a[16:31], a[192:195], v[88:91], a[16:31]
  ds_read_b128 a[192:195], v12 offset:8192
  v_add_f32 v60, v60, v103
  v_cvt_pk_bf16_f32 v99, v102, v103
  v_exp_f32 v113, v113
  v_add_f32 v61, v61, v112
  v_mfma_f32_32x32x16_bf16 a[32:47], a[196:199], v[72:75], a[32:47]
  s_add_u32 m0, s53, 12288
  s_xor_b32 s54, s60, 49152
  buffer_load_dwordx4 v48, s[16:19], s54 offen offset:0 lds
  v_exp_f32 v114, v114
  v_add_f32 v61, v61, v113
  v_mfma_f32_32x32x16_bf16 a[48:63], a[196:199], v[88:91], a[48:63]
  ds_read_b128 a[196:199], v13 offset:8192
  v_cvt_pk_bf16_f32 v112, v112, v113
  v_exp_f32 v115, v115
  v_add_f32 v61, v61, v114
  v_mfma_f32_32x32x16_bf16 a[64:79], a[200:203], v[72:75], a[64:79]
  buffer_load_dwordx4 v48, s[16:19], s54 offen offset:1024 lds
  v_exp_f32 v116, v116
  v_add_f32 v61, v61, v115
  v_cvt_pk_bf16_f32 v113, v114, v115
  v_mfma_f32_32x32x16_bf16 a[80:95], a[200:203], v[88:91], a[80:95]
  ds_read_b128 a[200:203], v14 offset:8192
  v_exp_f32 v117, v117
  v_add_f32 v61, v61, v116
  v_exp_f32 v118, v118
  v_mfma_f32_32x32x16_bf16 a[96:111], a[204:207], v[72:75], a[96:111]
  buffer_load_dwordx4 v48, s[16:19], s54 offen offset:2048 lds
  v_add_f32 v61, v61, v117
  v_cvt_pk_bf16_f32 v114, v116, v117
  v_exp_f32 v119, v119
  v_add_f32 v61, v61, v118
  v_mfma_f32_32x32x16_bf16 a[112:127], a[204:207], v[88:91], a[112:127]
  buffer_load_dwordx4 v48, s[16:19], s54 offen offset:3072 lds
  ds_read_b128 a[204:207], v15 offset:8192
  v_exp_f32 v104, v104
  v_add_f32 v61, v61, v119
  v_cvt_pk_bf16_f32 v115, v118, v119
  s_waitcnt lgkmcnt(4)
  v_mfma_f32_32x32x16_bf16 v[64:79], a[176:179], v[128:131], v[224:239]
  v_exp_f32 v105, v105
  v_add_f32 v60, v60, v104
  v_exp_f32 v106, v106
  v_add_f32 v60, v60, v105
  v_mfma_f32_32x32x16_bf16 v[80:95], a[176:179], v[136:139], v[240:255]
  ds_read_b64_tr_b16 a[176:177], v20 offset:36864
  v_cvt_pk_bf16_f32 v104, v104, v105
  v_exp_f32 v107, v107
  v_add_f32 v60, v60, v106
  v_mfma_f32_32x32x16_bf16 v[64:79], a[180:183], v[132:135], v[64:79]
  ds_read_b64_tr_b16 a[178:179], v20 offset:37888
  v_exp_f32 v108, v108
  v_add_f32 v60, v60, v107
  v_cvt_pk_bf16_f32 v105, v106, v107
  v_mfma_f32_32x32x16_bf16 v[80:95], a[180:183], v[140:143], v[80:95]
  ds_read_b64_tr_b16 a[180:181], v21 offset:36864
  v_exp_f32 v109, v109
  v_add_f32 v60, v60, v108
  v_exp_f32 v110, v110
  v_mfma_f32_32x32x16_bf16 v[64:79], a[184:187], v[144:147], v[64:79]
  ds_read_b64_tr_b16 a[182:183], v21 offset:37888
  v_add_f32 v60, v60, v109
  v_cvt_pk_bf16_f32 v106, v108, v109
  v_exp_f32 v111, v111
  v_add_f32 v60, v60, v110
  v_mfma_f32_32x32x16_bf16 v[80:95], a[184:187], v[152:155], v[80:95]
  ds_read_b64_tr_b16 a[184:185], v22 offset:36864
  v_exp_f32 v120, v120
  v_add_f32 v60, v60, v111
  v_cvt_pk_bf16_f32 v107, v110, v111
  v_mfma_f32_32x32x16_bf16 v[64:79], a[188:191], v[148:151], v[64:79]
  ds_read_b64_tr_b16 a[186:187], v22 offset:37888
  v_exp_f32 v121, v121
  v_add_f32 v61, v61, v120
  v_exp_f32 v122, v122
  v_mfma_f32_32x32x16_bf16 v[80:95], a[188:191], v[156:159], v[80:95]
  ds_read_b64_tr_b16 a[188:189], v23 offset:36864
  v_add_f32 v61, v61, v121
  v_cvt_pk_bf16_f32 v120, v120, v121
  v_exp_f32 v123, v123
  v_add_f32 v61, v61, v122
  s_waitcnt lgkmcnt(7)
  v_mfma_f32_32x32x16_bf16 v[64:79], a[192:195], v[160:163], v[64:79]
  ds_read_b64_tr_b16 a[190:191], v23 offset:37888
  v_exp_f32 v124, v124
  v_add_f32 v61, v61, v123
  v_cvt_pk_bf16_f32 v121, v122, v123
  v_mfma_f32_32x32x16_bf16 v[80:95], a[192:195], v[168:171], v[80:95]
  ds_read_b64_tr_b16 a[192:193], v20 offset:53248
  v_exp_f32 v125, v125
  v_add_f32 v61, v61, v124
  v_exp_f32 v126, v126
  v_mfma_f32_32x32x16_bf16 v[64:79], a[196:199], v[164:167], v[64:79]
  ds_read_b64_tr_b16 a[194:195], v20 offset:54272
  v_add_f32 v61, v61, v125
  v_cvt_pk_bf16_f32 v122, v124, v125
  v_exp_f32 v127, v127
  v_add_f32 v61, v61, v126
  v_mfma_f32_32x32x16_bf16 v[80:95], a[196:199], v[172:175], v[80:95]
  ds_read_b64_tr_b16 a[196:197], v21 offset:53248
  v_add_f32 v61, v61, v127
  v_cvt_pk_bf16_f32 v123, v126, v127
  v_mfma_f32_32x32x16_bf16 v[64:79], a[200:203], v[176:179], v[64:79]
  ds_read_b64_tr_b16 a[198:199], v21 offset:54272
  v_mfma_f32_32x32x16_bf16 v[80:95], a[200:203], v[184:187], v[80:95]
  ds_read_b64_tr_b16 a[200:201], v22 offset:53248
  v_mfma_f32_32x32x16_bf16 v[64:79], a[204:207], v[180:183], v[64:79]
  ds_read_b64_tr_b16 a[202:203], v22 offset:54272
  v_mfma_f32_32x32x16_bf16 v[80:95], a[204:207], v[188:191], v[80:95]
  ds_read_b64_tr_b16 a[204:205], v23 offset:53248
  ds_read_b64_tr_b16 a[206:207], v23 offset:54272
  s_waitcnt lgkmcnt(8)
  v_mfma_f32_32x32x16_bf16 a[0:15], a[176:179], v[96:99], a[0:15]
  v_and_b32 v5, 3, v1
  v_lshlrev_b32 v5, 3, v5
  v_mfma_f32_32x32x16_bf16 a[16:31], a[176:179], v[112:115], a[16:31]
  ds_read_b128 a[176:179], v8 offset:40960
  v_mfma_f32_32x32x16_bf16 a[32:47], a[180:183], v[96:99], a[32:47]
  v_bfe_u32 v2, v1, 2, 2
  v_lshl_add_u32 v5, v2, 7, v5
  v_mfma_f32_32x32x16_bf16 a[48:63], a[180:183], v[112:115], a[48:63]
  ds_read_b128 a[180:183], v9 offset:40960
  v_exp_f32 v64, v64
  v_exp_f32 v65, v65
  v_add_f32 v60, v60, v64
  v_mfma_f32_32x32x16_bf16 a[64:79], a[184:187], v[96:99], a[64:79]
  v_lshrrev_b32 v2, 4, v1
  v_lshl_add_u32 v5, v2, 10, v5
  v_exp_f32 v66, v66
  v_add_f32 v60, v60, v65
  v_cvt_pk_bf16_f32 v64, v64, v65
  v_mfma_f32_32x32x16_bf16 a[80:95], a[184:187], v[112:115], a[80:95]
  ds_read_b128 a[184:187], v10 offset:40960
  v_exp_f32 v67, v67
  v_add_f32 v60, v60, v66
  v_exp_f32 v68, v68
  v_mfma_f32_32x32x16_bf16 a[96:111], a[188:191], v[96:99], a[96:111]
  v_bfe_u32 v2, v1, 3, 2
  v_lshl_add_u32 v5, v2, 5, v5
  v_add_f32 v60, v60, v67
  v_cvt_pk_bf16_f32 v65, v66, v67
  v_exp_f32 v69, v69
  v_mfma_f32_32x32x16_bf16 a[112:127], a[188:191], v[112:115], a[112:127]
  ds_read_b128 a[188:191], v11 offset:40960
  v_add_f32 v60, v60, v68
  v_exp_f32 v70, v70
  v_add_f32 v60, v60, v69
  v_cvt_pk_bf16_f32 v66, v68, v69
  s_waitcnt lgkmcnt(4)
  v_mfma_f32_32x32x16_bf16 a[0:15], a[192:195], v[104:107], a[0:15]
  v_add_u32 v28, s69, v5
  v_exp_f32 v71, v71
  v_add_f32 v60, v60, v70
  v_exp_f32 v80, v80
  v_mfma_f32_32x32x16_bf16 a[16:31], a[192:195], v[120:123], a[16:31]
  ds_read_b128 a[192:195], v12 offset:40960
  v_add_f32 v60, v60, v71
  v_cvt_pk_bf16_f32 v67, v70, v71
  v_exp_f32 v81, v81
  v_add_f32 v61, v61, v80
  v_mfma_f32_32x32x16_bf16 a[32:47], a[196:199], v[104:107], a[32:47]
  v_xor_b32 v29, 32, v28
  v_exp_f32 v82, v82
  v_add_f32 v61, v61, v81
  v_cvt_pk_bf16_f32 v80, v80, v81
  v_mfma_f32_32x32x16_bf16 a[48:63], a[196:199], v[120:123], a[48:63]
  ds_read_b128 a[196:199], v13 offset:40960
  v_exp_f32 v83, v83
  v_add_f32 v61, v61, v82
  v_exp_f32 v84, v84
  v_mfma_f32_32x32x16_bf16 a[64:79], a[200:203], v[104:107], a[64:79]
  v_add_f32 v61, v61, v83
  v_cvt_pk_bf16_f32 v81, v82, v83
  v_exp_f32 v85, v85
  v_add_f32 v61, v61, v84
  v_mfma_f32_32x32x16_bf16 a[80:95], a[200:203], v[120:123], a[80:95]
  ds_read_b128 a[200:203], v14 offset:40960
  v_exp_f32 v86, v86
  v_add_f32 v61, v61, v85
  v_cvt_pk_bf16_f32 v82, v84, v85
  v_mfma_f32_32x32x16_bf16 a[96:111], a[204:207], v[104:107], a[96:111]
  v_xor_b32 v30, 64, v28
  v_exp_f32 v87, v87
  v_add_f32 v61, v61, v86
  v_exp_f32 v72, v72
  v_mfma_f32_32x32x16_bf16 a[112:127], a[204:207], v[120:123], a[112:127]
  v_xor_b32 v31, 96, v28
  ds_read_b128 a[204:207], v15 offset:40960
  v_add_f32 v61, v61, v87
  v_cvt_pk_bf16_f32 v83, v86, v87
  v_exp_f32 v73, v73
  s_waitcnt lgkmcnt(4)
  v_mfma_f32_32x32x16_bf16 v[96:111], a[176:179], v[128:131], v[224:239]
  v_xor_b32 v8, 98304, v8
  v_add_f32 v60, v60, v72
  v_exp_f32 v74, v74
  v_add_f32 v60, v60, v73
  v_cvt_pk_bf16_f32 v72, v72, v73
  v_mfma_f32_32x32x16_bf16 v[112:127], a[176:179], v[136:139], v[240:255]
  ds_read_b64_tr_b16 a[176:177], v20 offset:12288
  v_exp_f32 v75, v75
  v_add_f32 v60, v60, v74
  v_exp_f32 v76, v76
  v_mfma_f32_32x32x16_bf16 v[96:111], a[180:183], v[132:135], v[96:111]
  ds_read_b64_tr_b16 a[178:179], v20 offset:13312
  v_xor_b32 v9, 98304, v9
  v_add_f32 v60, v60, v75
  v_cvt_pk_bf16_f32 v73, v74, v75
  v_exp_f32 v77, v77
  v_mfma_f32_32x32x16_bf16 v[112:127], a[180:183], v[140:143], v[112:127]
  ds_read_b64_tr_b16 a[180:181], v21 offset:12288
  v_add_f32 v60, v60, v76
  v_exp_f32 v78, v78
  v_add_f32 v60, v60, v77
  v_cvt_pk_bf16_f32 v74, v76, v77
  v_mfma_f32_32x32x16_bf16 v[96:111], a[184:187], v[144:147], v[96:111]
  ds_read_b64_tr_b16 a[182:183], v21 offset:13312
  v_xor_b32 v10, 98304, v10
  v_exp_f32 v79, v79
  v_add_f32 v60, v60, v78
  v_mfma_f32_32x32x16_bf16 v[112:127], a[184:187], v[152:155], v[112:127]
  ds_read_b64_tr_b16 a[184:185], v22 offset:12288
  v_exp_f32 v88, v88
  v_add_f32 v60, v60, v79
  v_cvt_pk_bf16_f32 v75, v78, v79
  v_mfma_f32_32x32x16_bf16 v[96:111], a[188:191], v[148:151], v[96:111]
  ds_read_b64_tr_b16 a[186:187], v22 offset:13312
  v_xor_b32 v11, 98304, v11
  v_exp_f32 v89, v89
  v_add_f32 v61, v61, v88
  v_mfma_f32_32x32x16_bf16 v[112:127], a[188:191], v[156:159], v[112:127]
  ds_read_b64_tr_b16 a[188:189], v23 offset:12288
  v_exp_f32 v90, v90
  v_add_f32 v61, v61, v89
  v_cvt_pk_bf16_f32 v88, v88, v89
  s_waitcnt lgkmcnt(7)
  v_mfma_f32_32x32x16_bf16 v[96:111], a[192:195], v[160:163], v[96:111]
  ds_read_b64_tr_b16 a[190:191], v23 offset:13312
  v_xor_b32 v12, 98304, v12
  v_exp_f32 v91, v91
  v_add_f32 v61, v61, v90
  v_mfma_f32_32x32x16_bf16 v[112:127], a[192:195], v[168:171], v[112:127]
  ds_read_b64_tr_b16 a[192:193], v20 offset:28672
  v_exp_f32 v92, v92
  v_add_f32 v61, v61, v91
  v_cvt_pk_bf16_f32 v89, v90, v91
  v_mfma_f32_32x32x16_bf16 v[96:111], a[196:199], v[164:167], v[96:111]
  ds_read_b64_tr_b16 a[194:195], v20 offset:29696
  v_xor_b32 v13, 98304, v13
  v_exp_f32 v93, v93
  v_add_f32 v61, v61, v92
  v_mfma_f32_32x32x16_bf16 v[112:127], a[196:199], v[172:175], v[112:127]
  ds_read_b64_tr_b16 a[196:197], v21 offset:28672
  v_exp_f32 v94, v94
  v_add_f32 v61, v61, v93
  v_cvt_pk_bf16_f32 v90, v92, v93
  v_mfma_f32_32x32x16_bf16 v[96:111], a[200:203], v[176:179], v[96:111]
  ds_read_b64_tr_b16 a[198:199], v21 offset:29696
  v_xor_b32 v14, 98304, v14
  v_exp_f32 v95, v95
  v_add_f32 v61, v61, v94
  v_add_f32 v61, v61, v95
  v_mfma_f32_32x32x16_bf16 v[112:127], a[200:203], v[184:187], v[112:127]
  ds_read_b64_tr_b16 a[200:201], v22 offset:28672
  v_cvt_pk_bf16_f32 v91, v94, v95
  v_mfma_f32_32x32x16_bf16 v[96:111], a[204:207], v[180:183], v[96:111]
  ds_read_b64_tr_b16 a[202:203], v22 offset:29696
  v_xor_b32 v15, 98304, v15
  v_mfma_f32_32x32x16_bf16 v[112:127], a[204:207], v[188:191], v[112:127]
  ds_read_b64_tr_b16 a[204:205], v23 offset:28672
  ds_read_b64_tr_b16 a[206:207], v23 offset:29696
  s_waitcnt lgkmcnt(8)
  v_mfma_f32_32x32x16_bf16 a[0:15], a[176:179], v[64:67], a[0:15]
  s_waitcnt vmcnt(9)
  s_barrier
  v_mfma_f32_32x32x16_bf16 a[16:31], a[176:179], v[80:83], a[16:31]
  ds_read_b128 a[176:179], v8 offset:0
  v_mfma_f32_32x32x16_bf16 a[32:47], a[180:183], v[64:67], a[32:47]
  s_add_u32 m0, s52, 0
  s_xor_b32 s54, s60, 65536
  buffer_load_dwordx4 v16, s[12:15], s54 offen offset:0 lds
  v_mfma_f32_32x32x16_bf16 a[48:63], a[180:183], v[80:83], a[48:63]
  ds_read_b128 a[180:183], v9 offset:0
  v_exp_f32 v96, v96
  v_exp_f32 v97, v97
  v_add_f32 v60, v60, v96
  v_mfma_f32_32x32x16_bf16 a[64:79], a[184:187], v[64:67], a[64:79]
  buffer_load_dwordx4 v17, s[12:15], s54 offen offset:1024 lds
  v_exp_f32 v98, v98
  v_add_f32 v60, v60, v97
  v_cvt_pk_bf16_f32 v96, v96, v97
  v_mfma_f32_32x32x16_bf16 a[80:95], a[184:187], v[80:83], a[80:95]
  ds_read_b128 a[184:187], v10 offset:0
  v_exp_f32 v99, v99
  v_add_f32 v60, v60, v98
  v_exp_f32 v100, v100
  v_mfma_f32_32x32x16_bf16 a[96:111], a[188:191], v[64:67], a[96:111]
  buffer_load_dwordx4 v18, s[12:15], s54 offen offset:2048 lds
  v_add_f32 v60, v60, v99
  v_cvt_pk_bf16_f32 v97, v98, v99
  v_exp_f32 v101, v101
  v_add_f32 v60, v60, v100
  v_mfma_f32_32x32x16_bf16 a[112:127], a[188:191], v[80:83], a[112:127]
  ds_read_b128 a[188:191], v11 offset:0
  v_exp_f32 v102, v102
  v_add_f32 v60, v60, v101
  v_cvt_pk_bf16_f32 v98, v100, v101
  s_waitcnt lgkmcnt(4)
  v_mfma_f32_32x32x16_bf16 a[0:15], a[192:195], v[72:75], a[0:15]
  buffer_load_dwordx4 v19, s[12:15], s54 offen offset:3072 lds
  v_exp_f32 v103, v103
  v_add_f32 v60, v60, v102
  v_exp_f32 v112, v112
  v_mfma_f32_32x32x16_bf16 a[16:31], a[192:195], v[88:91], a[16:31]
  ds_read_b128 a[192:195], v12 offset:0
  v_add_f32 v60, v60, v103
  v_cvt_pk_bf16_f32 v99, v102, v103
  v_exp_f32 v113, v113
  v_add_f32 v61, v61, v112
  v_mfma_f32_32x32x16_bf16 a[32:47], a[196:199], v[72:75], a[32:47]
  s_add_u32 m0, s52, 4096
  s_xor_b32 s54, s60, 65536
  buffer_load_dwordx4 v48, s[16:19], s54 offen offset:0 lds
  v_exp_f32 v114, v114
  v_add_f32 v61, v61, v113
  v_mfma_f32_32x32x16_bf16 a[48:63], a[196:199], v[88:91], a[48:63]
  ds_read_b128 a[196:199], v13 offset:0
  v_cvt_pk_bf16_f32 v112, v112, v113
  v_exp_f32 v115, v115
  v_add_f32 v61, v61, v114
  v_mfma_f32_32x32x16_bf16 a[64:79], a[200:203], v[72:75], a[64:79]
  buffer_load_dwordx4 v48, s[16:19], s54 offen offset:1024 lds
  v_exp_f32 v116, v116
  v_add_f32 v61, v61, v115
  v_cvt_pk_bf16_f32 v113, v114, v115
  v_mfma_f32_32x32x16_bf16 a[80:95], a[200:203], v[88:91], a[80:95]
  ds_read_b128 a[200:203], v14 offset:0
  v_exp_f32 v117, v117
  v_add_f32 v61, v61, v116
  v_exp_f32 v118, v118
  v_mfma_f32_32x32x16_bf16 a[96:111], a[204:207], v[72:75], a[96:111]
  buffer_load_dwordx4 v48, s[16:19], s54 offen offset:2048 lds
  v_add_f32 v61, v61, v117
  v_cvt_pk_bf16_f32 v114, v116, v117
  v_exp_f32 v119, v119
  v_add_f32 v61, v61, v118
  v_mfma_f32_32x32x16_bf16 a[112:127], a[204:207], v[88:91], a[112:127]
  buffer_load_dwordx4 v48, s[16:19], s54 offen offset:3072 lds
  ds_read_b128 a[204:207], v15 offset:0
  v_exp_f32 v104, v104
  v_add_f32 v61, v61, v119
  v_cvt_pk_bf16_f32 v115, v118, v119
  s_waitcnt lgkmcnt(4)
  v_mfma_f32_32x32x16_bf16 v[64:79], a[176:179], v[128:131], v[224:239]
  v_exp_f32 v105, v105
  v_add_f32 v60, v60, v104
  v_exp_f32 v106, v106
  v_add_f32 v60, v60, v105
  v_mfma_f32_32x32x16_bf16 v[80:95], a[176:179], v[136:139], v[240:255]
  ds_read_b64_tr_b16 a[176:177], v20 offset:45056
  v_cvt_pk_bf16_f32 v104, v104, v105
  v_exp_f32 v107, v107
  v_add_f32 v60, v60, v106
  v_mfma_f32_32x32x16_bf16 v[64:79], a[180:183], v[132:135], v[64:79]
  ds_read_b64_tr_b16 a[178:179], v20 offset:46080
  v_exp_f32 v108, v108
  v_add_f32 v60, v60, v107
  v_cvt_pk_bf16_f32 v105, v106, v107
  v_mfma_f32_32x32x16_bf16 v[80:95], a[180:183], v[140:143], v[80:95]
  ds_read_b64_tr_b16 a[180:181], v21 offset:45056
  v_exp_f32 v109, v109
  v_add_f32 v60, v60, v108
  v_exp_f32 v110, v110
  v_mfma_f32_32x32x16_bf16 v[64:79], a[184:187], v[144:147], v[64:79]
  ds_read_b64_tr_b16 a[182:183], v21 offset:46080
  v_add_f32 v60, v60, v109
  v_cvt_pk_bf16_f32 v106, v108, v109
  v_exp_f32 v111, v111
  v_add_f32 v60, v60, v110
  v_mfma_f32_32x32x16_bf16 v[80:95], a[184:187], v[152:155], v[80:95]
  ds_read_b64_tr_b16 a[184:185], v22 offset:45056
  v_exp_f32 v120, v120
  v_add_f32 v60, v60, v111
  v_cvt_pk_bf16_f32 v107, v110, v111
  v_mfma_f32_32x32x16_bf16 v[64:79], a[188:191], v[148:151], v[64:79]
  ds_read_b64_tr_b16 a[186:187], v22 offset:46080
  v_exp_f32 v121, v121
  v_add_f32 v61, v61, v120
  v_exp_f32 v122, v122
  v_mfma_f32_32x32x16_bf16 v[80:95], a[188:191], v[156:159], v[80:95]
  ds_read_b64_tr_b16 a[188:189], v23 offset:45056
  v_add_f32 v61, v61, v121
  v_cvt_pk_bf16_f32 v120, v120, v121
  v_exp_f32 v123, v123
  v_add_f32 v61, v61, v122
  s_waitcnt lgkmcnt(7)
  v_mfma_f32_32x32x16_bf16 v[64:79], a[192:195], v[160:163], v[64:79]
  ds_read_b64_tr_b16 a[190:191], v23 offset:46080
  v_exp_f32 v124, v124
  v_add_f32 v61, v61, v123
  v_cvt_pk_bf16_f32 v121, v122, v123
  v_mfma_f32_32x32x16_bf16 v[80:95], a[192:195], v[168:171], v[80:95]
  ds_read_b64_tr_b16 a[192:193], v20 offset:61440
  v_exp_f32 v125, v125
  v_add_f32 v61, v61, v124
  v_exp_f32 v126, v126
  v_mfma_f32_32x32x16_bf16 v[64:79], a[196:199], v[164:167], v[64:79]
  ds_read_b64_tr_b16 a[194:195], v20 offset:62464
  v_add_f32 v61, v61, v125
  v_cvt_pk_bf16_f32 v122, v124, v125
  v_exp_f32 v127, v127
  v_add_f32 v61, v61, v126
  v_mfma_f32_32x32x16_bf16 v[80:95], a[196:199], v[172:175], v[80:95]
  ds_read_b64_tr_b16 a[196:197], v21 offset:61440
  v_add_f32 v61, v61, v127
  v_cvt_pk_bf16_f32 v123, v126, v127
  v_mfma_f32_32x32x16_bf16 v[64:79], a[200:203], v[176:179], v[64:79]
  ds_read_b64_tr_b16 a[198:199], v21 offset:62464
  v_mfma_f32_32x32x16_bf16 v[80:95], a[200:203], v[184:187], v[80:95]
  ds_read_b64_tr_b16 a[200:201], v22 offset:61440
  v_mfma_f32_32x32x16_bf16 v[64:79], a[204:207], v[180:183], v[64:79]
  ds_read_b64_tr_b16 a[202:203], v22 offset:62464
  buffer_load_dword v6, off, s[80:83], s71 sc1
  v_mfma_f32_32x32x16_bf16 v[80:95], a[204:207], v[188:191], v[80:95]
  ds_read_b64_tr_b16 a[204:205], v23 offset:61440
  ds_read_b64_tr_b16 a[206:207], v23 offset:62464
  s_waitcnt lgkmcnt(8)
  v_mfma_f32_32x32x16_bf16 a[0:15], a[176:179], v[96:99], a[0:15]
  v_xor_b32 v20, 98304, v20
  v_mfma_f32_32x32x16_bf16 a[16:31], a[176:179], v[112:115], a[16:31]
  ds_read_b128 a[176:179], v8 offset:32768
  v_mfma_f32_32x32x16_bf16 a[32:47], a[180:183], v[96:99], a[32:47]
  v_xor_b32 v21, 98304, v21
  v_mfma_f32_32x32x16_bf16 a[48:63], a[180:183], v[112:115], a[48:63]
  ds_read_b128 a[180:183], v9 offset:32768
  v_exp_f32 v64, v64
  v_exp_f32 v65, v65
  v_add_f32 v60, v60, v64
  v_mfma_f32_32x32x16_bf16 a[64:79], a[184:187], v[96:99], a[64:79]
  v_xor_b32 v22, 98304, v22
  v_exp_f32 v66, v66
  v_add_f32 v60, v60, v65
  v_cvt_pk_bf16_f32 v64, v64, v65
  v_mfma_f32_32x32x16_bf16 a[80:95], a[184:187], v[112:115], a[80:95]
  ds_read_b128 a[184:187], v10 offset:32768
  v_exp_f32 v67, v67
  v_add_f32 v60, v60, v66
  v_exp_f32 v68, v68
  v_mfma_f32_32x32x16_bf16 a[96:111], a[188:191], v[96:99], a[96:111]
  v_xor_b32 v23, 98304, v23
  v_add_f32 v60, v60, v67
  v_cvt_pk_bf16_f32 v65, v66, v67
  v_exp_f32 v69, v69
  v_add_f32 v60, v60, v68
  v_mfma_f32_32x32x16_bf16 a[112:127], a[188:191], v[112:115], a[112:127]
  ds_read_b128 a[188:191], v11 offset:32768
  v_exp_f32 v70, v70
  v_add_f32 v60, v60, v69
  v_cvt_pk_bf16_f32 v66, v68, v69
  s_waitcnt lgkmcnt(4)
  v_mfma_f32_32x32x16_bf16 a[0:15], a[192:195], v[104:107], a[0:15]
  v_exp_f32 v71, v71
  v_add_f32 v60, v60, v70
  v_exp_f32 v80, v80
  v_add_f32 v60, v60, v71
  v_mfma_f32_32x32x16_bf16 a[16:31], a[192:195], v[120:123], a[16:31]
  ds_read_b128 a[192:195], v12 offset:32768
  v_cvt_pk_bf16_f32 v67, v70, v71
  v_exp_f32 v81, v81
  v_add_f32 v61, v61, v80
  v_mfma_f32_32x32x16_bf16 a[32:47], a[196:199], v[104:107], a[32:47]
  v_exp_f32 v82, v82
  v_add_f32 v61, v61, v81
  v_cvt_pk_bf16_f32 v80, v80, v81
  v_exp_f32 v83, v83
  v_mfma_f32_32x32x16_bf16 a[48:63], a[196:199], v[120:123], a[48:63]
  ds_read_b128 a[196:199], v13 offset:32768
  v_add_f32 v61, v61, v82
  v_exp_f32 v84, v84
  v_add_f32 v61, v61, v83
  v_cvt_pk_bf16_f32 v81, v82, v83
  v_mfma_f32_32x32x16_bf16 a[64:79], a[200:203], v[104:107], a[64:79]
  v_exp_f32 v85, v85
  v_add_f32 v61, v61, v84
  v_exp_f32 v86, v86
  v_add_f32 v61, v61, v85
  v_mfma_f32_32x32x16_bf16 a[80:95], a[200:203], v[120:123], a[80:95]
  ds_read_b128 a[200:203], v14 offset:32768
  v_cvt_pk_bf16_f32 v82, v84, v85
  v_exp_f32 v87, v87
  v_add_f32 v61, v61, v86
  v_mfma_f32_32x32x16_bf16 a[96:111], a[204:207], v[104:107], a[96:111]
  v_exp_f32 v72, v72
  v_add_f32 v61, v61, v87
  v_cvt_pk_bf16_f32 v83, v86, v87
  v_exp_f32 v73, v73
  v_mfma_f32_32x32x16_bf16 a[112:127], a[204:207], v[120:123], a[112:127]
  ds_read_b128 a[204:207], v15 offset:32768
  v_add_f32 v60, v60, v72
  v_exp_f32 v74, v74
  v_add_f32 v60, v60, v73
  v_cvt_pk_bf16_f32 v72, v72, v73
  s_waitcnt lgkmcnt(4)
  v_mfma_f32_32x32x16_bf16 v[96:111], a[176:179], v[128:131], v[224:239]
  v_exp_f32 v75, v75
  v_add_f32 v60, v60, v74
  v_exp_f32 v76, v76
  v_add_f32 v60, v60, v75
  v_mfma_f32_32x32x16_bf16 v[112:127], a[176:179], v[136:139], v[240:255]
  ds_read_b64_tr_b16 a[176:177], v20 offset:4096
  s_waitcnt vmcnt(0)
  v_cmp_gt_u32 vcc, 8, v6
  v_cvt_pk_bf16_f32 v73, v74, v75
  v_exp_f32 v77, v77
  v_add_f32 v60, v60, v76
  v_mfma_f32_32x32x16_bf16 v[96:111], a[180:183], v[132:135], v[96:111]
  ds_read_b64_tr_b16 a[178:179], v20 offset:5120
  v_exp_f32 v78, v78
  v_add_f32 v60, v60, v77
  v_cvt_pk_bf16_f32 v74, v76, v77
  v_mfma_f32_32x32x16_bf16 v[112:127], a[180:183], v[140:143], v[112:127]
  ds_read_b64_tr_b16 a[180:181], v21 offset:4096
  s_cbranch_vccnz Lspina
Lspina_ret:
  v_exp_f32 v79, v79
  v_add_f32 v60, v60, v78
  v_mfma_f32_32x32x16_bf16 v[96:111], a[184:187], v[144:147], v[96:111]
  ds_read_b64_tr_b16 a[182:183], v21 offset:5120
  v_exp_f32 v88, v88
  v_add_f32 v60, v60, v79
  v_cvt_pk_bf16_f32 v75, v78, v79
  v_mfma_f32_32x32x16_bf16 v[112:127], a[184:187], v[152:155], v[112:127]
  ds_read_b64_tr_b16 a[184:185], v22 offset:4096
  v_and_b32 v7, 7, v1
  v_exp_f32 v89, v89
  v_add_f32 v61, v61, v88
  v_mfma_f32_32x32x16_bf16 v[96:111], a[188:191], v[148:151], v[96:111]
  ds_read_b64_tr_b16 a[186:187], v22 offset:5120
  v_exp_f32 v90, v90
  v_add_f32 v61, v61, v89
  v_cvt_pk_bf16_f32 v88, v88, v89
  v_mfma_f32_32x32x16_bf16 v[112:127], a[188:191], v[156:159], v[112:127]
  ds_read_b64_tr_b16 a[188:189], v23 offset:4096
  v_lshlrev_b32 v7, 2, v7
  v_exp_f32 v91, v91
  v_add_f32 v61, v61, v90
  s_waitcnt lgkmcnt(7)
  v_mfma_f32_32x32x16_bf16 v[96:111], a[192:195], v[160:163], v[96:111]
  ds_read_b64_tr_b16 a[190:191], v23 offset:5120
  v_exp_f32 v92, v92
  v_add_f32 v61, v61, v91
  v_cvt_pk_bf16_f32 v89, v90, v91
  v_mfma_f32_32x32x16_bf16 v[112:127], a[192:195], v[168:171], v[112:127]
  ds_read_b64_tr_b16 a[192:193], v20 offset:20480
  v_exp_f32 v93, v93
  v_add_f32 v61, v61, v92
  v_exp_f32 v94, v94
  v_mfma_f32_32x32x16_bf16 v[96:111], a[196:199], v[164:167], v[96:111]
  ds_read_b64_tr_b16 a[194:195], v20 offset:21504
  v_add_f32 v61, v61, v93
  v_cvt_pk_bf16_f32 v90, v92, v93
  v_exp_f32 v95, v95
  v_add_f32 v61, v61, v94
  v_mfma_f32_32x32x16_bf16 v[112:127], a[196:199], v[172:175], v[112:127]
  ds_read_b64_tr_b16 a[196:197], v21 offset:20480
  v_add_f32 v61, v61, v95
  v_cvt_pk_bf16_f32 v91, v94, v95
  v_mfma_f32_32x32x16_bf16 v[96:111], a[200:203], v[176:179], v[96:111]
  ds_read_b64_tr_b16 a[198:199], v21 offset:21504
  v_mfma_f32_32x32x16_bf16 v[112:127], a[200:203], v[184:187], v[112:127]
  ds_read_b64_tr_b16 a[200:201], v22 offset:20480
  v_mfma_f32_32x32x16_bf16 v[96:111], a[204:207], v[180:183], v[96:111]
  ds_read_b64_tr_b16 a[202:203], v22 offset:21504
  v_mfma_f32_32x32x16_bf16 v[112:127], a[204:207], v[188:191], v[112:127]
  ds_read_b64_tr_b16 a[204:205], v23 offset:20480
  ds_read_b64_tr_b16 a[206:207], v23 offset:21504
  s_waitcnt lgkmcnt(8)
  v_mfma_f32_32x32x16_bf16 a[0:15], a[176:179], v[64:67], a[0:15]
  s_barrier
  v_mfma_f32_32x32x16_bf16 a[16:31], a[176:179], v[80:83], a[16:31]
  ds_read_b128 a[176:179], v8 offset:8192
  v_mfma_f32_32x32x16_bf16 a[32:47], a[180:183], v[64:67], a[32:47]
  s_add_u32 m0, s52, 8192
  s_xor_b32 s54, s60, 81920
  buffer_load_dwordx4 v16, s[12:15], s54 offen offset:0 lds
  v_mfma_f32_32x32x16_bf16 a[48:63], a[180:183], v[80:83], a[48:63]
  ds_read_b128 a[180:183], v9 offset:8192
  v_exp_f32 v96, v96
  v_exp_f32 v97, v97
  v_add_f32 v60, v60, v96
  v_mfma_f32_32x32x16_bf16 a[64:79], a[184:187], v[64:67], a[64:79]
  buffer_load_dwordx4 v17, s[12:15], s54 offen offset:1024 lds
  v_exp_f32 v98, v98
  v_add_f32 v60, v60, v97
  v_cvt_pk_bf16_f32 v96, v96, v97
  v_mfma_f32_32x32x16_bf16 a[80:95], a[184:187], v[80:83], a[80:95]
  ds_read_b128 a[184:187], v10 offset:8192
  v_exp_f32 v99, v99
  v_add_f32 v60, v60, v98
  v_exp_f32 v100, v100
  v_mfma_f32_32x32x16_bf16 a[96:111], a[188:191], v[64:67], a[96:111]
  buffer_load_dwordx4 v18, s[12:15], s54 offen offset:2048 lds
  v_add_f32 v60, v60, v99
  v_cvt_pk_bf16_f32 v97, v98, v99
  v_exp_f32 v101, v101
  v_add_f32 v60, v60, v100
  v_mfma_f32_32x32x16_bf16 a[112:127], a[188:191], v[80:83], a[112:127]
  ds_read_b128 a[188:191], v11 offset:8192
  v_exp_f32 v102, v102
  v_add_f32 v60, v60, v101
  v_cvt_pk_bf16_f32 v98, v100, v101
  s_waitcnt lgkmcnt(4)
  v_mfma_f32_32x32x16_bf16 a[0:15], a[192:195], v[72:75], a[0:15]
  buffer_load_dwordx4 v19, s[12:15], s54 offen offset:3072 lds
  v_exp_f32 v103, v103
  v_add_f32 v60, v60, v102
  v_exp_f32 v112, v112
  v_mfma_f32_32x32x16_bf16 a[16:31], a[192:195], v[88:91], a[16:31]
  ds_read_b128 a[192:195], v12 offset:8192
  v_add_f32 v60, v60, v103
  v_cvt_pk_bf16_f32 v99, v102, v103
  v_exp_f32 v113, v113
  v_add_f32 v61, v61, v112
  v_mfma_f32_32x32x16_bf16 a[32:47], a[196:199], v[72:75], a[32:47]
  s_add_u32 m0, s52, 12288
  s_xor_b32 s54, s60, 81920
  buffer_load_dwordx4 v48, s[16:19], s54 offen offset:0 lds
  v_exp_f32 v114, v114
  v_add_f32 v61, v61, v113
  v_mfma_f32_32x32x16_bf16 a[48:63], a[196:199], v[88:91], a[48:63]
  ds_read_b128 a[196:199], v13 offset:8192
  v_cvt_pk_bf16_f32 v112, v112, v113
  v_exp_f32 v115, v115
  v_add_f32 v61, v61, v114
  v_mfma_f32_32x32x16_bf16 a[64:79], a[200:203], v[72:75], a[64:79]
  buffer_load_dwordx4 v48, s[16:19], s54 offen offset:1024 lds
  v_exp_f32 v116, v116
  v_add_f32 v61, v61, v115
  v_cvt_pk_bf16_f32 v113, v114, v115
  v_mfma_f32_32x32x16_bf16 a[80:95], a[200:203], v[88:91], a[80:95]
  ds_read_b128 a[200:203], v14 offset:8192
  v_exp_f32 v117, v117
  v_add_f32 v61, v61, v116
  v_exp_f32 v118, v118
  v_mfma_f32_32x32x16_bf16 a[96:111], a[204:207], v[72:75], a[96:111]
  buffer_load_dwordx4 v48, s[16:19], s54 offen offset:2048 lds
  v_add_f32 v61, v61, v117
  v_cvt_pk_bf16_f32 v114, v116, v117
  v_exp_f32 v119, v119
  v_add_f32 v61, v61, v118
  v_mfma_f32_32x32x16_bf16 a[112:127], a[204:207], v[88:91], a[112:127]
  buffer_load_dwordx4 v48, s[16:19], s54 offen offset:3072 lds
  ds_read_b128 a[204:207], v15 offset:8192
  v_exp_f32 v104, v104
  v_add_f32 v61, v61, v119
  v_cvt_pk_bf16_f32 v115, v118, v119
  s_waitcnt lgkmcnt(4)
  v_mfma_f32_32x32x16_bf16 v[64:79], a[176:179], v[128:131], v[224:239]
  v_exp_f32 v105, v105
  v_add_f32 v60, v60, v104
  v_exp_f32 v106, v106
  v_add_f32 v60, v60, v105
  v_mfma_f32_32x32x16_bf16 v[80:95], a[176:179], v[136:139], v[240:255]
  ds_read_b64_tr_b16 a[176:177], v20 offset:36864
  v_cvt_pk_bf16_f32 v104, v104, v105
  v_exp_f32 v107, v107
  v_add_f32 v60, v60, v106
  v_mfma_f32_32x32x16_bf16 v[64:79], a[180:183], v[132:135], v[64:79]
  ds_read_b64_tr_b16 a[178:179], v20 offset:37888
  v_exp_f32 v108, v108
  v_add_f32 v60, v60, v107
  v_cvt_pk_bf16_f32 v105, v106, v107
  v_mfma_f32_32x32x16_bf16 v[80:95], a[180:183], v[140:143], v[80:95]
  ds_read_b64_tr_b16 a[180:181], v21 offset:36864
  v_exp_f32 v109, v109
  v_add_f32 v60, v60, v108
  v_exp_f32 v110, v110
  v_mfma_f32_32x32x16_bf16 v[64:79], a[184:187], v[144:147], v[64:79]
  ds_read_b64_tr_b16 a[182:183], v21 offset:37888
  v_add_f32 v60, v60, v109
  v_cvt_pk_bf16_f32 v106, v108, v109
  v_exp_f32 v111, v111
  v_add_f32 v60, v60, v110
  v_mfma_f32_32x32x16_bf16 v[80:95], a[184:187], v[152:155], v[80:95]
  ds_read_b64_tr_b16 a[184:185], v22 offset:36864
  v_exp_f32 v120, v120
  v_add_f32 v60, v60, v111
  v_cvt_pk_bf16_f32 v107, v110, v111
  v_mfma_f32_32x32x16_bf16 v[64:79], a[188:191], v[148:151], v[64:79]
  ds_read_b64_tr_b16 a[186:187], v22 offset:37888
  v_exp_f32 v121, v121
  v_add_f32 v61, v61, v120
  v_exp_f32 v122, v122
  v_mfma_f32_32x32x16_bf16 v[80:95], a[188:191], v[156:159], v[80:95]
  ds_read_b64_tr_b16 a[188:189], v23 offset:36864
  v_add_f32 v61, v61, v121
  v_cvt_pk_bf16_f32 v120, v120, v121
  v_exp_f32 v123, v123
  v_add_f32 v61, v61, v122
  s_waitcnt lgkmcnt(7)
  v_mfma_f32_32x32x16_bf16 v[64:79], a[192:195], v[160:163], v[64:79]
  ds_read_b64_tr_b16 a[190:191], v23 offset:37888
  v_exp_f32 v124, v124
  v_add_f32 v61, v61, v123
  v_cvt_pk_bf16_f32 v121, v122, v123
  v_mfma_f32_32x32x16_bf16 v[80:95], a[192:195], v[168:171], v[80:95]
  ds_read_b64_tr_b16 a[192:193], v20 offset:53248
  v_exp_f32 v125, v125
  v_add_f32 v61, v61, v124
  v_exp_f32 v126, v126
  v_mfma_f32_32x32x16_bf16 v[64:79], a[196:199], v[164:167], v[64:79]
  ds_read_b64_tr_b16 a[194:195], v20 offset:54272
  v_add_f32 v61, v61, v125
  v_cvt_pk_bf16_f32 v122, v124, v125
  v_exp_f32 v127, v127
  v_add_f32 v61, v61, v126
  v_mfma_f32_32x32x16_bf16 v[80:95], a[196:199], v[172:175], v[80:95]
  ds_read_b64_tr_b16 a[196:197], v21 offset:53248
  v_add_f32 v61, v61, v127
  v_cvt_pk_bf16_f32 v123, v126, v127
  v_mfma_f32_32x32x16_bf16 v[64:79], a[200:203], v[176:179], v[64:79]
  ds_read_b64_tr_b16 a[198:199], v21 offset:54272
  v_mfma_f32_32x32x16_bf16 v[80:95], a[200:203], v[184:187], v[80:95]
  ds_read_b64_tr_b16 a[200:201], v22 offset:53248
  v_mfma_f32_32x32x16_bf16 v[64:79], a[204:207], v[180:183], v[64:79]
  ds_read_b64_tr_b16 a[202:203], v22 offset:54272
  buffer_load_dword v6, v7, s[76:79], s94 offen sc1
  v_mfma_f32_32x32x16_bf16 v[80:95], a[204:207], v[188:191], v[80:95]
  ds_read_b64_tr_b16 a[204:205], v23 offset:53248
  ds_read_b64_tr_b16 a[206:207], v23 offset:54272
  s_waitcnt lgkmcnt(8)
  v_mfma_f32_32x32x16_bf16 a[0:15], a[176:179], v[96:99], a[0:15]
  s_add_u32 m0, s69, 0
  s_add_u32 s54, s59, 0
  s_sub_u32 s3, s54, 458752
  s_min_u32 s54, s54, s3
  buffer_load_dwordx4 v38, s[36:39], s54 offen offset:0 lds
  v_mfma_f32_32x32x16_bf16 a[16:31], a[176:179], v[112:115], a[16:31]
  ds_read_b128 a[176:179], v8 offset:40960
  v_mfma_f32_32x32x16_bf16 a[32:47], a[180:183], v[96:99], a[32:47]
  buffer_load_dwordx4 v39, s[36:39], s54 offen offset:1024 lds
  v_mfma_f32_32x32x16_bf16 a[48:63], a[180:183], v[112:115], a[48:63]
  ds_read_b128 a[180:183], v9 offset:40960
  v_exp_f32 v64, v64
  v_exp_f32 v65, v65
  v_add_f32 v60, v60, v64
  v_mfma_f32_32x32x16_bf16 a[64:79], a[184:187], v[96:99], a[64:79]
  buffer_load_dwordx4 v40, s[36:39], s54 offen offset:2048 lds
  v_exp_f32 v66, v66
  v_add_f32 v60, v60, v65
  v_cvt_pk_bf16_f32 v64, v64, v65
  v_mfma_f32_32x32x16_bf16 a[80:95], a[184:187], v[112:115], a[80:95]
  ds_read_b128 a[184:187], v10 offset:40960
  v_exp_f32 v67, v67
  v_add_f32 v60, v60, v66
  v_exp_f32 v68, v68
  v_mfma_f32_32x32x16_bf16 a[96:111], a[188:191], v[96:99], a[96:111]
  buffer_load_dwordx4 v41, s[36:39], s54 offen offset:3072 lds
  v_add_f32 v60, v60, v67
  v_cvt_pk_bf16_f32 v65, v66, v67
  v_exp_f32 v69, v69
  v_add_f32 v60, v60, v68
  v_mfma_f32_32x32x16_bf16 a[112:127], a[188:191], v[112:115], a[112:127]
  ds_read_b128 a[188:191], v11 offset:40960
  v_exp_f32 v70, v70
  v_add_f32 v60, v60, v69
  v_cvt_pk_bf16_f32 v66, v68, v69
  s_waitcnt lgkmcnt(4)
  v_mfma_f32_32x32x16_bf16 a[0:15], a[192:195], v[104:107], a[0:15]
  s_add_u32 m0, s69, 4096
  s_add_u32 s54, s59, 32768
  s_sub_u32 s3, s54, 458752
  s_min_u32 s54, s54, s3
  buffer_load_dwordx4 v38, s[36:39], s54 offen offset:0 lds
  v_mfma_f32_32x32x16_bf16 a[16:31], a[192:195], v[120:123], a[16:31]
  ds_read_b128 a[192:195], v12 offset:40960
  v_exp_f32 v71, v71
  v_add_f32 v60, v60, v70
  v_exp_f32 v80, v80
  v_mfma_f32_32x32x16_bf16 a[32:47], a[196:199], v[104:107], a[32:47]
  buffer_load_dwordx4 v39, s[36:39], s54 offen offset:1024 lds
  v_add_f32 v60, v60, v71
  v_cvt_pk_bf16_f32 v67, v70, v71
  v_exp_f32 v81, v81
  v_add_f32 v61, v61, v80
  v_mfma_f32_32x32x16_bf16 a[48:63], a[196:199], v[120:123], a[48:63]
  ds_read_b128 a[196:199], v13 offset:40960
  v_exp_f32 v82, v82
  v_add_f32 v61, v61, v81
  v_cvt_pk_bf16_f32 v80, v80, v81
  v_mfma_f32_32x32x16_bf16 a[64:79], a[200:203], v[104:107], a[64:79]
  v_exp_f32 v83, v83
  v_add_f32 v61, v61, v82
  v_exp_f32 v84, v84
  v_add_f32 v61, v61, v83
  v_mfma_f32_32x32x16_bf16 a[80:95], a[200:203], v[120:123], a[80:95]
  ds_read_b128 a[200:203], v14 offset:40960
  v_cvt_pk_bf16_f32 v81, v82, v83
  v_exp_f32 v85, v85
  v_add_f32 v61, v61, v84
  v_mfma_f32_32x32x16_bf16 a[96:111], a[204:207], v[104:107], a[96:111]
  buffer_load_dwordx4 v40, s[36:39], s54 offen offset:2048 lds
  v_exp_f32 v86, v86
  v_add_f32 v61, v61, v85
  v_cvt_pk_bf16_f32 v82, v84, v85
  v_mfma_f32_32x32x16_bf16 a[112:127], a[204:207], v[120:123], a[112:127]
  buffer_load_dwordx4 v41, s[36:39], s54 offen offset:3072 lds
  ds_read_b128 a[204:207], v15 offset:40960
  v_exp_f32 v87, v87
  v_add_f32 v61, v61, v86
  s_waitcnt lgkmcnt(4)
  v_mfma_f32_32x32x16_bf16 v[96:111], a[176:179], v[128:131], v[224:239]
  v_xor_b32 v8, 98304, v8
  v_exp_f32 v72, v72
  v_add_f32 v61, v61, v87
  v_cvt_pk_bf16_f32 v83, v86, v87
  v_mfma_f32_32x32x16_bf16 v[112:127], a[176:179], v[136:139], v[240:255]
  ds_read_b64_tr_b16 a[176:177], v20 offset:12288
  s_waitcnt vmcnt(8)
  v_cmp_ne_u32 vcc, 1, v6
  v_exp_f32 v73, v73
  v_add_f32 v60, v60, v72
  v_mfma_f32_32x32x16_bf16 v[96:111], a[180:183], v[132:135], v[96:111]
  ds_read_b64_tr_b16 a[178:179], v20 offset:13312
  v_xor_b32 v9, 98304, v9
  v_exp_f32 v74, v74
  v_add_f32 v60, v60, v73
  v_cvt_pk_bf16_f32 v72, v72, v73
  v_mfma_f32_32x32x16_bf16 v[112:127], a[180:183], v[140:143], v[112:127]
  ds_read_b64_tr_b16 a[180:181], v21 offset:12288
  s_cbranch_vccnz Lspinb
Lspinb_ret:
  v_exp_f32 v75, v75
  v_add_f32 v60, v60, v74
  v_mfma_f32_32x32x16_bf16 v[96:111], a[184:187], v[144:147], v[96:111]
  ds_read_b64_tr_b16 a[182:183], v21 offset:13312
  v_xor_b32 v10, 98304, v10
  v_exp_f32 v76, v76
  v_add_f32 v60, v60, v75
  v_cvt_pk_bf16_f32 v73, v74, v75
  v_mfma_f32_32x32x16_bf16 v[112:127], a[184:187], v[152:155], v[112:127]
  ds_read_b64_tr_b16 a[184:185], v22 offset:12288
  v_exp_f32 v77, v77
  v_add_f32 v60, v60, v76
  v_exp_f32 v78, v78
  v_mfma_f32_32x32x16_bf16 v[96:111], a[188:191], v[148:151], v[96:111]
  ds_read_b64_tr_b16 a[186:187], v22 offset:13312
  v_xor_b32 v11, 98304, v11
  v_add_f32 v60, v60, v77
  v_cvt_pk_bf16_f32 v74, v76, v77
  v_exp_f32 v79, v79
  v_mfma_f32_32x32x16_bf16 v[112:127], a[188:191], v[156:159], v[112:127]
  ds_read_b64_tr_b16 a[188:189], v23 offset:12288
  v_add_f32 v60, v60, v78
  v_exp_f32 v88, v88
  v_add_f32 v60, v60, v79
  v_cvt_pk_bf16_f32 v75, v78, v79
  s_waitcnt lgkmcnt(7)
  v_mfma_f32_32x32x16_bf16 v[96:111], a[192:195], v[160:163], v[96:111]
  ds_read_b64_tr_b16 a[190:191], v23 offset:13312
  v_xor_b32 v12, 98304, v12
  v_exp_f32 v89, v89
  v_add_f32 v61, v61, v88
  v_mfma_f32_32x32x16_bf16 v[112:127], a[192:195], v[168:171], v[112:127]
  ds_read_b64_tr_b16 a[192:193], v20 offset:28672
  v_exp_f32 v90, v90
  v_add_f32 v61, v61, v89
  v_cvt_pk_bf16_f32 v88, v88, v89
  v_mfma_f32_32x32x16_bf16 v[96:111], a[196:199], v[164:167], v[96:111]
  ds_read_b64_tr_b16 a[194:195], v20 offset:29696
  v_xor_b32 v13, 98304, v13
  v_exp_f32 v91, v91
  v_add_f32 v61, v61, v90
  v_mfma_f32_32x32x16_bf16 v[112:127], a[196:199], v[172:175], v[112:127]
  ds_read_b64_tr_b16 a[196:197], v21 offset:28672
  v_exp_f32 v92, v92
  v_add_f32 v61, v61, v91
  v_cvt_pk_bf16_f32 v89, v90, v91
  v_mfma_f32_32x32x16_bf16 v[96:111], a[200:203], v[176:179], v[96:111]
  ds_read_b64_tr_b16 a[198:199], v21 offset:29696
  v_xor_b32 v14, 98304, v14
  v_exp_f32 v93, v93
  v_add_f32 v61, v61, v92
  v_mfma_f32_32x32x16_bf16 v[112:127], a[200:203], v[184:187], v[112:127]
  ds_read_b64_tr_b16 a[200:201], v22 offset:28672
  v_exp_f32 v94, v94
  v_add_f32 v61, v61, v93
  v_cvt_pk_bf16_f32 v90, v92, v93
  v_mfma_f32_32x32x16_bf16 v[96:111], a[204:207], v[180:183], v[96:111]
  ds_read_b64_tr_b16 a[202:203], v22 offset:29696
  v_xor_b32 v15, 98304, v15
  v_exp_f32 v95, v95
  v_add_f32 v61, v61, v94
  v_add_f32 v61, v61, v95
  v_mfma_f32_32x32x16_bf16 v[112:127], a[204:207], v[188:191], v[112:127]
  ds_read_b64_tr_b16 a[204:205], v23 offset:28672
  ds_read_b64_tr_b16 a[206:207], v23 offset:29696
  v_cvt_pk_bf16_f32 v91, v94, v95
  s_waitcnt lgkmcnt(8)
  v_mfma_f32_32x32x16_bf16 a[0:15], a[176:179], v[64:67], a[0:15]
  s_barrier
  v_mfma_f32_32x32x16_bf16 a[16:31], a[176:179], v[80:83], a[16:31]
  ds_read_b128 a[176:179], v8 offset:0
  v_mfma_f32_32x32x16_bf16 a[32:47], a[180:183], v[64:67], a[32:47]
  s_add_u32 m0, s53, 0
  s_xor_b32 s54, s60, 98304
  buffer_load_dwordx4 v16, s[12:15], s54 offen offset:0 lds
  v_mfma_f32_32x32x16_bf16 a[48:63], a[180:183], v[80:83], a[48:63]
  ds_read_b128 a[180:183], v9 offset:0
  v_exp_f32 v96, v96
  v_exp_f32 v97, v97
  v_add_f32 v60, v60, v96
  v_mfma_f32_32x32x16_bf16 a[64:79], a[184:187], v[64:67], a[64:79]
  buffer_load_dwordx4 v17, s[12:15], s54 offen offset:1024 lds
  v_exp_f32 v98, v98
  v_add_f32 v60, v60, v97
  v_cvt_pk_bf16_f32 v96, v96, v97
  v_mfma_f32_32x32x16_bf16 a[80:95], a[184:187], v[80:83], a[80:95]
  ds_read_b128 a[184:187], v10 offset:0
  v_exp_f32 v99, v99
  v_add_f32 v60, v60, v98
  v_exp_f32 v100, v100
  v_mfma_f32_32x32x16_bf16 a[96:111], a[188:191], v[64:67], a[96:111]
  buffer_load_dwordx4 v18, s[12:15], s54 offen offset:2048 lds
  v_add_f32 v60, v60, v99
  v_cvt_pk_bf16_f32 v97, v98, v99
  v_exp_f32 v101, v101
  v_add_f32 v60, v60, v100
  v_mfma_f32_32x32x16_bf16 a[112:127], a[188:191], v[80:83], a[112:127]
  ds_read_b128 a[188:191], v11 offset:0
  v_exp_f32 v102, v102
  v_add_f32 v60, v60, v101
  v_cvt_pk_bf16_f32 v98, v100, v101
  s_waitcnt lgkmcnt(4)
  v_mfma_f32_32x32x16_bf16 a[0:15], a[192:195], v[72:75], a[0:15]
  buffer_load_dwordx4 v19, s[12:15], s54 offen offset:3072 lds
  v_exp_f32 v103, v103
  v_add_f32 v60, v60, v102
  v_exp_f32 v112, v112
  v_mfma_f32_32x32x16_bf16 a[16:31], a[192:195], v[88:91], a[16:31]
  ds_read_b128 a[192:195], v12 offset:0
  v_add_f32 v60, v60, v103
  v_cvt_pk_bf16_f32 v99, v102, v103
  v_exp_f32 v113, v113
  v_add_f32 v61, v61, v112
  v_mfma_f32_32x32x16_bf16 a[32:47], a[196:199], v[72:75], a[32:47]
  s_add_u32 m0, s53, 4096
  s_xor_b32 s54, s60, 98304
  buffer_load_dwordx4 v48, s[16:19], s54 offen offset:0 lds
  v_exp_f32 v114, v114
  v_add_f32 v61, v61, v113
  v_mfma_f32_32x32x16_bf16 a[48:63], a[196:199], v[88:91], a[48:63]
  ds_read_b128 a[196:199], v13 offset:0
  v_cvt_pk_bf16_f32 v112, v112, v113
  v_exp_f32 v115, v115
  v_add_f32 v61, v61, v114
  v_mfma_f32_32x32x16_bf16 a[64:79], a[200:203], v[72:75], a[64:79]
  buffer_load_dwordx4 v48, s[16:19], s54 offen offset:1024 lds
  v_exp_f32 v116, v116
  v_add_f32 v61, v61, v115
  v_cvt_pk_bf16_f32 v113, v114, v115
  v_mfma_f32_32x32x16_bf16 a[80:95], a[200:203], v[88:91], a[80:95]
  ds_read_b128 a[200:203], v14 offset:0
  v_exp_f32 v117, v117
  v_add_f32 v61, v61, v116
  v_exp_f32 v118, v118
  v_mfma_f32_32x32x16_bf16 a[96:111], a[204:207], v[72:75], a[96:111]
  buffer_load_dwordx4 v48, s[16:19], s54 offen offset:2048 lds
  v_add_f32 v61, v61, v117
  v_cvt_pk_bf16_f32 v114, v116, v117
  v_exp_f32 v119, v119
  v_add_f32 v61, v61, v118
  v_mfma_f32_32x32x16_bf16 a[112:127], a[204:207], v[88:91], a[112:127]
  buffer_load_dwordx4 v48, s[16:19], s54 offen offset:3072 lds
  ds_read_b128 a[204:207], v15 offset:0
  v_exp_f32 v104, v104
  v_add_f32 v61, v61, v119
  v_cvt_pk_bf16_f32 v115, v118, v119
  s_waitcnt lgkmcnt(4)
  v_mfma_f32_32x32x16_bf16 v[64:79], a[176:179], v[128:131], v[224:239]
  v_exp_f32 v105, v105
  v_add_f32 v60, v60, v104
  v_exp_f32 v106, v106
  v_add_f32 v60, v60, v105
  v_mfma_f32_32x32x16_bf16 v[80:95], a[176:179], v[136:139], v[240:255]
  ds_read_b64_tr_b16 a[176:177], v20 offset:45056
  v_cvt_pk_bf16_f32 v104, v104, v105
  v_exp_f32 v107, v107
  v_add_f32 v60, v60, v106
  v_mfma_f32_32x32x16_bf16 v[64:79], a[180:183], v[132:135], v[64:79]
  ds_read_b64_tr_b16 a[178:179], v20 offset:46080
  s_add_u32 s55, s68, 20480
  s_sub_u32 s3, s55, 57344
  s_min_u32 s55, s55, s3
  buffer_load_dwordx4 v[192:195], v46, s[84:87], s55 offen offset:0 sc1
  v_mfma_f32_32x32x16_bf16 v[80:95], a[180:183], v[140:143], v[80:95]
  ds_read_b64_tr_b16 a[180:181], v21 offset:45056
  v_exp_f32 v108, v108
  v_add_f32 v60, v60, v107
  v_cvt_pk_bf16_f32 v105, v106, v107
  v_mfma_f32_32x32x16_bf16 v[64:79], a[184:187], v[144:147], v[64:79]
  ds_read_b64_tr_b16 a[182:183], v21 offset:46080
  v_exp_f32 v109, v109
  v_add_f32 v60, v60, v108
  v_exp_f32 v110, v110
  v_mfma_f32_32x32x16_bf16 v[80:95], a[184:187], v[152:155], v[80:95]
  ds_read_b64_tr_b16 a[184:185], v22 offset:45056
  v_add_f32 v60, v60, v109
  v_cvt_pk_bf16_f32 v106, v108, v109
  v_exp_f32 v111, v111
  v_add_f32 v60, v60, v110
  v_mfma_f32_32x32x16_bf16 v[64:79], a[188:191], v[148:151], v[64:79]
  ds_read_b64_tr_b16 a[186:187], v22 offset:46080
  buffer_load_dwordx4 v[196:199], v46, s[84:87], s55 offen offset:1024 sc1
  v_exp_f32 v120, v120
  v_add_f32 v60, v60, v111
  v_cvt_pk_bf16_f32 v107, v110, v111
  v_mfma_f32_32x32x16_bf16 v[80:95], a[188:191], v[156:159], v[80:95]
  ds_read_b64_tr_b16 a[188:189], v23 offset:45056
  v_exp_f32 v121, v121
  v_add_f32 v61, v61, v120
  v_exp_f32 v122, v122
  s_waitcnt lgkmcnt(7)
  v_mfma_f32_32x32x16_bf16 v[64:79], a[192:195], v[160:163], v[64:79]
  ds_read_b64_tr_b16 a[190:191], v23 offset:46080
  v_add_f32 v61, v61, v121
  v_cvt_pk_bf16_f32 v120, v120, v121
  v_exp_f32 v123, v123
  v_add_f32 v61, v61, v122
  v_mfma_f32_32x32x16_bf16 v[80:95], a[192:195], v[168:171], v[80:95]
  ds_read_b64_tr_b16 a[192:193], v20 offset:61440
  v_exp_f32 v124, v124
  v_add_f32 v61, v61, v123
  v_cvt_pk_bf16_f32 v121, v122, v123
  v_mfma_f32_32x32x16_bf16 v[64:79], a[196:199], v[164:167], v[64:79]
  ds_read_b64_tr_b16 a[194:195], v20 offset:62464
  buffer_load_dwordx4 v[200:203], v46, s[84:87], s55 offen offset:2048 sc1
  v_exp_f32 v125, v125
  v_add_f32 v61, v61, v124
  v_mfma_f32_32x32x16_bf16 v[80:95], a[196:199], v[172:175], v[80:95]
  ds_read_b64_tr_b16 a[196:197], v21 offset:61440
  v_exp_f32 v126, v126
  v_add_f32 v61, v61, v125
  v_cvt_pk_bf16_f32 v122, v124, v125
  v_mfma_f32_32x32x16_bf16 v[64:79], a[200:203], v[176:179], v[64:79]
  ds_read_b64_tr_b16 a[198:199], v21 offset:62464
  v_exp_f32 v127, v127
  v_add_f32 v61, v61, v126
  v_add_f32 v61, v61, v127
  v_cvt_pk_bf16_f32 v123, v126, v127
  v_mfma_f32_32x32x16_bf16 v[80:95], a[200:203], v[184:187], v[80:95]
  ds_read_b64_tr_b16 a[200:201], v22 offset:61440
  v_mfma_f32_32x32x16_bf16 v[64:79], a[204:207], v[180:183], v[64:79]
  ds_read_b64_tr_b16 a[202:203], v22 offset:62464
  v_mfma_f32_32x32x16_bf16 v[80:95], a[204:207], v[188:191], v[80:95]
  ds_read_b64_tr_b16 a[204:205], v23 offset:61440
  ds_read_b64_tr_b16 a[206:207], v23 offset:62464
  s_waitcnt lgkmcnt(8)
  v_mfma_f32_32x32x16_bf16 a[0:15], a[176:179], v[96:99], a[0:15]
  buffer_load_dwordx4 v[204:207], v46, s[84:87], s55 offen offset:3072 sc1
  v_xor_b32 v20, 98304, v20
  v_mfma_f32_32x32x16_bf16 a[16:31], a[176:179], v[112:115], a[16:31]
  ds_read_b128 a[176:179], v8 offset:32768
  v_mfma_f32_32x32x16_bf16 a[32:47], a[180:183], v[96:99], a[32:47]
  v_xor_b32 v21, 98304, v21
  v_mfma_f32_32x32x16_bf16 a[48:63], a[180:183], v[112:115], a[48:63]
  ds_read_b128 a[180:183], v9 offset:32768
  v_exp_f32 v64, v64
  v_exp_f32 v65, v65
  v_add_f32 v60, v60, v64
  v_mfma_f32_32x32x16_bf16 a[64:79], a[184:187], v[96:99], a[64:79]
  s_add_u32 s55, s68, 24576
  s_sub_u32 s3, s55, 57344
  s_min_u32 s55, s55, s3
  buffer_load_dwordx4 v[208:211], v46, s[84:87], s55 offen offset:0 sc1
  v_xor_b32 v22, 98304, v22
  v_mfma_f32_32x32x16_bf16 a[80:95], a[184:187], v[112:115], a[80:95]
  ds_read_b128 a[184:187], v10 offset:32768
  v_exp_f32 v66, v66
  v_add_f32 v60, v60, v65
  v_cvt_pk_bf16_f32 v64, v64, v65
  v_mfma_f32_32x32x16_bf16 a[96:111], a[188:191], v[96:99], a[96:111]
  v_xor_b32 v23, 98304, v23
  v_exp_f32 v67, v67
  v_add_f32 v60, v60, v66
  v_exp_f32 v68, v68
  v_mfma_f32_32x32x16_bf16 a[112:127], a[188:191], v[112:115], a[112:127]
  ds_read_b128 a[188:191], v11 offset:32768
  v_add_f32 v60, v60, v67
  v_cvt_pk_bf16_f32 v65, v66, v67
  v_exp_f32 v69, v69
  v_add_f32 v60, v60, v68
  s_waitcnt lgkmcnt(4)
  v_mfma_f32_32x32x16_bf16 a[0:15], a[192:195], v[104:107], a[0:15]
  buffer_load_dwordx4 v[212:215], v46, s[84:87], s55 offen offset:1024 sc1
  v_exp_f32 v70, v70
  v_add_f32 v60, v60, v69
  v_cvt_pk_bf16_f32 v66, v68, v69
  v_mfma_f32_32x32x16_bf16 a[16:31], a[192:195], v[120:123], a[16:31]
  ds_read_b128 a[192:195], v12 offset:32768
  v_exp_f32 v71, v71
  v_add_f32 v60, v60, v70
  v_exp_f32 v80, v80
  v_mfma_f32_32x32x16_bf16 a[32:47], a[196:199], v[104:107], a[32:47]
  v_add_f32 v60, v60, v71
  v_cvt_pk_bf16_f32 v67, v70, v71
  v_exp_f32 v81, v81
  v_add_f32 v61, v61, v80
  v_mfma_f32_32x32x16_bf16 a[48:63], a[196:199], v[120:123], a[48:63]
  ds_read_b128 a[196:199], v13 offset:32768
  v_exp_f32 v82, v82
  v_add_f32 v61, v61, v81
  v_cvt_pk_bf16_f32 v80, v80, v81
  v_mfma_f32_32x32x16_bf16 a[64:79], a[200:203], v[104:107], a[64:79]
  buffer_load_dwordx4 v[216:219], v46, s[84:87], s55 offen offset:2048 sc1
  v_exp_f32 v83, v83
  v_add_f32 v61, v61, v82
  v_exp_f32 v84, v84
  v_mfma_f32_32x32x16_bf16 a[80:95], a[200:203], v[120:123], a[80:95]
  ds_read_b128 a[200:203], v14 offset:32768
  v_add_f32 v61, v61, v83
  v_cvt_pk_bf16_f32 v81, v82, v83
  v_exp_f32 v85, v85
  v_add_f32 v61, v61, v84
  v_mfma_f32_32x32x16_bf16 a[96:111], a[204:207], v[104:107], a[96:111]
  v_exp_f32 v86, v86
  v_add_f32 v61, v61, v85
  v_cvt_pk_bf16_f32 v82, v84, v85
  v_exp_f32 v87, v87
  v_mfma_f32_32x32x16_bf16 a[112:127], a[204:207], v[120:123], a[112:127]
  ds_read_b128 a[204:207], v15 offset:32768
  v_add_f32 v61, v61, v86
  v_exp_f32 v72, v72
  v_add_f32 v61, v61, v87
  v_cvt_pk_bf16_f32 v83, v86, v87
  s_waitcnt lgkmcnt(4)
  v_mfma_f32_32x32x16_bf16 v[96:111], a[176:179], v[128:131], v[224:239]
  v_exp_f32 v73, v73
  v_add_f32 v60, v60, v72
  v_exp_f32 v74, v74
  v_add_f32 v60, v60, v73
  v_mfma_f32_32x32x16_bf16 v[112:127], a[176:179], v[136:139], v[240:255]
  ds_read_b64_tr_b16 a[176:177], v20 offset:4096
  v_cvt_pk_bf16_f32 v72, v72, v73
  v_exp_f32 v75, v75
  v_add_f32 v60, v60, v74
  v_mfma_f32_32x32x16_bf16 v[96:111], a[180:183], v[132:135], v[96:111]
  ds_read_b64_tr_b16 a[178:179], v20 offset:5120
  buffer_load_dwordx4 v[220:223], v46, s[84:87], s55 offen offset:3072 sc1
  v_exp_f32 v76, v76
  v_add_f32 v60, v60, v75
  v_cvt_pk_bf16_f32 v73, v74, v75
  v_mfma_f32_32x32x16_bf16 v[112:127], a[180:183], v[140:143], v[112:127]
  ds_read_b64_tr_b16 a[180:181], v21 offset:4096
  v_exp_f32 v77, v77
  v_add_f32 v60, v60, v76
  v_exp_f32 v78, v78
  v_mfma_f32_32x32x16_bf16 v[96:111], a[184:187], v[144:147], v[96:111]
  ds_read_b64_tr_b16 a[182:183], v21 offset:5120
  v_add_f32 v60, v60, v77
  v_cvt_pk_bf16_f32 v74, v76, v77
  v_exp_f32 v79, v79
  v_add_f32 v60, v60, v78
  v_mfma_f32_32x32x16_bf16 v[112:127], a[184:187], v[152:155], v[112:127]
  ds_read_b64_tr_b16 a[184:185], v22 offset:4096
  v_exp_f32 v88, v88
  v_add_f32 v60, v60, v79
  v_cvt_pk_bf16_f32 v75, v78, v79
  v_mfma_f32_32x32x16_bf16 v[96:111], a[188:191], v[148:151], v[96:111]
  ds_read_b64_tr_b16 a[186:187], v22 offset:5120
  s_add_u32 s55, s68, 28672
  s_sub_u32 s3, s55, 57344
  s_min_u32 s55, s55, s3
  buffer_load_dwordx4 a[128:131], v46, s[84:87], s55 offen offset:0 sc1
  v_mfma_f32_32x32x16_bf16 v[112:127], a[188:191], v[156:159], v[112:127]
  ds_read_b64_tr_b16 a[188:189], v23 offset:4096
  v_exp_f32 v89, v89
  v_add_f32 v61, v61, v88
  v_exp_f32 v90, v90
  s_waitcnt lgkmcnt(7)
  v_mfma_f32_32x32x16_bf16 v[96:111], a[192:195], v[160:163], v[96:111]
  ds_read_b64_tr_b16 a[190:191], v23 offset:5120
  v_add_f32 v61, v61, v89
  v_cvt_pk_bf16_f32 v88, v88, v89
  v_exp_f32 v91, v91
  v_add_f32 v61, v61, v90
  v_mfma_f32_32x32x16_bf16 v[112:127], a[192:195], v[168:171], v[112:127]
  ds_read_b64_tr_b16 a[192:193], v20 offset:20480
  v_exp_f32 v92, v92
  v_add_f32 v61, v61, v91
  v_cvt_pk_bf16_f32 v89, v90, v91
  v_mfma_f32_32x32x16_bf16 v[96:111], a[196:199], v[164:167], v[96:111]
  ds_read_b64_tr_b16 a[194:195], v20 offset:21504
  buffer_load_dwordx4 a[132:135], v46, s[84:87], s55 offen offset:1024 sc1
  v_exp_f32 v93, v93
  v_add_f32 v61, v61, v92
  v_mfma_f32_32x32x16_bf16 v[112:127], a[196:199], v[172:175], v[112:127]
  ds_read_b64_tr_b16 a[196:197], v21 offset:20480
  v_exp_f32 v94, v94
  v_add_f32 v61, v61, v93
  v_cvt_pk_bf16_f32 v90, v92, v93
  v_mfma_f32_32x32x16_bf16 v[96:111], a[200:203], v[176:179], v[96:111]
  ds_read_b64_tr_b16 a[198:199], v21 offset:21504
  v_exp_f32 v95, v95
  v_add_f32 v61, v61, v94
  v_add_f32 v61, v61, v95
  v_cvt_pk_bf16_f32 v91, v94, v95
  v_mfma_f32_32x32x16_bf16 v[112:127], a[200:203], v[184:187], v[112:127]
  ds_read_b64_tr_b16 a[200:201], v22 offset:20480
  v_mfma_f32_32x32x16_bf16 v[96:111], a[204:207], v[180:183], v[96:111]
  ds_read_b64_tr_b16 a[202:203], v22 offset:21504
  v_mfma_f32_32x32x16_bf16 v[112:127], a[204:207], v[188:191], v[112:127]
  ds_read_b64_tr_b16 a[204:205], v23 offset:20480
  ds_read_b64_tr_b16 a[206:207], v23 offset:21504
  s_waitcnt lgkmcnt(8)
  v_mfma_f32_32x32x16_bf16 a[0:15], a[176:179], v[64:67], a[0:15]
  s_barrier
  v_mfma_f32_32x32x16_bf16 a[16:31], a[176:179], v[80:83], a[16:31]
  ds_read_b128 a[176:179], v8 offset:8192
  v_mfma_f32_32x32x16_bf16 a[32:47], a[180:183], v[64:67], a[32:47]
  s_add_u32 m0, s53, 8192
  s_xor_b32 s54, s60, 114688
  buffer_load_dwordx4 v16, s[12:15], s54 offen offset:0 lds
  v_mfma_f32_32x32x16_bf16 a[48:63], a[180:183], v[80:83], a[48:63]
  ds_read_b128 a[180:183], v9 offset:8192
  v_exp_f32 v96, v96
  v_exp_f32 v97, v97
  v_add_f32 v60, v60, v96
  v_mfma_f32_32x32x16_bf16 a[64:79], a[184:187], v[64:67], a[64:79]
  buffer_load_dwordx4 v17, s[12:15], s54 offen offset:1024 lds
  v_exp_f32 v98, v98
  v_add_f32 v60, v60, v97
  v_cvt_pk_bf16_f32 v96, v96, v97
  v_mfma_f32_32x32x16_bf16 a[80:95], a[184:187], v[80:83], a[80:95]
  ds_read_b128 a[184:187], v10 offset:8192
  v_exp_f32 v99, v99
  v_add_f32 v60, v60, v98
  v_exp_f32 v100, v100
  v_mfma_f32_32x32x16_bf16 a[96:111], a[188:191], v[64:67], a[96:111]
  buffer_load_dwordx4 v18, s[12:15], s54 offen offset:2048 lds
  v_add_f32 v60, v60, v99
  v_cvt_pk_bf16_f32 v97, v98, v99
  v_exp_f32 v101, v101
  v_add_f32 v60, v60, v100
  v_mfma_f32_32x32x16_bf16 a[112:127], a[188:191], v[80:83], a[112:127]
  ds_read_b128 a[188:191], v11 offset:8192
  v_exp_f32 v102, v102
  v_add_f32 v60, v60, v101
  v_cvt_pk_bf16_f32 v98, v100, v101
  s_waitcnt lgkmcnt(4)
  v_mfma_f32_32x32x16_bf16 a[0:15], a[192:195], v[72:75], a[0:15]
  buffer_load_dwordx4 v19, s[12:15], s54 offen offset:3072 lds
  v_exp_f32 v103, v103
  v_add_f32 v60, v60, v102
  v_exp_f32 v112, v112
  v_mfma_f32_32x32x16_bf16 a[16:31], a[192:195], v[88:91], a[16:31]
  ds_read_b128 a[192:195], v12 offset:8192
  v_add_f32 v60, v60, v103
  v_cvt_pk_bf16_f32 v99, v102, v103
  v_exp_f32 v113, v113
  v_add_f32 v61, v61, v112
  v_mfma_f32_32x32x16_bf16 a[32:47], a[196:199], v[72:75], a[32:47]
  s_add_u32 m0, s53, 12288
  s_xor_b32 s54, s60, 114688
  buffer_load_dwordx4 v48, s[16:19], s54 offen offset:0 lds
  v_exp_f32 v114, v114
  v_add_f32 v61, v61, v113
  v_mfma_f32_32x32x16_bf16 a[48:63], a[196:199], v[88:91], a[48:63]
  ds_read_b128 a[196:199], v13 offset:8192
  v_cvt_pk_bf16_f32 v112, v112, v113
  v_exp_f32 v115, v115
  v_add_f32 v61, v61, v114
  v_mfma_f32_32x32x16_bf16 a[64:79], a[200:203], v[72:75], a[64:79]
  buffer_load_dwordx4 v48, s[16:19], s54 offen offset:1024 lds
  v_exp_f32 v116, v116
  v_add_f32 v61, v61, v115
  v_cvt_pk_bf16_f32 v113, v114, v115
  v_mfma_f32_32x32x16_bf16 a[80:95], a[200:203], v[88:91], a[80:95]
  ds_read_b128 a[200:203], v14 offset:8192
  v_exp_f32 v117, v117
  v_add_f32 v61, v61, v116
  v_exp_f32 v118, v118
  v_mfma_f32_32x32x16_bf16 a[96:111], a[204:207], v[72:75], a[96:111]
  buffer_load_dwordx4 v48, s[16:19], s54 offen offset:2048 lds
  v_add_f32 v61, v61, v117
  v_cvt_pk_bf16_f32 v114, v116, v117
  v_exp_f32 v119, v119
  v_add_f32 v61, v61, v118
  v_mfma_f32_32x32x16_bf16 a[112:127], a[204:207], v[88:91], a[112:127]
  buffer_load_dwordx4 v48, s[16:19], s54 offen offset:3072 lds
  ds_read_b128 a[204:207], v15 offset:8192
  v_exp_f32 v104, v104
  v_add_f32 v61, v61, v119
  v_cvt_pk_bf16_f32 v115, v118, v119
  s_waitcnt lgkmcnt(4)
  v_mfma_f32_32x32x16_bf16 v[64:79], a[176:179], v[128:131], v[224:239]
  v_exp_f32 v105, v105
  v_add_f32 v60, v60, v104
  v_exp_f32 v106, v106
  v_add_f32 v60, v60, v105
  v_mfma_f32_32x32x16_bf16 v[80:95], a[176:179], v[136:139], v[240:255]
  ds_read_b64_tr_b16 a[176:177], v20 offset:36864
  v_cvt_pk_bf16_f32 v104, v104, v105
  v_exp_f32 v107, v107
  v_add_f32 v60, v60, v106
  v_mfma_f32_32x32x16_bf16 v[64:79], a[180:183], v[132:135], v[64:79]
  ds_read_b64_tr_b16 a[178:179], v20 offset:37888
  buffer_load_dwordx4 a[136:139], v46, s[84:87], s55 offen offset:2048 sc1
  v_exp_f32 v108, v108
  v_add_f32 v60, v60, v107
  v_cvt_pk_bf16_f32 v105, v106, v107
  v_mfma_f32_32x32x16_bf16 v[80:95], a[180:183], v[140:143], v[80:95]
  ds_read_b64_tr_b16 a[180:181], v21 offset:36864
  v_exp_f32 v109, v109
  v_add_f32 v60, v60, v108
  v_exp_f32 v110, v110
  v_mfma_f32_32x32x16_bf16 v[64:79], a[184:187], v[144:147], v[64:79]
  ds_read_b64_tr_b16 a[182:183], v21 offset:37888
  v_add_f32 v60, v60, v109
  v_cvt_pk_bf16_f32 v106, v108, v109
  v_exp_f32 v111, v111
  v_add_f32 v60, v60, v110
  v_mfma_f32_32x32x16_bf16 v[80:95], a[184:187], v[152:155], v[80:95]
  ds_read_b64_tr_b16 a[184:185], v22 offset:36864
  v_exp_f32 v120, v120
  v_add_f32 v60, v60, v111
  v_cvt_pk_bf16_f32 v107, v110, v111
  v_mfma_f32_32x32x16_bf16 v[64:79], a[188:191], v[148:151], v[64:79]
  ds_read_b64_tr_b16 a[186:187], v22 offset:37888
  buffer_load_dwordx4 a[140:143], v46, s[84:87], s55 offen offset:3072 sc1
  v_exp_f32 v121, v121
  v_add_f32 v61, v61, v120
  v_mfma_f32_32x32x16_bf16 v[80:95], a[188:191], v[156:159], v[80:95]
  ds_read_b64_tr_b16 a[188:189], v23 offset:36864
  v_exp_f32 v122, v122
  v_add_f32 v61, v61, v121
  v_cvt_pk_bf16_f32 v120, v120, v121
  s_waitcnt lgkmcnt(7)
  v_mfma_f32_32x32x16_bf16 v[64:79], a[192:195], v[160:163], v[64:79]
  ds_read_b64_tr_b16 a[190:191], v23 offset:37888
  v_exp_f32 v123, v123
  v_add_f32 v61, v61, v122
  v_exp_f32 v124, v124
  v_mfma_f32_32x32x16_bf16 v[80:95], a[192:195], v[168:171], v[80:95]
  ds_read_b64_tr_b16 a[192:193], v20 offset:53248
  v_add_f32 v61, v61, v123
  v_cvt_pk_bf16_f32 v121, v122, v123
  v_exp_f32 v125, v125
  v_add_f32 v61, v61, v124
  v_mfma_f32_32x32x16_bf16 v[64:79], a[196:199], v[164:167], v[64:79]
  ds_read_b64_tr_b16 a[194:195], v20 offset:54272
  s_add_u32 s55, s68, 32768
  s_sub_u32 s3, s55, 57344
  s_min_u32 s55, s55, s3
  buffer_load_dwordx4 a[144:147], v46, s[84:87], s55 offen offset:0 sc1
  v_mfma_f32_32x32x16_bf16 v[80:95], a[196:199], v[172:175], v[80:95]
  ds_read_b64_tr_b16 a[196:197], v21 offset:53248
  v_exp_f32 v126, v126
  v_add_f32 v61, v61, v125
  v_cvt_pk_bf16_f32 v122, v124, v125
  v_mfma_f32_32x32x16_bf16 v[64:79], a[200:203], v[176:179], v[64:79]
  ds_read_b64_tr_b16 a[198:199], v21 offset:54272
  v_exp_f32 v127, v127
  v_add_f32 v61, v61, v126
  v_add_f32 v61, v61, v127
  v_cvt_pk_bf16_f32 v123, v126, v127
  v_mfma_f32_32x32x16_bf16 v[80:95], a[200:203], v[184:187], v[80:95]
  ds_read_b64_tr_b16 a[200:201], v22 offset:53248
  v_mfma_f32_32x32x16_bf16 v[64:79], a[204:207], v[180:183], v[64:79]
  ds_read_b64_tr_b16 a[202:203], v22 offset:54272
  v_mfma_f32_32x32x16_bf16 v[80:95], a[204:207], v[188:191], v[80:95]
  ds_read_b64_tr_b16 a[204:205], v23 offset:53248
  ds_read_b64_tr_b16 a[206:207], v23 offset:54272
  s_waitcnt lgkmcnt(8)
  v_mfma_f32_32x32x16_bf16 a[0:15], a[176:179], v[96:99], a[0:15]
  buffer_load_dwordx4 a[148:151], v46, s[84:87], s55 offen offset:1024 sc1
  v_mfma_f32_32x32x16_bf16 a[16:31], a[176:179], v[112:115], a[16:31]
  ds_read_b128 a[176:179], v8 offset:40960
  v_mfma_f32_32x32x16_bf16 a[32:47], a[180:183], v[96:99], a[32:47]
  v_mfma_f32_32x32x16_bf16 a[48:63], a[180:183], v[112:115], a[48:63]
  ds_read_b128 a[180:183], v9 offset:40960
  v_exp_f32 v64, v64
  v_exp_f32 v65, v65
  v_add_f32 v60, v60, v64
  v_mfma_f32_32x32x16_bf16 a[64:79], a[184:187], v[96:99], a[64:79]
  buffer_load_dwordx4 a[152:155], v46, s[84:87], s55 offen offset:2048 sc1
  v_exp_f32 v66, v66
  v_add_f32 v60, v60, v65
  v_cvt_pk_bf16_f32 v64, v64, v65
  v_mfma_f32_32x32x16_bf16 a[80:95], a[184:187], v[112:115], a[80:95]
  ds_read_b128 a[184:187], v10 offset:40960
  v_exp_f32 v67, v67
  v_add_f32 v60, v60, v66
  v_exp_f32 v68, v68
  v_mfma_f32_32x32x16_bf16 a[96:111], a[188:191], v[96:99], a[96:111]
  v_add_f32 v60, v60, v67
  v_cvt_pk_bf16_f32 v65, v66, v67
  v_exp_f32 v69, v69
  v_add_f32 v60, v60, v68
  v_mfma_f32_32x32x16_bf16 a[112:127], a[188:191], v[112:115], a[112:127]
  ds_read_b128 a[188:191], v11 offset:40960
  v_exp_f32 v70, v70
  v_add_f32 v60, v60, v69
  v_cvt_pk_bf16_f32 v66, v68, v69
  s_waitcnt lgkmcnt(4)
  v_mfma_f32_32x32x16_bf16 a[0:15], a[192:195], v[104:107], a[0:15]
  buffer_load_dwordx4 a[156:159], v46, s[84:87], s55 offen offset:3072 sc1
  v_exp_f32 v71, v71
  v_add_f32 v60, v60, v70
  v_exp_f32 v80, v80
  v_mfma_f32_32x32x16_bf16 a[16:31], a[192:195], v[120:123], a[16:31]
  ds_read_b128 a[192:195], v12 offset:40960
  v_add_f32 v60, v60, v71
  v_cvt_pk_bf16_f32 v67, v70, v71
  v_exp_f32 v81, v81
  v_add_f32 v61, v61, v80
  v_mfma_f32_32x32x16_bf16 a[32:47], a[196:199], v[104:107], a[32:47]
  v_exp_f32 v82, v82
  v_add_f32 v61, v61, v81
  v_cvt_pk_bf16_f32 v80, v80, v81
  v_exp_f32 v83, v83
  v_mfma_f32_32x32x16_bf16 a[48:63], a[196:199], v[120:123], a[48:63]
  ds_read_b128 a[196:199], v13 offset:40960
  v_add_f32 v61, v61, v82
  v_exp_f32 v84, v84
  v_add_f32 v61, v61, v83
  v_cvt_pk_bf16_f32 v81, v82, v83
  v_mfma_f32_32x32x16_bf16 a[64:79], a[200:203], v[104:107], a[64:79]
  s_add_u32 s55, s68, 36864
  s_sub_u32 s3, s55, 57344
  s_min_u32 s55, s55, s3
  buffer_load_dwordx4 a[160:163], v46, s[84:87], s55 offen offset:0 sc1
  v_exp_f32 v85, v85
  v_mfma_f32_32x32x16_bf16 a[80:95], a[200:203], v[120:123], a[80:95]
  ds_read_b128 a[200:203], v14 offset:40960
  v_add_f32 v61, v61, v84
  v_exp_f32 v86, v86
  v_add_f32 v61, v61, v85
  v_cvt_pk_bf16_f32 v82, v84, v85
  v_mfma_f32_32x32x16_bf16 a[96:111], a[204:207], v[104:107], a[96:111]
  v_exp_f32 v87, v87
  v_add_f32 v61, v61, v86
  v_exp_f32 v72, v72
  v_add_f32 v61, v61, v87
  v_mfma_f32_32x32x16_bf16 a[112:127], a[204:207], v[120:123], a[112:127]
  ds_read_b128 a[204:207], v15 offset:40960
  v_cvt_pk_bf16_f32 v83, v86, v87
  v_exp_f32 v73, v73
  v_add_f32 v60, v60, v72
  s_waitcnt lgkmcnt(4)
  v_mfma_f32_32x32x16_bf16 v[96:111], a[176:179], v[128:131], v[224:239]
  v_xor_b32 v8, 98304, v8
  v_exp_f32 v74, v74
  v_add_f32 v60, v60, v73
  v_cvt_pk_bf16_f32 v72, v72, v73
  v_mfma_f32_32x32x16_bf16 v[112:127], a[176:179], v[136:139], v[240:255]
  ds_read_b64_tr_b16 a[176:177], v20 offset:12288
  v_exp_f32 v75, v75
  v_add_f32 v60, v60, v74
  v_exp_f32 v76, v76
  v_mfma_f32_32x32x16_bf16 v[96:111], a[180:183], v[132:135], v[96:111]
  ds_read_b64_tr_b16 a[178:179], v20 offset:13312
  v_xor_b32 v9, 98304, v9
  buffer_load_dwordx4 a[164:167], v46, s[84:87], s55 offen offset:1024 sc1
  v_add_f32 v60, v60, v75
  v_cvt_pk_bf16_f32 v73, v74, v75
  v_mfma_f32_32x32x16_bf16 v[112:127], a[180:183], v[140:143], v[112:127]
  ds_read_b64_tr_b16 a[180:181], v21 offset:12288
  v_exp_f32 v77, v77
  v_add_f32 v60, v60, v76
  v_exp_f32 v78, v78
  v_mfma_f32_32x32x16_bf16 v[96:111], a[184:187], v[144:147], v[96:111]
  ds_read_b64_tr_b16 a[182:183], v21 offset:13312
  v_xor_b32 v10, 98304, v10
  v_add_f32 v60, v60, v77
  v_cvt_pk_bf16_f32 v74, v76, v77
  v_exp_f32 v79, v79
  v_mfma_f32_32x32x16_bf16 v[112:127], a[184:187], v[152:155], v[112:127]
  ds_read_b64_tr_b16 a[184:185], v22 offset:12288
  v_add_f32 v60, v60, v78
  v_exp_f32 v88, v88
  v_add_f32 v60, v60, v79
  v_cvt_pk_bf16_f32 v75, v78, v79
  v_mfma_f32_32x32x16_bf16 v[96:111], a[188:191], v[148:151], v[96:111]
  ds_read_b64_tr_b16 a[186:187], v22 offset:13312
  v_xor_b32 v11, 98304, v11
  buffer_load_dwordx4 a[168:171], v46, s[84:87], s55 offen offset:2048 sc1
  v_exp_f32 v89, v89
  v_add_f32 v61, v61, v88
  v_mfma_f32_32x32x16_bf16 v[112:127], a[188:191], v[156:159], v[112:127]
  ds_read_b64_tr_b16 a[188:189], v23 offset:12288
  v_exp_f32 v90, v90
  v_add_f32 v61, v61, v89
  v_cvt_pk_bf16_f32 v88, v88, v89
  s_waitcnt lgkmcnt(7)
  v_mfma_f32_32x32x16_bf16 v[96:111], a[192:195], v[160:163], v[96:111]
  ds_read_b64_tr_b16 a[190:191], v23 offset:13312
  v_xor_b32 v12, 98304, v12
  v_exp_f32 v91, v91
  v_add_f32 v61, v61, v90
  v_mfma_f32_32x32x16_bf16 v[112:127], a[192:195], v[168:171], v[112:127]
  ds_read_b64_tr_b16 a[192:193], v20 offset:28672
  v_exp_f32 v92, v92
  v_add_f32 v61, v61, v91
  v_cvt_pk_bf16_f32 v89, v90, v91
  v_mfma_f32_32x32x16_bf16 v[96:111], a[196:199], v[164:167], v[96:111]
  ds_read_b64_tr_b16 a[194:195], v20 offset:29696
  v_xor_b32 v13, 98304, v13
  buffer_load_dwordx4 a[172:175], v46, s[84:87], s55 offen offset:3072 sc1
  v_exp_f32 v93, v93
  v_add_f32 v61, v61, v92
  v_mfma_f32_32x32x16_bf16 v[112:127], a[196:199], v[172:175], v[112:127]
  ds_read_b64_tr_b16 a[196:197], v21 offset:28672
  v_exp_f32 v94, v94
  v_add_f32 v61, v61, v93
  v_cvt_pk_bf16_f32 v90, v92, v93
  v_mfma_f32_32x32x16_bf16 v[96:111], a[200:203], v[176:179], v[96:111]
  ds_read_b64_tr_b16 a[198:199], v21 offset:29696
  v_xor_b32 v14, 98304, v14
  v_exp_f32 v95, v95
  v_add_f32 v61, v61, v94
  v_add_f32 v61, v61, v95
  v_mfma_f32_32x32x16_bf16 v[112:127], a[200:203], v[184:187], v[112:127]
  ds_read_b64_tr_b16 a[200:201], v22 offset:28672
  v_cvt_pk_bf16_f32 v91, v94, v95
  v_mfma_f32_32x32x16_bf16 v[96:111], a[204:207], v[180:183], v[96:111]
  ds_read_b64_tr_b16 a[202:203], v22 offset:29696
  v_xor_b32 v15, 98304, v15
  v_mfma_f32_32x32x16_bf16 v[112:127], a[204:207], v[188:191], v[112:127]
  ds_read_b64_tr_b16 a[204:205], v23 offset:28672
  ds_read_b64_tr_b16 a[206:207], v23 offset:29696
  s_waitcnt lgkmcnt(8)
  v_mfma_f32_32x32x16_bf16 a[0:15], a[176:179], v[64:67], a[0:15]
  s_waitcnt vmcnt(28)
  s_barrier
  v_mfma_f32_32x32x16_bf16 a[16:31], a[176:179], v[80:83], a[16:31]
  ds_read_b128 a[176:179], v8 offset:0
  v_mfma_f32_32x32x16_bf16 a[32:47], a[180:183], v[64:67], a[32:47]
  s_add_u32 m0, s52, 0
  s_xor_b32 s54, s58, 0
  buffer_load_dwordx4 v42, s[24:27], s54 offen offset:0 lds
  v_mfma_f32_32x32x16_bf16 a[48:63], a[180:183], v[80:83], a[48:63]
  ds_read_b128 a[180:183], v9 offset:0
  v_exp_f32 v96, v96
  v_exp_f32 v97, v97
  v_add_f32 v60, v60, v96
  v_mfma_f32_32x32x16_bf16 a[64:79], a[184:187], v[64:67], a[64:79]
  buffer_load_dwordx4 v43, s[24:27], s54 offen offset:1024 lds
  v_exp_f32 v98, v98
  v_add_f32 v60, v60, v97
  v_cvt_pk_bf16_f32 v96, v96, v97
  v_mfma_f32_32x32x16_bf16 a[80:95], a[184:187], v[80:83], a[80:95]
  ds_read_b128 a[184:187], v10 offset:0
  v_exp_f32 v99, v99
  v_add_f32 v60, v60, v98
  v_exp_f32 v100, v100
  v_mfma_f32_32x32x16_bf16 a[96:111], a[188:191], v[64:67], a[96:111]
  buffer_load_dwordx4 v44, s[24:27], s54 offen offset:2048 lds
  v_add_f32 v60, v60, v99
  v_cvt_pk_bf16_f32 v97, v98, v99
  v_exp_f32 v101, v101
  v_add_f32 v60, v60, v100
  v_mfma_f32_32x32x16_bf16 a[112:127], a[188:191], v[80:83], a[112:127]
  ds_read_b128 a[188:191], v11 offset:0
  v_exp_f32 v102, v102
  v_add_f32 v60, v60, v101
  v_cvt_pk_bf16_f32 v98, v100, v101
  s_waitcnt lgkmcnt(4)
  v_mfma_f32_32x32x16_bf16 a[0:15], a[192:195], v[72:75], a[0:15]
  buffer_load_dwordx4 v45, s[24:27], s54 offen offset:3072 lds
  v_exp_f32 v103, v103
  v_add_f32 v60, v60, v102
  v_exp_f32 v112, v112
  v_mfma_f32_32x32x16_bf16 a[16:31], a[192:195], v[88:91], a[16:31]
  ds_read_b128 a[192:195], v12 offset:0
  v_add_f32 v60, v60, v103
  v_cvt_pk_bf16_f32 v99, v102, v103
  v_exp_f32 v113, v113
  v_add_f32 v61, v61, v112
  v_mfma_f32_32x32x16_bf16 a[32:47], a[196:199], v[72:75], a[32:47]
  s_add_u32 m0, s52, 4096
  s_xor_b32 s54, s58, 16384
  buffer_load_dwordx4 v42, s[24:27], s54 offen offset:0 lds
  v_exp_f32 v114, v114
  v_add_f32 v61, v61, v113
  v_mfma_f32_32x32x16_bf16 a[48:63], a[196:199], v[88:91], a[48:63]
  ds_read_b128 a[196:199], v13 offset:0
  v_cvt_pk_bf16_f32 v112, v112, v113
  v_exp_f32 v115, v115
  v_add_f32 v61, v61, v114
  v_mfma_f32_32x32x16_bf16 a[64:79], a[200:203], v[72:75], a[64:79]
  buffer_load_dwordx4 v43, s[24:27], s54 offen offset:1024 lds
  v_exp_f32 v116, v116
  v_add_f32 v61, v61, v115
  v_cvt_pk_bf16_f32 v113, v114, v115
  v_mfma_f32_32x32x16_bf16 a[80:95], a[200:203], v[88:91], a[80:95]
  ds_read_b128 a[200:203], v14 offset:0
  v_exp_f32 v117, v117
  v_add_f32 v61, v61, v116
  v_exp_f32 v118, v118
  v_mfma_f32_32x32x16_bf16 a[96:111], a[204:207], v[72:75], a[96:111]
  buffer_load_dwordx4 v44, s[24:27], s54 offen offset:2048 lds
  v_add_f32 v61, v61, v117
  v_cvt_pk_bf16_f32 v114, v116, v117
  v_exp_f32 v119, v119
  v_add_f32 v61, v61, v118
  v_mfma_f32_32x32x16_bf16 a[112:127], a[204:207], v[88:91], a[112:127]
  buffer_load_dwordx4 v45, s[24:27], s54 offen offset:3072 lds
  ds_read_b128 a[204:207], v15 offset:0
  v_exp_f32 v104, v104
  v_add_f32 v61, v61, v119
  v_cvt_pk_bf16_f32 v115, v118, v119
  s_waitcnt lgkmcnt(4)
  v_mfma_f32_32x32x16_bf16 v[64:79], a[176:179], v[128:131], v[224:239]
  v_exp_f32 v105, v105
  v_add_f32 v60, v60, v104
  v_exp_f32 v106, v106
  v_add_f32 v60, v60, v105
  v_mfma_f32_32x32x16_bf16 v[80:95], a[176:179], v[136:139], v[240:255]
  ds_read_b64_tr_b16 a[176:177], v20 offset:45056
  v_cvt_pk_bf16_f32 v104, v104, v105
  v_exp_f32 v107, v107
  v_add_f32 v60, v60, v106
  v_mfma_f32_32x32x16_bf16 v[64:79], a[180:183], v[132:135], v[64:79]
  ds_read_b64_tr_b16 a[178:179], v20 offset:46080
  s_add_u32 s55, s68, 40960
  s_sub_u32 s3, s55, 57344
  s_min_u32 s55, s55, s3
  buffer_load_dwordx4 a[240:243], v46, s[84:87], s55 offen offset:0 sc1
  v_mfma_f32_32x32x16_bf16 v[80:95], a[180:183], v[140:143], v[80:95]
  ds_read_b64_tr_b16 a[180:181], v21 offset:45056
  v_exp_f32 v108, v108
  v_add_f32 v60, v60, v107
  v_cvt_pk_bf16_f32 v105, v106, v107
  v_mfma_f32_32x32x16_bf16 v[64:79], a[184:187], v[144:147], v[64:79]
  ds_read_b64_tr_b16 a[182:183], v21 offset:46080
  v_exp_f32 v109, v109
  v_add_f32 v60, v60, v108
  v_exp_f32 v110, v110
  v_mfma_f32_32x32x16_bf16 v[80:95], a[184:187], v[152:155], v[80:95]
  ds_read_b64_tr_b16 a[184:185], v22 offset:45056
  v_add_f32 v60, v60, v109
  v_cvt_pk_bf16_f32 v106, v108, v109
  v_exp_f32 v111, v111
  v_add_f32 v60, v60, v110
  v_mfma_f32_32x32x16_bf16 v[64:79], a[188:191], v[148:151], v[64:79]
  ds_read_b64_tr_b16 a[186:187], v22 offset:46080
  buffer_load_dwordx4 a[244:247], v46, s[84:87], s55 offen offset:1024 sc1
  v_exp_f32 v120, v120
  v_add_f32 v60, v60, v111
  v_cvt_pk_bf16_f32 v107, v110, v111
  v_mfma_f32_32x32x16_bf16 v[80:95], a[188:191], v[156:159], v[80:95]
  ds_read_b64_tr_b16 a[188:189], v23 offset:45056
  v_exp_f32 v121, v121
  v_add_f32 v61, v61, v120
  v_exp_f32 v122, v122
  s_waitcnt lgkmcnt(7)
  v_mfma_f32_32x32x16_bf16 v[64:79], a[192:195], v[160:163], v[64:79]
  ds_read_b64_tr_b16 a[190:191], v23 offset:46080
  v_add_f32 v61, v61, v121
  v_cvt_pk_bf16_f32 v120, v120, v121
  v_exp_f32 v123, v123
  v_add_f32 v61, v61, v122
  v_mfma_f32_32x32x16_bf16 v[80:95], a[192:195], v[168:171], v[80:95]
  ds_read_b64_tr_b16 a[192:193], v20 offset:61440
  v_exp_f32 v124, v124
  v_add_f32 v61, v61, v123
  v_cvt_pk_bf16_f32 v121, v122, v123
  v_mfma_f32_32x32x16_bf16 v[64:79], a[196:199], v[164:167], v[64:79]
  ds_read_b64_tr_b16 a[194:195], v20 offset:62464
  buffer_load_dwordx4 a[208:211], v46, s[84:87], s55 offen offset:2048 sc1
  v_exp_f32 v125, v125
  v_add_f32 v61, v61, v124
  v_mfma_f32_32x32x16_bf16 v[80:95], a[196:199], v[172:175], v[80:95]
  ds_read_b64_tr_b16 a[196:197], v21 offset:61440
  v_exp_f32 v126, v126
  v_add_f32 v61, v61, v125
  v_cvt_pk_bf16_f32 v122, v124, v125
  v_mfma_f32_32x32x16_bf16 v[64:79], a[200:203], v[176:179], v[64:79]
  ds_read_b64_tr_b16 a[198:199], v21 offset:62464
  v_exp_f32 v127, v127
  v_add_f32 v61, v61, v126
  v_add_f32 v61, v61, v127
  v_cvt_pk_bf16_f32 v123, v126, v127
  v_mfma_f32_32x32x16_bf16 v[80:95], a[200:203], v[184:187], v[80:95]
  ds_read_b64_tr_b16 a[200:201], v22 offset:61440
  v_mfma_f32_32x32x16_bf16 v[64:79], a[204:207], v[180:183], v[64:79]
  ds_read_b64_tr_b16 a[202:203], v22 offset:62464
  v_mfma_f32_32x32x16_bf16 v[80:95], a[204:207], v[188:191], v[80:95]
  ds_read_b64_tr_b16 a[204:205], v23 offset:61440
  ds_read_b64_tr_b16 a[206:207], v23 offset:62464
  s_waitcnt lgkmcnt(8)
  v_mfma_f32_32x32x16_bf16 a[0:15], a[176:179], v[96:99], a[0:15]
  buffer_load_dwordx4 a[212:215], v46, s[84:87], s55 offen offset:3072 sc1
  v_xor_b32 v20, 98304, v20
  v_mfma_f32_32x32x16_bf16 a[16:31], a[176:179], v[112:115], a[16:31]
  ds_read_b128 a[176:179], v8 offset:32768
  v_mfma_f32_32x32x16_bf16 a[32:47], a[180:183], v[96:99], a[32:47]
  v_xor_b32 v21, 98304, v21
  v_mfma_f32_32x32x16_bf16 a[48:63], a[180:183], v[112:115], a[48:63]
  ds_read_b128 a[180:183], v9 offset:32768
  v_exp_f32 v64, v64
  v_exp_f32 v65, v65
  v_add_f32 v60, v60, v64
  v_mfma_f32_32x32x16_bf16 a[64:79], a[184:187], v[96:99], a[64:79]
  s_add_u32 s55, s68, 45056
  s_sub_u32 s3, s55, 57344
  s_min_u32 s55, s55, s3
  buffer_load_dwordx4 a[216:219], v46, s[84:87], s55 offen offset:0 sc1
  v_xor_b32 v22, 98304, v22
  v_mfma_f32_32x32x16_bf16 a[80:95], a[184:187], v[112:115], a[80:95]
  ds_read_b128 a[184:187], v10 offset:32768
  v_exp_f32 v66, v66
  v_add_f32 v60, v60, v65
  v_cvt_pk_bf16_f32 v64, v64, v65
  v_mfma_f32_32x32x16_bf16 a[96:111], a[188:191], v[96:99], a[96:111]
  v_xor_b32 v23, 98304, v23
  v_exp_f32 v67, v67
  v_add_f32 v60, v60, v66
  v_exp_f32 v68, v68
  v_mfma_f32_32x32x16_bf16 a[112:127], a[188:191], v[112:115], a[112:127]
  ds_read_b128 a[188:191], v11 offset:32768
  v_add_f32 v60, v60, v67
  v_cvt_pk_bf16_f32 v65, v66, v67
  v_exp_f32 v69, v69
  v_add_f32 v60, v60, v68
  s_waitcnt lgkmcnt(4)
  v_mfma_f32_32x32x16_bf16 a[0:15], a[192:195], v[104:107], a[0:15]
  buffer_load_dwordx4 a[220:223], v46, s[84:87], s55 offen offset:1024 sc1
  v_exp_f32 v70, v70
  v_add_f32 v60, v60, v69
  v_cvt_pk_bf16_f32 v66, v68, v69
  v_mfma_f32_32x32x16_bf16 a[16:31], a[192:195], v[120:123], a[16:31]
  ds_read_b128 a[192:195], v12 offset:32768
  v_exp_f32 v71, v71
  v_add_f32 v60, v60, v70
  v_exp_f32 v80, v80
  v_mfma_f32_32x32x16_bf16 a[32:47], a[196:199], v[104:107], a[32:47]
  v_add_f32 v60, v60, v71
  v_cvt_pk_bf16_f32 v67, v70, v71
  v_exp_f32 v81, v81
  v_add_f32 v61, v61, v80
  v_mfma_f32_32x32x16_bf16 a[48:63], a[196:199], v[120:123], a[48:63]
  ds_read_b128 a[196:199], v13 offset:32768
  v_exp_f32 v82, v82
  v_add_f32 v61, v61, v81
  v_cvt_pk_bf16_f32 v80, v80, v81
  v_mfma_f32_32x32x16_bf16 a[64:79], a[200:203], v[104:107], a[64:79]
  buffer_load_dwordx4 a[224:227], v46, s[84:87], s55 offen offset:2048 sc1
  v_exp_f32 v83, v83
  v_add_f32 v61, v61, v82
  v_exp_f32 v84, v84
  v_mfma_f32_32x32x16_bf16 a[80:95], a[200:203], v[120:123], a[80:95]
  ds_read_b128 a[200:203], v14 offset:32768
  v_add_f32 v61, v61, v83
  v_cvt_pk_bf16_f32 v81, v82, v83
  v_exp_f32 v85, v85
  v_add_f32 v61, v61, v84
  v_mfma_f32_32x32x16_bf16 a[96:111], a[204:207], v[104:107], a[96:111]
  v_exp_f32 v86, v86
  v_add_f32 v61, v61, v85
  v_cvt_pk_bf16_f32 v82, v84, v85
  v_exp_f32 v87, v87
  v_mfma_f32_32x32x16_bf16 a[112:127], a[204:207], v[120:123], a[112:127]
  ds_read_b128 a[204:207], v15 offset:32768
  v_add_f32 v61, v61, v86
  v_exp_f32 v72, v72
  v_add_f32 v61, v61, v87
  v_cvt_pk_bf16_f32 v83, v86, v87
  s_waitcnt lgkmcnt(4)
  v_mfma_f32_32x32x16_bf16 v[96:111], a[176:179], v[128:131], v[224:239]
  v_exp_f32 v73, v73
  v_add_f32 v60, v60, v72
  v_exp_f32 v74, v74
  v_add_f32 v60, v60, v73
  v_mfma_f32_32x32x16_bf16 v[112:127], a[176:179], v[136:139], v[240:255]
  ds_read_b64_tr_b16 a[176:177], v20 offset:4096
  v_cvt_pk_bf16_f32 v72, v72, v73
  v_exp_f32 v75, v75
  v_add_f32 v60, v60, v74
  v_mfma_f32_32x32x16_bf16 v[96:111], a[180:183], v[132:135], v[96:111]
  ds_read_b64_tr_b16 a[178:179], v20 offset:5120
  buffer_load_dwordx4 a[228:231], v46, s[84:87], s55 offen offset:3072 sc1
  v_exp_f32 v76, v76
  v_add_f32 v60, v60, v75
  v_cvt_pk_bf16_f32 v73, v74, v75
  v_mfma_f32_32x32x16_bf16 v[112:127], a[180:183], v[140:143], v[112:127]
  ds_read_b64_tr_b16 a[180:181], v21 offset:4096
  v_exp_f32 v77, v77
  v_add_f32 v60, v60, v76
  v_exp_f32 v78, v78
  v_mfma_f32_32x32x16_bf16 v[96:111], a[184:187], v[144:147], v[96:111]
  ds_read_b64_tr_b16 a[182:183], v21 offset:5120
  v_add_f32 v60, v60, v77
  v_cvt_pk_bf16_f32 v74, v76, v77
  v_exp_f32 v79, v79
  v_add_f32 v60, v60, v78
  v_mfma_f32_32x32x16_bf16 v[112:127], a[184:187], v[152:155], v[112:127]
  ds_read_b64_tr_b16 a[184:185], v22 offset:4096
  v_exp_f32 v88, v88
  v_add_f32 v60, v60, v79
  v_cvt_pk_bf16_f32 v75, v78, v79
  v_mfma_f32_32x32x16_bf16 v[96:111], a[188:191], v[148:151], v[96:111]
  ds_read_b64_tr_b16 a[186:187], v22 offset:5120
  s_add_u32 s55, s68, 49152
  s_sub_u32 s3, s55, 57344
  s_min_u32 s55, s55, s3
  buffer_load_dwordx4 a[232:235], v46, s[84:87], s55 offen offset:0 sc1
  v_mfma_f32_32x32x16_bf16 v[112:127], a[188:191], v[156:159], v[112:127]
  ds_read_b64_tr_b16 a[188:189], v23 offset:4096
  v_exp_f32 v89, v89
  v_add_f32 v61, v61, v88
  v_exp_f32 v90, v90
  s_waitcnt lgkmcnt(7)
  v_mfma_f32_32x32x16_bf16 v[96:111], a[192:195], v[160:163], v[96:111]
  ds_read_b64_tr_b16 a[190:191], v23 offset:5120
  v_add_f32 v61, v61, v89
  v_cvt_pk_bf16_f32 v88, v88, v89
  v_exp_f32 v91, v91
  v_add_f32 v61, v61, v90
  v_mfma_f32_32x32x16_bf16 v[112:127], a[192:195], v[168:171], v[112:127]
  ds_read_b64_tr_b16 a[192:193], v20 offset:20480
  v_exp_f32 v92, v92
  v_add_f32 v61, v61, v91
  v_cvt_pk_bf16_f32 v89, v90, v91
  v_mfma_f32_32x32x16_bf16 v[96:111], a[196:199], v[164:167], v[96:111]
  ds_read_b64_tr_b16 a[194:195], v20 offset:21504
  buffer_load_dwordx4 a[236:239], v46, s[84:87], s55 offen offset:1024 sc1
  v_exp_f32 v93, v93
  v_add_f32 v61, v61, v92
  v_mfma_f32_32x32x16_bf16 v[112:127], a[196:199], v[172:175], v[112:127]
  ds_read_b64_tr_b16 a[196:197], v21 offset:20480
  v_exp_f32 v94, v94
  v_add_f32 v61, v61, v93
  v_cvt_pk_bf16_f32 v90, v92, v93
  v_mfma_f32_32x32x16_bf16 v[96:111], a[200:203], v[176:179], v[96:111]
  ds_read_b64_tr_b16 a[198:199], v21 offset:21504
  v_exp_f32 v95, v95
  v_add_f32 v61, v61, v94
  v_add_f32 v61, v61, v95
  v_cvt_pk_bf16_f32 v91, v94, v95
  v_mfma_f32_32x32x16_bf16 v[112:127], a[200:203], v[184:187], v[112:127]
  ds_read_b64_tr_b16 a[200:201], v22 offset:20480
  v_mfma_f32_32x32x16_bf16 v[96:111], a[204:207], v[180:183], v[96:111]
  ds_read_b64_tr_b16 a[202:203], v22 offset:21504
  v_mfma_f32_32x32x16_bf16 v[112:127], a[204:207], v[188:191], v[112:127]
  ds_read_b64_tr_b16 a[204:205], v23 offset:20480
  ds_read_b64_tr_b16 a[206:207], v23 offset:21504
  s_waitcnt lgkmcnt(8)
  v_mfma_f32_32x32x16_bf16 a[0:15], a[176:179], v[64:67], a[0:15]
  s_waitcnt vmcnt(28)
  s_barrier
  v_mfma_f32_32x32x16_bf16 a[16:31], a[176:179], v[80:83], a[16:31]
  ds_read_b128 a[176:179], v8 offset:8192
  v_mfma_f32_32x32x16_bf16 a[32:47], a[180:183], v[64:67], a[32:47]
  s_add_u32 m0, s52, 8192
  s_xor_b32 s54, s58, 32768
  buffer_load_dwordx4 v42, s[24:27], s54 offen offset:0 lds
  v_mfma_f32_32x32x16_bf16 a[48:63], a[180:183], v[80:83], a[48:63]
  ds_read_b128 a[180:183], v9 offset:8192
  v_exp_f32 v96, v96
  v_exp_f32 v97, v97
  v_add_f32 v60, v60, v96
  v_mfma_f32_32x32x16_bf16 a[64:79], a[184:187], v[64:67], a[64:79]
  buffer_load_dwordx4 v43, s[24:27], s54 offen offset:1024 lds
  v_exp_f32 v98, v98
  v_add_f32 v60, v60, v97
  v_cvt_pk_bf16_f32 v96, v96, v97
  v_mfma_f32_32x32x16_bf16 a[80:95], a[184:187], v[80:83], a[80:95]
  ds_read_b128 a[184:187], v10 offset:8192
  v_exp_f32 v99, v99
  v_add_f32 v60, v60, v98
  v_exp_f32 v100, v100
  v_mfma_f32_32x32x16_bf16 a[96:111], a[188:191], v[64:67], a[96:111]
  buffer_load_dwordx4 v44, s[24:27], s54 offen offset:2048 lds
  v_add_f32 v60, v60, v99
  v_cvt_pk_bf16_f32 v97, v98, v99
  v_exp_f32 v101, v101
  v_add_f32 v60, v60, v100
  v_mfma_f32_32x32x16_bf16 a[112:127], a[188:191], v[80:83], a[112:127]
  ds_read_b128 a[188:191], v11 offset:8192
  v_exp_f32 v102, v102
  v_add_f32 v60, v60, v101
  v_cvt_pk_bf16_f32 v98, v100, v101
  s_waitcnt lgkmcnt(4)
  v_mfma_f32_32x32x16_bf16 a[0:15], a[192:195], v[72:75], a[0:15]
  buffer_load_dwordx4 v45, s[24:27], s54 offen offset:3072 lds
  v_exp_f32 v103, v103
  v_add_f32 v60, v60, v102
  v_exp_f32 v112, v112
  v_mfma_f32_32x32x16_bf16 a[16:31], a[192:195], v[88:91], a[16:31]
  ds_read_b128 a[192:195], v12 offset:8192
  v_add_f32 v60, v60, v103
  v_cvt_pk_bf16_f32 v99, v102, v103
  v_exp_f32 v113, v113
  v_add_f32 v61, v61, v112
  v_mfma_f32_32x32x16_bf16 a[32:47], a[196:199], v[72:75], a[32:47]
  s_add_u32 m0, s52, 12288
  s_xor_b32 s54, s58, 49152
  buffer_load_dwordx4 v42, s[24:27], s54 offen offset:0 lds
  v_exp_f32 v114, v114
  v_add_f32 v61, v61, v113
  v_mfma_f32_32x32x16_bf16 a[48:63], a[196:199], v[88:91], a[48:63]
  ds_read_b128 a[196:199], v13 offset:8192
  v_cvt_pk_bf16_f32 v112, v112, v113
  v_exp_f32 v115, v115
  v_add_f32 v61, v61, v114
  v_mfma_f32_32x32x16_bf16 a[64:79], a[200:203], v[72:75], a[64:79]
  buffer_load_dwordx4 v43, s[24:27], s54 offen offset:1024 lds
  v_exp_f32 v116, v116
  v_add_f32 v61, v61, v115
  v_cvt_pk_bf16_f32 v113, v114, v115
  v_mfma_f32_32x32x16_bf16 a[80:95], a[200:203], v[88:91], a[80:95]
  ds_read_b128 a[200:203], v14 offset:8192
  v_exp_f32 v117, v117
  v_add_f32 v61, v61, v116
  v_exp_f32 v118, v118
  v_mfma_f32_32x32x16_bf16 a[96:111], a[204:207], v[72:75], a[96:111]
  buffer_load_dwordx4 v44, s[24:27], s54 offen offset:2048 lds
  v_add_f32 v61, v61, v117
  v_cvt_pk_bf16_f32 v114, v116, v117
  v_exp_f32 v119, v119
  v_add_f32 v61, v61, v118
  v_mfma_f32_32x32x16_bf16 a[112:127], a[204:207], v[88:91], a[112:127]
  buffer_load_dwordx4 v45, s[24:27], s54 offen offset:3072 lds
  ds_read_b128 a[204:207], v15 offset:8192
  v_exp_f32 v104, v104
  v_add_f32 v61, v61, v119
  v_cvt_pk_bf16_f32 v115, v118, v119
  s_waitcnt lgkmcnt(4)
  v_mfma_f32_32x32x16_bf16 v[64:79], a[176:179], v[128:131], v[224:239]
  v_exp_f32 v105, v105
  v_add_f32 v60, v60, v104
  v_exp_f32 v106, v106
  v_add_f32 v60, v60, v105
  v_mfma_f32_32x32x16_bf16 v[80:95], a[176:179], v[136:139], v[240:255]
  ds_read_b64_tr_b16 a[176:177], v20 offset:36864
  v_cvt_pk_bf16_f32 v104, v104, v105
  v_exp_f32 v107, v107
  v_add_f32 v60, v60, v106
  v_mfma_f32_32x32x16_bf16 v[64:79], a[180:183], v[132:135], v[64:79]
  ds_read_b64_tr_b16 a[178:179], v20 offset:37888
  buffer_load_dwordx2 a[248:249], v47, s[8:11], s93 offen offset:0
  buffer_load_dwordx2 a[250:251], v47, s[8:11], s93 offen offset:32
  v_exp_f32 v108, v108
  v_add_f32 v60, v60, v107
  v_mfma_f32_32x32x16_bf16 v[80:95], a[180:183], v[140:143], v[80:95]
  ds_read_b64_tr_b16 a[180:181], v21 offset:36864
  v_cvt_pk_bf16_f32 v105, v106, v107
  v_exp_f32 v109, v109
  v_add_f32 v60, v60, v108
  v_mfma_f32_32x32x16_bf16 v[64:79], a[184:187], v[144:147], v[64:79]
  ds_read_b64_tr_b16 a[182:183], v21 offset:37888
  v_exp_f32 v110, v110
  v_add_f32 v60, v60, v109
  v_cvt_pk_bf16_f32 v106, v108, v109
  v_mfma_f32_32x32x16_bf16 v[80:95], a[184:187], v[152:155], v[80:95]
  ds_read_b64_tr_b16 a[184:185], v22 offset:36864
  v_exp_f32 v111, v111
  v_add_f32 v60, v60, v110
  v_exp_f32 v120, v120
  v_mfma_f32_32x32x16_bf16 v[64:79], a[188:191], v[148:151], v[64:79]
  ds_read_b64_tr_b16 a[186:187], v22 offset:37888
  buffer_load_dwordx2 a[252:253], v47, s[8:11], s93 offen offset:64
  buffer_load_dwordx2 a[254:255], v47, s[8:11], s93 offen offset:96
  v_add_f32 v60, v60, v111
  v_cvt_pk_bf16_f32 v107, v110, v111
  v_mfma_f32_32x32x16_bf16 v[80:95], a[188:191], v[156:159], v[80:95]
  ds_read_b64_tr_b16 a[188:189], v23 offset:36864
  v_exp_f32 v121, v121
  v_add_f32 v61, v61, v120
  v_exp_f32 v122, v122
  s_waitcnt lgkmcnt(7)
  v_mfma_f32_32x32x16_bf16 v[64:79], a[192:195], v[160:163], v[64:79]
  ds_read_b64_tr_b16 a[190:191], v23 offset:37888
  v_add_f32 v61, v61, v121
  v_cvt_pk_bf16_f32 v120, v120, v121
  v_exp_f32 v123, v123
  v_add_f32 v61, v61, v122
  v_mfma_f32_32x32x16_bf16 v[80:95], a[192:195], v[168:171], v[80:95]
  ds_read_b64_tr_b16 a[192:193], v20 offset:53248
  v_exp_f32 v124, v124
  v_add_f32 v61, v61, v123
  v_cvt_pk_bf16_f32 v121, v122, v123
  v_mfma_f32_32x32x16_bf16 v[64:79], a[196:199], v[164:167], v[64:79]
  ds_read_b64_tr_b16 a[194:195], v20 offset:54272
  v_exp_f32 v125, v125
  v_add_f32 v61, v61, v124
  v_exp_f32 v126, v126
  v_mfma_f32_32x32x16_bf16 v[80:95], a[196:199], v[172:175], v[80:95]
  ds_read_b64_tr_b16 a[196:197], v21 offset:53248
  v_add_f32 v61, v61, v125
  v_cvt_pk_bf16_f32 v122, v124, v125
  v_exp_f32 v127, v127
  v_add_f32 v61, v61, v126
  v_mfma_f32_32x32x16_bf16 v[64:79], a[200:203], v[176:179], v[64:79]
  ds_read_b64_tr_b16 a[198:199], v21 offset:54272
  v_add_f32 v61, v61, v127
  v_cvt_pk_bf16_f32 v123, v126, v127
  v_mfma_f32_32x32x16_bf16 v[80:95], a[200:203], v[184:187], v[80:95]
  ds_read_b64_tr_b16 a[200:201], v22 offset:53248
  v_mfma_f32_32x32x16_bf16 v[64:79], a[204:207], v[180:183], v[64:79]
  ds_read_b64_tr_b16 a[202:203], v22 offset:54272
  v_mfma_f32_32x32x16_bf16 v[80:95], a[204:207], v[188:191], v[80:95]
  ds_read_b64_tr_b16 a[204:205], v23 offset:53248
  ds_read_b64_tr_b16 a[206:207], v23 offset:54272
  s_waitcnt lgkmcnt(8)
  v_mfma_f32_32x32x16_bf16 a[0:15], a[176:179], v[96:99], a[0:15]
  v_mfma_f32_32x32x16_bf16 a[16:31], a[176:179], v[112:115], a[16:31]
  ds_read_b128 a[176:179], v8 offset:40960
  v_mfma_f32_32x32x16_bf16 a[32:47], a[180:183], v[96:99], a[32:47]
  v_mfma_f32_32x32x16_bf16 a[48:63], a[180:183], v[112:115], a[48:63]
  ds_read_b128 a[180:183], v9 offset:40960
  s_nop 0
  v_exp_f32 v64, v64
  v_exp_f32 v65, v65
  v_add_f32 v60, v60, v64
  v_mfma_f32_32x32x16_bf16 a[64:79], a[184:187], v[96:99], a[64:79]
  v_exp_f32 v66, v66
  v_add_f32 v60, v60, v65
  v_cvt_pk_bf16_f32 v64, v64, v65
  v_exp_f32 v67, v67
  v_mfma_f32_32x32x16_bf16 a[80:95], a[184:187], v[112:115], a[80:95]
  ds_read_b128 a[184:187], v10 offset:40960
  v_add_f32 v60, v60, v66
  v_exp_f32 v68, v68
  v_add_f32 v60, v60, v67
  v_cvt_pk_bf16_f32 v65, v66, v67
  v_mfma_f32_32x32x16_bf16 a[96:111], a[188:191], v[96:99], a[96:111]
  v_exp_f32 v69, v69
  v_add_f32 v60, v60, v68
  v_exp_f32 v70, v70
  v_add_f32 v60, v60, v69
  v_mfma_f32_32x32x16_bf16 a[112:127], a[188:191], v[112:115], a[112:127]
  ds_read_b128 a[188:191], v11 offset:40960
  v_cvt_pk_bf16_f32 v66, v68, v69
  v_exp_f32 v71, v71
  v_add_f32 v60, v60, v70
  s_waitcnt lgkmcnt(4)
  v_mfma_f32_32x32x16_bf16 a[0:15], a[192:195], v[104:107], a[0:15]
  v_exp_f32 v80, v80
  v_add_f32 v60, v60, v71
  v_cvt_pk_bf16_f32 v67, v70, v71
  v_exp_f32 v81, v81
  v_mfma_f32_32x32x16_bf16 a[16:31], a[192:195], v[120:123], a[16:31]
  ds_read_b128 a[192:195], v12 offset:40960
  v_add_f32 v61, v61, v80
  v_exp_f32 v82, v82
  v_add_f32 v61, v61, v81
  v_cvt_pk_bf16_f32 v80, v80, v81
  v_mfma_f32_32x32x16_bf16 a[32:47], a[196:199], v[104:107], a[32:47]
  v_exp_f32 v83, v83
  v_add_f32 v61, v61, v82
  v_exp_f32 v84, v84
  v_add_f32 v61, v61, v83
  v_mfma_f32_32x32x16_bf16 a[48:63], a[196:199], v[120:123], a[48:63]
  ds_read_b128 a[196:199], v13 offset:40960
  v_cvt_pk_bf16_f32 v81, v82, v83
  v_exp_f32 v85, v85
  v_add_f32 v61, v61, v84
  v_mfma_f32_32x32x16_bf16 a[64:79], a[200:203], v[104:107], a[64:79]
  v_exp_f32 v86, v86
  v_add_f32 v61, v61, v85
  v_cvt_pk_bf16_f32 v82, v84, v85
  v_exp_f32 v87, v87
  v_mfma_f32_32x32x16_bf16 a[80:95], a[200:203], v[120:123], a[80:95]
  ds_read_b128 a[200:203], v14 offset:40960
  v_add_f32 v61, v61, v86
  v_exp_f32 v72, v72
  v_add_f32 v61, v61, v87
  v_cvt_pk_bf16_f32 v83, v86, v87
  v_mfma_f32_32x32x16_bf16 a[96:111], a[204:207], v[104:107], a[96:111]
  v_exp_f32 v73, v73
  v_add_f32 v60, v60, v72
  v_exp_f32 v74, v74
  v_add_f32 v60, v60, v73
  v_mfma_f32_32x32x16_bf16 a[112:127], a[204:207], v[120:123], a[112:127]
  ds_read_b128 a[204:207], v15 offset:40960
  v_cvt_pk_bf16_f32 v72, v72, v73
  v_exp_f32 v75, v75
  v_add_f32 v60, v60, v74
  s_waitcnt lgkmcnt(4)
  v_mfma_f32_32x32x16_bf16 v[96:111], a[176:179], v[128:131], v[224:239]
  v_exp_f32 v76, v76
  v_add_f32 v60, v60, v75
  v_cvt_pk_bf16_f32 v73, v74, v75
  v_exp_f32 v77, v77
  v_mfma_f32_32x32x16_bf16 v[112:127], a[176:179], v[136:139], v[240:255]
  ds_read_b64_tr_b16 a[176:177], v20 offset:12288
  v_add_f32 v60, v60, v76
  v_exp_f32 v78, v78
  v_add_f32 v60, v60, v77
  v_cvt_pk_bf16_f32 v74, v76, v77
  v_mfma_f32_32x32x16_bf16 v[96:111], a[180:183], v[132:135], v[96:111]
  ds_read_b64_tr_b16 a[178:179], v20 offset:13312
  v_exp_f32 v79, v79
  v_add_f32 v60, v60, v78
  v_exp_f32 v88, v88
  v_mfma_f32_32x32x16_bf16 v[112:127], a[180:183], v[140:143], v[112:127]
  ds_read_b64_tr_b16 a[180:181], v21 offset:12288
  v_add_f32 v60, v60, v79
  v_cvt_pk_bf16_f32 v75, v78, v79
  v_exp_f32 v89, v89
  v_add_f32 v61, v61, v88
  v_mfma_f32_32x32x16_bf16 v[96:111], a[184:187], v[144:147], v[96:111]
  ds_read_b64_tr_b16 a[182:183], v21 offset:13312
  v_exp_f32 v90, v90
  v_add_f32 v61, v61, v89
  v_cvt_pk_bf16_f32 v88, v88, v89
  v_mfma_f32_32x32x16_bf16 v[112:127], a[184:187], v[152:155], v[112:127]
  ds_read_b64_tr_b16 a[184:185], v22 offset:12288
  v_exp_f32 v91, v91
  v_add_f32 v61, v61, v90
  v_exp_f32 v92, v92
  v_mfma_f32_32x32x16_bf16 v[96:111], a[188:191], v[148:151], v[96:111]
  ds_read_b64_tr_b16 a[186:187], v22 offset:13312
  v_add_f32 v61, v61, v91
  v_cvt_pk_bf16_f32 v89, v90, v91
  v_exp_f32 v93, v93
  v_add_f32 v61, v61, v92
  v_mfma_f32_32x32x16_bf16 v[112:127], a[188:191], v[156:159], v[112:127]
  ds_read_b64_tr_b16 a[188:189], v23 offset:12288
  v_exp_f32 v94, v94
  v_add_f32 v61, v61, v93
  v_cvt_pk_bf16_f32 v90, v92, v93
  s_waitcnt lgkmcnt(7)
  v_mfma_f32_32x32x16_bf16 v[96:111], a[192:195], v[160:163], v[96:111]
  ds_read_b64_tr_b16 a[190:191], v23 offset:13312
  v_exp_f32 v95, v95
  v_add_f32 v61, v61, v94
  v_add_f32 v61, v61, v95
  v_cvt_pk_bf16_f32 v91, v94, v95
  v_mfma_f32_32x32x16_bf16 v[112:127], a[192:195], v[168:171], v[112:127]
  ds_read_b64_tr_b16 a[192:193], v20 offset:28672
  v_mfma_f32_32x32x16_bf16 v[96:111], a[196:199], v[164:167], v[96:111]
  ds_read_b64_tr_b16 a[194:195], v20 offset:29696
  v_mfma_f32_32x32x16_bf16 v[112:127], a[196:199], v[172:175], v[112:127]
  ds_read_b64_tr_b16 a[196:197], v21 offset:28672
  v_mfma_f32_32x32x16_bf16 v[96:111], a[200:203], v[176:179], v[96:111]
  ds_read_b64_tr_b16 a[198:199], v21 offset:29696
  v_mfma_f32_32x32x16_bf16 v[112:127], a[200:203], v[184:187], v[112:127]
  ds_read_b64_tr_b16 a[200:201], v22 offset:28672
  v_mfma_f32_32x32x16_bf16 v[96:111], a[204:207], v[180:183], v[96:111]
  ds_read_b64_tr_b16 a[202:203], v22 offset:29696
  v_mfma_f32_32x32x16_bf16 v[112:127], a[204:207], v[188:191], v[112:127]
  ds_read_b64_tr_b16 a[204:205], v23 offset:28672
  ds_read_b64_tr_b16 a[206:207], v23 offset:29696
  s_waitcnt lgkmcnt(8)
  v_mfma_f32_32x32x16_bf16 a[0:15], a[176:179], v[64:67], a[0:15]
  v_mfma_f32_32x32x16_bf16 a[16:31], a[176:179], v[80:83], a[16:31]
  ds_read_b64_tr_b16 a[176:177], v20 offset:45056
  v_mfma_f32_32x32x16_bf16 a[32:47], a[180:183], v[64:67], a[32:47]
  ds_read_b64_tr_b16 a[178:179], v20 offset:46080
  v_mfma_f32_32x32x16_bf16 a[48:63], a[180:183], v[80:83], a[48:63]
  ds_read_b64_tr_b16 a[180:181], v21 offset:45056
  v_exp_f32 v96, v96
  v_exp_f32 v97, v97
  v_add_f32 v60, v60, v96
  v_mfma_f32_32x32x16_bf16 a[64:79], a[184:187], v[64:67], a[64:79]
  ds_read_b64_tr_b16 a[182:183], v21 offset:46080
  v_exp_f32 v98, v98
  v_add_f32 v60, v60, v97
  v_cvt_pk_bf16_f32 v96, v96, v97
  v_exp_f32 v99, v99
  v_mfma_f32_32x32x16_bf16 a[80:95], a[184:187], v[80:83], a[80:95]
  ds_read_b64_tr_b16 a[184:185], v22 offset:45056
  v_add_f32 v60, v60, v98
  v_exp_f32 v100, v100
  v_add_f32 v60, v60, v99
  v_cvt_pk_bf16_f32 v97, v98, v99
  v_mfma_f32_32x32x16_bf16 a[96:111], a[188:191], v[64:67], a[96:111]
  ds_read_b64_tr_b16 a[186:187], v22 offset:46080
  v_exp_f32 v101, v101
  v_add_f32 v60, v60, v100
  v_exp_f32 v102, v102
  v_add_f32 v60, v60, v101
  v_mfma_f32_32x32x16_bf16 a[112:127], a[188:191], v[80:83], a[112:127]
  ds_read_b64_tr_b16 a[188:189], v23 offset:45056
  v_cvt_pk_bf16_f32 v98, v100, v101
  v_exp_f32 v103, v103
  v_add_f32 v60, v60, v102
  v_exp_f32 v112, v112
  s_waitcnt lgkmcnt(7)
  v_mfma_f32_32x32x16_bf16 a[0:15], a[192:195], v[72:75], a[0:15]
  ds_read_b64_tr_b16 a[190:191], v23 offset:46080
  v_add_f32 v60, v60, v103
  v_cvt_pk_bf16_f32 v99, v102, v103
  v_exp_f32 v113, v113
  v_add_f32 v61, v61, v112
  v_mfma_f32_32x32x16_bf16 a[16:31], a[192:195], v[88:91], a[16:31]
  ds_read_b64_tr_b16 a[192:193], v20 offset:61440
  v_exp_f32 v114, v114
  v_add_f32 v61, v61, v113
  v_cvt_pk_bf16_f32 v112, v112, v113
  v_exp_f32 v115, v115
  v_mfma_f32_32x32x16_bf16 a[32:47], a[196:199], v[72:75], a[32:47]
  ds_read_b64_tr_b16 a[194:195], v20 offset:62464
  v_add_f32 v61, v61, v114
  v_exp_f32 v116, v116
  v_add_f32 v61, v61, v115
  v_cvt_pk_bf16_f32 v113, v114, v115
  v_mfma_f32_32x32x16_bf16 a[48:63], a[196:199], v[88:91], a[48:63]
  ds_read_b64_tr_b16 a[196:197], v21 offset:61440
  v_exp_f32 v117, v117
  v_add_f32 v61, v61, v116
  v_exp_f32 v118, v118
  v_add_f32 v61, v61, v117
  v_mfma_f32_32x32x16_bf16 a[64:79], a[200:203], v[72:75], a[64:79]
  ds_read_b64_tr_b16 a[198:199], v21 offset:62464
  v_cvt_pk_bf16_f32 v114, v116, v117
  v_exp_f32 v119, v119
  v_add_f32 v61, v61, v118
  v_exp_f32 v104, v104
  v_mfma_f32_32x32x16_bf16 a[80:95], a[200:203], v[88:91], a[80:95]
  ds_read_b64_tr_b16 a[200:201], v22 offset:61440
  v_add_f32 v61, v61, v119
  v_cvt_pk_bf16_f32 v115, v118, v119
  v_exp_f32 v105, v105
  v_add_f32 v60, v60, v104
  v_mfma_f32_32x32x16_bf16 a[96:111], a[204:207], v[72:75], a[96:111]
  ds_read_b64_tr_b16 a[202:203], v22 offset:62464
  v_exp_f32 v106, v106
  v_add_f32 v60, v60, v105
  v_cvt_pk_bf16_f32 v104, v104, v105
  v_exp_f32 v107, v107
  v_mfma_f32_32x32x16_bf16 a[112:127], a[204:207], v[88:91], a[112:127]
  ds_read_b64_tr_b16 a[204:205], v23 offset:61440
  ds_read_b64_tr_b16 a[206:207], v23 offset:62464
  v_add_f32 v60, v60, v106
  v_exp_f32 v108, v108
  v_add_f32 v60, v60, v107
  v_cvt_pk_bf16_f32 v105, v106, v107
  v_mov_b32 v4, 0x4e800000
  s_waitcnt lgkmcnt(8)
  v_mfma_f32_32x32x16_bf16 a[0:15], a[176:179], v[96:99], a[0:15]
  v_exp_f32 v109, v109
  v_add_f32 v60, v60, v108
  v_exp_f32 v110, v110
  v_add_f32 v60, v60, v109
  v_cvt_pk_bf16_f32 v106, v108, v109
  v_mfma_f32_32x32x16_bf16 a[16:31], a[176:179], v[112:115], a[16:31]
  v_exp_f32 v111, v111
  v_add_f32 v60, v60, v110
  v_exp_f32 v120, v120
  v_add_f32 v60, v60, v111
  v_cvt_pk_bf16_f32 v107, v110, v111
  v_mfma_f32_32x32x16_bf16 a[32:47], a[180:183], v[96:99], a[32:47]
  v_exp_f32 v121, v121
  v_add_f32 v61, v61, v120
  v_exp_f32 v122, v122
  v_add_f32 v61, v61, v121
  v_cvt_pk_bf16_f32 v120, v120, v121
  v_mfma_f32_32x32x16_bf16 a[48:63], a[180:183], v[112:115], a[48:63]
  v_exp_f32 v123, v123
  v_add_f32 v61, v61, v122
  v_exp_f32 v124, v124
  v_add_f32 v61, v61, v123
  v_cvt_pk_bf16_f32 v121, v122, v123
  v_mfma_f32_32x32x16_bf16 a[64:79], a[184:187], v[96:99], a[64:79]
  v_exp_f32 v125, v125
  v_add_f32 v61, v61, v124
  v_exp_f32 v126, v126
  v_add_f32 v61, v61, v125
  v_cvt_pk_bf16_f32 v122, v124, v125
  v_mfma_f32_32x32x16_bf16 a[80:95], a[184:187], v[112:115], a[80:95]
  v_exp_f32 v127, v127
  v_add_f32 v61, v61, v126
  v_add_f32 v61, v61, v127
  v_cvt_pk_bf16_f32 v123, v126, v127
  v_mfma_f32_32x32x16_bf16 a[96:111], a[188:191], v[96:99], a[96:111]
  v_mfma_f32_32x32x16_bf16 a[112:127], a[188:191], v[112:115], a[112:127]
  s_waitcnt lgkmcnt(0)
  v_mfma_f32_32x32x16_bf16 a[0:15], a[192:195], v[104:107], a[0:15]
  s_barrier
  v_mfma_f32_32x32x16_bf16 a[16:31], a[192:195], v[120:123], a[16:31]
  v_mov_b32 v2, v60
  v_mov_b32 v3, v61
  s_nop 0
  v_permlane32_swap_b32 v2, v60
  v_permlane32_swap_b32 v3, v61
  v_add_f32 v60, v60, v2
  v_add_f32 v61, v61, v3
  v_mfma_f32_32x32x16_bf16 a[32:47], a[196:199], v[104:107], a[32:47]
  v_rcp_f32 v32, v60
  v_rcp_f32 v33, v61
  v_add_f32 v2, v60, v61
  v_cmp_nle_f32 vcc, v2, v4
  v_lshrrev_b32 v6, 2, v1
  v_mfma_f32_32x32x16_bf16 a[48:63], a[196:199], v[120:123], a[48:63]
  v_and_b32 v5, 3, v1
  v_lshlrev_b32 v5, 3, v5
  v_lshl_add_u32 v7, v6, 8, v5
  v_and_b32 v6, 7, v6
  v_lshl_add_u32 v7, v6, 5, v7
  v_add_u32 v240, s52, v7
  v_xor_b32 v241, 32, v240
  v_mfma_f32_32x32x16_bf16 a[64:79], a[200:203], v[104:107], a[64:79]
  v_xor_b32 v242, 64, v240
  v_xor_b32 v243, 96, v240
  v_xor_b32 v244, 128, v240
  v_xor_b32 v245, 160, v240
  v_xor_b32 v246, 192, v240
  v_xor_b32 v247, 224, v240
  v_mfma_f32_32x32x16_bf16 a[80:95], a[200:203], v[120:123], a[80:95]
  v_mfma_f32_32x32x16_bf16 a[96:111], a[204:207], v[104:107], a[96:111]
  v_mfma_f32_32x32x16_bf16 a[112:127], a[204:207], v[120:123], a[112:127]
  s_cbranch_vccnz Lslow
Lrejoin:
  s_waitcnt vmcnt(10)
  v_accvgpr_read_b32 v96, a0
  v_accvgpr_read_b32 v97, a1
  v_accvgpr_read_b32 v98, a2
  s_add_u32 s55, s68, 0
  s_sub_u32 s3, s55, 57344
  s_min_u32 s55, s55, s3
  buffer_load_dwordx4 v[128:131], v46, s[84:87], s55 offen offset:0 sc1
  v_accvgpr_read_b32 v99, a3
  v_accvgpr_read_b32 v100, a4
  v_accvgpr_read_b32 v101, a5
  v_accvgpr_read_b32 v102, a6
  buffer_load_dwordx4 v[132:135], v46, s[84:87], s55 offen offset:1024 sc1
  v_accvgpr_read_b32 v103, a7
  v_xor_b32 v53, 0, v49
  v_pk_mul_f32 v[96:97], v[96:97], v[32:33] op_sel:[0,0] op_sel_hi:[1,0]
  v_pk_mul_f32 v[98:99], v[98:99], v[32:33] op_sel:[0,0] op_sel_hi:[1,0]
  v_pk_mul_f32 v[100:101], v[100:101], v[32:33] op_sel:[0,0] op_sel_hi:[1,0]
  v_pk_mul_f32 v[102:103], v[102:103], v[32:33] op_sel:[0,0] op_sel_hi:[1,0]
  buffer_load_dwordx4 v[136:139], v46, s[84:87], s55 offen offset:2048 sc1
  v_cvt_pk_bf16_f32 v104, v96, v97
  v_cvt_pk_bf16_f32 v105, v98, v99
  v_cvt_pk_bf16_f32 v106, v100, v101
  v_cvt_pk_bf16_f32 v107, v102, v103
  ds_write_b128 v53, v[104:107] offset:0
  v_accvgpr_read_b32 v112, a8
  v_accvgpr_read_b32 v113, a9
  v_accvgpr_read_b32 v114, a10
  buffer_load_dwordx4 v[140:143], v46, s[84:87], s55 offen offset:3072 sc1
  v_accvgpr_read_b32 v115, a11
  v_accvgpr_read_b32 v116, a12
  v_accvgpr_read_b32 v117, a13
  v_accvgpr_read_b32 v118, a14
  s_add_u32 s55, s68, 4096
  s_sub_u32 s3, s55, 57344
  s_min_u32 s55, s55, s3
  buffer_load_dwordx4 v[144:147], v46, s[84:87], s55 offen offset:0 sc1
  v_accvgpr_read_b32 v119, a15
  v_xor_b32 v52, 32, v49
  v_pk_mul_f32 v[112:113], v[112:113], v[32:33] op_sel:[0,0] op_sel_hi:[1,0]
  v_pk_mul_f32 v[114:115], v[114:115], v[32:33] op_sel:[0,0] op_sel_hi:[1,0]
  v_pk_mul_f32 v[116:117], v[116:117], v[32:33] op_sel:[0,0] op_sel_hi:[1,0]
  v_pk_mul_f32 v[118:119], v[118:119], v[32:33] op_sel:[0,0] op_sel_hi:[1,0]
  buffer_load_dwordx4 v[148:151], v46, s[84:87], s55 offen offset:1024 sc1
  v_cvt_pk_bf16_f32 v120, v112, v113
  v_cvt_pk_bf16_f32 v121, v114, v115
  v_cvt_pk_bf16_f32 v122, v116, v117
  v_cvt_pk_bf16_f32 v123, v118, v119
  ds_write_b128 v52, v[120:123] offset:0
  v_accvgpr_read_b32 v96, a16
  v_accvgpr_read_b32 v97, a17
  v_accvgpr_read_b32 v98, a18
  buffer_load_dwordx4 v[152:155], v46, s[84:87], s55 offen offset:2048 sc1
  v_accvgpr_read_b32 v99, a19
  v_accvgpr_read_b32 v100, a20
  v_accvgpr_read_b32 v101, a21
  v_accvgpr_read_b32 v102, a22
  buffer_load_dwordx4 v[156:159], v46, s[84:87], s55 offen offset:3072 sc1
  v_accvgpr_read_b32 v103, a23
  v_xor_b32 v53, 0, v49
  v_pk_mul_f32 v[96:97], v[96:97], v[32:33] op_sel:[0,1] op_sel_hi:[1,1]
  v_pk_mul_f32 v[98:99], v[98:99], v[32:33] op_sel:[0,1] op_sel_hi:[1,1]
  v_pk_mul_f32 v[100:101], v[100:101], v[32:33] op_sel:[0,1] op_sel_hi:[1,1]
  v_pk_mul_f32 v[102:103], v[102:103], v[32:33] op_sel:[0,1] op_sel_hi:[1,1]
  s_add_u32 s55, s68, 8192
  s_sub_u32 s3, s55, 57344
  s_min_u32 s55, s55, s3
  buffer_load_dwordx4 v[160:163], v46, s[84:87], s55 offen offset:0 sc1
  v_cvt_pk_bf16_f32 v104, v96, v97
  v_cvt_pk_bf16_f32 v105, v98, v99
  v_cvt_pk_bf16_f32 v106, v100, v101
  v_cvt_pk_bf16_f32 v107, v102, v103
  ds_write_b128 v53, v[104:107] offset:32768
  v_accvgpr_read_b32 v112, a24
  v_accvgpr_read_b32 v113, a25
  v_accvgpr_read_b32 v114, a26
  buffer_load_dwordx4 v[164:167], v46, s[84:87], s55 offen offset:1024 sc1
  v_accvgpr_read_b32 v115, a27
  v_accvgpr_read_b32 v116, a28
  v_accvgpr_read_b32 v117, a29
  v_accvgpr_read_b32 v118, a30
  buffer_load_dwordx4 v[168:171], v46, s[84:87], s55 offen offset:2048 sc1
  v_accvgpr_read_b32 v119, a31
  v_xor_b32 v52, 32, v49
  v_pk_mul_f32 v[112:113], v[112:113], v[32:33] op_sel:[0,1] op_sel_hi:[1,1]
  v_pk_mul_f32 v[114:115], v[114:115], v[32:33] op_sel:[0,1] op_sel_hi:[1,1]
  v_pk_mul_f32 v[116:117], v[116:117], v[32:33] op_sel:[0,1] op_sel_hi:[1,1]
  v_pk_mul_f32 v[118:119], v[118:119], v[32:33] op_sel:[0,1] op_sel_hi:[1,1]
  buffer_load_dwordx4 v[172:175], v46, s[84:87], s55 offen offset:3072 sc1
  v_cvt_pk_bf16_f32 v120, v112, v113
  v_cvt_pk_bf16_f32 v121, v114, v115
  v_cvt_pk_bf16_f32 v122, v116, v117
  v_cvt_pk_bf16_f32 v123, v118, v119
  ds_write_b128 v52, v[120:123] offset:32768
  v_accvgpr_read_b32 v96, a32
  v_accvgpr_read_b32 v97, a33
  v_accvgpr_read_b32 v98, a34
  s_add_u32 s55, s68, 12288
  s_sub_u32 s3, s55, 57344
  s_min_u32 s55, s55, s3
  buffer_load_dwordx4 v[176:179], v46, s[84:87], s55 offen offset:0 sc1
  v_accvgpr_read_b32 v99, a35
  v_accvgpr_read_b32 v100, a36
  v_accvgpr_read_b32 v101, a37
  v_accvgpr_read_b32 v102, a38
  buffer_load_dwordx4 v[180:183], v46, s[84:87], s55 offen offset:1024 sc1
  v_accvgpr_read_b32 v103, a39
  v_xor_b32 v53, 64, v49
  v_pk_mul_f32 v[96:97], v[96:97], v[32:33] op_sel:[0,0] op_sel_hi:[1,0]
  v_pk_mul_f32 v[98:99], v[98:99], v[32:33] op_sel:[0,0] op_sel_hi:[1,0]
  v_pk_mul_f32 v[100:101], v[100:101], v[32:33] op_sel:[0,0] op_sel_hi:[1,0]
  v_pk_mul_f32 v[102:103], v[102:103], v[32:33] op_sel:[0,0] op_sel_hi:[1,0]
  buffer_load_dwordx4 v[184:187], v46, s[84:87], s55 offen offset:2048 sc1
  v_cvt_pk_bf16_f32 v104, v96, v97
  v_cvt_pk_bf16_f32 v105, v98, v99
  v_cvt_pk_bf16_f32 v106, v100, v101
  v_cvt_pk_bf16_f32 v107, v102, v103
  ds_write_b128 v53, v[104:107] offset:0
  v_accvgpr_read_b32 v112, a40
  v_accvgpr_read_b32 v113, a41
  v_accvgpr_read_b32 v114, a42
  buffer_load_dwordx4 v[188:191], v46, s[84:87], s55 offen offset:3072 sc1
  v_accvgpr_read_b32 v115, a43
  v_accvgpr_read_b32 v116, a44
  v_accvgpr_read_b32 v117, a45
  v_accvgpr_read_b32 v118, a46
  s_add_u32 s55, s68, 16384
  s_sub_u32 s3, s55, 57344
  s_min_u32 s55, s55, s3
  buffer_load_dwordx4 v[224:227], v46, s[84:87], s55 offen offset:0 sc1
  v_accvgpr_read_b32 v119, a47
  v_xor_b32 v52, 96, v49
  v_pk_mul_f32 v[112:113], v[112:113], v[32:33] op_sel:[0,0] op_sel_hi:[1,0]
  v_pk_mul_f32 v[114:115], v[114:115], v[32:33] op_sel:[0,0] op_sel_hi:[1,0]
  v_pk_mul_f32 v[116:117], v[116:117], v[32:33] op_sel:[0,0] op_sel_hi:[1,0]
  v_pk_mul_f32 v[118:119], v[118:119], v[32:33] op_sel:[0,0] op_sel_hi:[1,0]
  buffer_load_dwordx4 v[228:231], v46, s[84:87], s55 offen offset:1024 sc1
  v_cvt_pk_bf16_f32 v120, v112, v113
  v_cvt_pk_bf16_f32 v121, v114, v115
  v_cvt_pk_bf16_f32 v122, v116, v117
  v_cvt_pk_bf16_f32 v123, v118, v119
  ds_write_b128 v52, v[120:123] offset:0
  v_accvgpr_read_b32 v96, a48
  v_accvgpr_read_b32 v97, a49
  v_accvgpr_read_b32 v98, a50
  buffer_load_dwordx4 v[232:235], v46, s[84:87], s55 offen offset:2048 sc1
  v_accvgpr_read_b32 v99, a51
  v_accvgpr_read_b32 v100, a52
  v_accvgpr_read_b32 v101, a53
  v_accvgpr_read_b32 v102, a54
  buffer_load_dwordx4 v[236:239], v46, s[84:87], s55 offen offset:3072 sc1
  v_accvgpr_read_b32 v103, a55
  v_xor_b32 v53, 64, v49
  v_pk_mul_f32 v[96:97], v[96:97], v[32:33] op_sel:[0,1] op_sel_hi:[1,1]
  v_pk_mul_f32 v[98:99], v[98:99], v[32:33] op_sel:[0,1] op_sel_hi:[1,1]
  v_pk_mul_f32 v[100:101], v[100:101], v[32:33] op_sel:[0,1] op_sel_hi:[1,1]
  v_pk_mul_f32 v[102:103], v[102:103], v[32:33] op_sel:[0,1] op_sel_hi:[1,1]
  ds_read_b64_tr_b16 v[64:65], v240 offset:0
  ds_read_b64_tr_b16 v[68:69], v241 offset:0
  v_cvt_pk_bf16_f32 v104, v96, v97
  v_cvt_pk_bf16_f32 v105, v98, v99
  v_cvt_pk_bf16_f32 v106, v100, v101
  v_cvt_pk_bf16_f32 v107, v102, v103
  ds_write_b128 v53, v[104:107] offset:32768
  v_accvgpr_read_b32 v112, a56
  v_accvgpr_read_b32 v113, a57
  v_accvgpr_read_b32 v114, a58
  ds_read_b64_tr_b16 v[72:73], v242 offset:0
  ds_read_b64_tr_b16 v[76:77], v243 offset:0
  v_accvgpr_read_b32 v115, a59
  v_accvgpr_read_b32 v116, a60
  v_accvgpr_read_b32 v117, a61
  v_accvgpr_read_b32 v118, a62
  ds_read_b64_tr_b16 v[80:81], v244 offset:0
  ds_read_b64_tr_b16 v[84:85], v245 offset:0
  v_accvgpr_read_b32 v119, a63
  v_xor_b32 v52, 96, v49
  v_pk_mul_f32 v[112:113], v[112:113], v[32:33] op_sel:[0,1] op_sel_hi:[1,1]
  v_pk_mul_f32 v[114:115], v[114:115], v[32:33] op_sel:[0,1] op_sel_hi:[1,1]
  v_pk_mul_f32 v[116:117], v[116:117], v[32:33] op_sel:[0,1] op_sel_hi:[1,1]
  v_pk_mul_f32 v[118:119], v[118:119], v[32:33] op_sel:[0,1] op_sel_hi:[1,1]
  ds_read_b64_tr_b16 v[88:89], v246 offset:0
  ds_read_b64_tr_b16 v[92:93], v247 offset:0
  v_cvt_pk_bf16_f32 v120, v112, v113
  v_cvt_pk_bf16_f32 v121, v114, v115
  v_cvt_pk_bf16_f32 v122, v116, v117
  v_cvt_pk_bf16_f32 v123, v118, v119
  ds_write_b128 v52, v[120:123] offset:32768
  v_accvgpr_read_b32 v96, a64
  v_accvgpr_read_b32 v97, a65
  v_accvgpr_read_b32 v98, a66
  ds_read_b64_tr_b16 v[66:67], v240 offset:4096
  ds_read_b64_tr_b16 v[70:71], v241 offset:4096
  v_accvgpr_read_b32 v99, a67
  v_accvgpr_read_b32 v100, a68
  v_accvgpr_read_b32 v101, a69
  v_accvgpr_read_b32 v102, a70
  ds_read_b64_tr_b16 v[74:75], v242 offset:4096
  ds_read_b64_tr_b16 v[78:79], v243 offset:4096
  v_accvgpr_read_b32 v103, a71
  v_xor_b32 v53, 128, v49
  v_pk_mul_f32 v[96:97], v[96:97], v[32:33] op_sel:[0,0] op_sel_hi:[1,0]
  v_pk_mul_f32 v[98:99], v[98:99], v[32:33] op_sel:[0,0] op_sel_hi:[1,0]
  v_pk_mul_f32 v[100:101], v[100:101], v[32:33] op_sel:[0,0] op_sel_hi:[1,0]
  v_pk_mul_f32 v[102:103], v[102:103], v[32:33] op_sel:[0,0] op_sel_hi:[1,0]
  ds_read_b64_tr_b16 v[82:83], v244 offset:4096
  ds_read_b64_tr_b16 v[86:87], v245 offset:4096
  v_cvt_pk_bf16_f32 v104, v96, v97
  v_cvt_pk_bf16_f32 v105, v98, v99
  v_cvt_pk_bf16_f32 v106, v100, v101
  v_cvt_pk_bf16_f32 v107, v102, v103
  ds_write_b128 v53, v[104:107] offset:0
  v_accvgpr_read_b32 v112, a72
  v_accvgpr_read_b32 v113, a73
  v_accvgpr_read_b32 v114, a74
  ds_read_b64_tr_b16 v[90:91], v246 offset:4096
  ds_read_b64_tr_b16 v[94:95], v247 offset:4096
  v_accvgpr_read_b32 v115, a75
  v_accvgpr_read_b32 v116, a76
  v_accvgpr_read_b32 v117, a77
  v_accvgpr_read_b32 v118, a78
  v_accvgpr_read_b32 v119, a79
  v_xor_b32 v52, 160, v49
  v_pk_mul_f32 v[112:113], v[112:113], v[32:33] op_sel:[0,0] op_sel_hi:[1,0]
  v_pk_mul_f32 v[114:115], v[114:115], v[32:33] op_sel:[0,0] op_sel_hi:[1,0]
  v_pk_mul_f32 v[116:117], v[116:117], v[32:33] op_sel:[0,0] op_sel_hi:[1,0]
  v_pk_mul_f32 v[118:119], v[118:119], v[32:33] op_sel:[0,0] op_sel_hi:[1,0]
  v_cvt_pk_bf16_f32 v120, v112, v113
  v_cvt_pk_bf16_f32 v121, v114, v115
  v_cvt_pk_bf16_f32 v122, v116, v117
  v_cvt_pk_bf16_f32 v123, v118, v119
  ds_write_b128 v52, v[120:123] offset:0
  v_accvgpr_read_b32 v96, a80
  v_accvgpr_read_b32 v97, a81
  v_accvgpr_read_b32 v98, a82
  v_accvgpr_read_b32 v99, a83
  v_accvgpr_read_b32 v100, a84
  v_accvgpr_read_b32 v101, a85
  v_accvgpr_read_b32 v102, a86
  v_accvgpr_read_b32 v103, a87
  v_xor_b32 v53, 128, v49
  v_pk_mul_f32 v[96:97], v[96:97], v[32:33] op_sel:[0,1] op_sel_hi:[1,1]
  v_pk_mul_f32 v[98:99], v[98:99], v[32:33] op_sel:[0,1] op_sel_hi:[1,1]
  v_pk_mul_f32 v[100:101], v[100:101], v[32:33] op_sel:[0,1] op_sel_hi:[1,1]
  v_pk_mul_f32 v[102:103], v[102:103], v[32:33] op_sel:[0,1] op_sel_hi:[1,1]
  v_cvt_pk_bf16_f32 v104, v96, v97
  v_cvt_pk_bf16_f32 v105, v98, v99
  v_cvt_pk_bf16_f32 v106, v100, v101
  v_cvt_pk_bf16_f32 v107, v102, v103
  ds_write_b128 v53, v[104:107] offset:32768
  v_accvgpr_read_b32 v112, a88
  v_accvgpr_read_b32 v113, a89
  v_accvgpr_read_b32 v114, a90
  v_accvgpr_read_b32 v115, a91
  v_accvgpr_read_b32 v116, a92
  v_accvgpr_read_b32 v117, a93
  v_accvgpr_read_b32 v118, a94
  v_accvgpr_read_b32 v119, a95
  v_xor_b32 v52, 160, v49
  v_pk_mul_f32 v[112:113], v[112:113], v[32:33] op_sel:[0,1] op_sel_hi:[1,1]
  v_pk_mul_f32 v[114:115], v[114:115], v[32:33] op_sel:[0,1] op_sel_hi:[1,1]
  v_pk_mul_f32 v[116:117], v[116:117], v[32:33] op_sel:[0,1] op_sel_hi:[1,1]
  v_pk_mul_f32 v[118:119], v[118:119], v[32:33] op_sel:[0,1] op_sel_hi:[1,1]
  v_cvt_pk_bf16_f32 v120, v112, v113
  v_cvt_pk_bf16_f32 v121, v114, v115
  v_cvt_pk_bf16_f32 v122, v116, v117
  v_cvt_pk_bf16_f32 v123, v118, v119
  ds_write_b128 v52, v[120:123] offset:32768
  v_accvgpr_read_b32 v96, a96
  v_accvgpr_read_b32 v97, a97
  v_accvgpr_read_b32 v98, a98
  v_accvgpr_read_b32 v99, a99
  v_accvgpr_read_b32 v100, a100
  v_accvgpr_read_b32 v101, a101
  v_accvgpr_read_b32 v102, a102
  v_accvgpr_read_b32 v103, a103
  v_xor_b32 v53, 192, v49
  v_pk_mul_f32 v[96:97], v[96:97], v[32:33] op_sel:[0,0] op_sel_hi:[1,0]
  v_pk_mul_f32 v[98:99], v[98:99], v[32:33] op_sel:[0,0] op_sel_hi:[1,0]
  v_pk_mul_f32 v[100:101], v[100:101], v[32:33] op_sel:[0,0] op_sel_hi:[1,0]
  v_pk_mul_f32 v[102:103], v[102:103], v[32:33] op_sel:[0,0] op_sel_hi:[1,0]
  v_cvt_pk_bf16_f32 v104, v96, v97
  v_cvt_pk_bf16_f32 v105, v98, v99
  v_cvt_pk_bf16_f32 v106, v100, v101
  v_cvt_pk_bf16_f32 v107, v102, v103
  ds_write_b128 v53, v[104:107] offset:0
  v_accvgpr_read_b32 v112, a104
  v_accvgpr_read_b32 v113, a105
  v_accvgpr_read_b32 v114, a106
  v_accvgpr_read_b32 v115, a107
  v_accvgpr_read_b32 v116, a108
  v_accvgpr_read_b32 v117, a109
  v_accvgpr_read_b32 v118, a110
  v_accvgpr_read_b32 v119, a111
  v_xor_b32 v52, 224, v49
  v_pk_mul_f32 v[112:113], v[112:113], v[32:33] op_sel:[0,0] op_sel_hi:[1,0]
  v_pk_mul_f32 v[114:115], v[114:115], v[32:33] op_sel:[0,0] op_sel_hi:[1,0]
  v_pk_mul_f32 v[116:117], v[116:117], v[32:33] op_sel:[0,0] op_sel_hi:[1,0]
  v_pk_mul_f32 v[118:119], v[118:119], v[32:33] op_sel:[0,0] op_sel_hi:[1,0]
  v_cvt_pk_bf16_f32 v120, v112, v113
  v_cvt_pk_bf16_f32 v121, v114, v115
  v_cvt_pk_bf16_f32 v122, v116, v117
  v_cvt_pk_bf16_f32 v123, v118, v119
  ds_write_b128 v52, v[120:123] offset:0
  v_accvgpr_read_b32 v96, a112
  v_accvgpr_read_b32 v97, a113
  v_accvgpr_read_b32 v98, a114
  v_accvgpr_read_b32 v99, a115
  v_accvgpr_read_b32 v100, a116
  v_accvgpr_read_b32 v101, a117
  v_accvgpr_read_b32 v102, a118
  v_accvgpr_read_b32 v103, a119
  v_xor_b32 v53, 192, v49
  v_pk_mul_f32 v[96:97], v[96:97], v[32:33] op_sel:[0,1] op_sel_hi:[1,1]
  v_pk_mul_f32 v[98:99], v[98:99], v[32:33] op_sel:[0,1] op_sel_hi:[1,1]
  v_pk_mul_f32 v[100:101], v[100:101], v[32:33] op_sel:[0,1] op_sel_hi:[1,1]
  v_pk_mul_f32 v[102:103], v[102:103], v[32:33] op_sel:[0,1] op_sel_hi:[1,1]
  v_cvt_pk_bf16_f32 v104, v96, v97
  v_cvt_pk_bf16_f32 v105, v98, v99
  v_cvt_pk_bf16_f32 v106, v100, v101
  v_cvt_pk_bf16_f32 v107, v102, v103
  ds_write_b128 v53, v[104:107] offset:32768
  v_accvgpr_read_b32 v112, a120
  v_accvgpr_read_b32 v113, a121
  v_accvgpr_read_b32 v114, a122
  v_accvgpr_read_b32 v115, a123
  v_accvgpr_read_b32 v116, a124
  v_accvgpr_read_b32 v117, a125
  v_accvgpr_read_b32 v118, a126
  v_accvgpr_read_b32 v119, a127
  v_xor_b32 v52, 224, v49
  v_pk_mul_f32 v[112:113], v[112:113], v[32:33] op_sel:[0,1] op_sel_hi:[1,1]
  v_pk_mul_f32 v[114:115], v[114:115], v[32:33] op_sel:[0,1] op_sel_hi:[1,1]
  v_pk_mul_f32 v[116:117], v[116:117], v[32:33] op_sel:[0,1] op_sel_hi:[1,1]
  v_pk_mul_f32 v[118:119], v[118:119], v[32:33] op_sel:[0,1] op_sel_hi:[1,1]
  v_cvt_pk_bf16_f32 v120, v112, v113
  v_cvt_pk_bf16_f32 v121, v114, v115
  v_cvt_pk_bf16_f32 v122, v116, v117
  v_cvt_pk_bf16_f32 v123, v118, v119
  ds_write_b128 v52, v[120:123] offset:32768
  s_waitcnt lgkmcnt(0)
  s_barrier
  v_xor_b32 v36, 0, v35
  ds_read_b128 a[176:179], v36 offset:0
  ds_read_b128 a[180:183], v36 offset:16384
  ds_read_b128 a[184:187], v36 offset:32768
  ds_read_b128 a[188:191], v36 offset:49152
  s_add_u32 m0, s52, 0
  s_xor_b32 s54, s58, 65536
  buffer_load_dwordx4 v42, s[24:27], s54 offen offset:0 lds
  buffer_load_dwordx4 v43, s[24:27], s54 offen offset:1024 lds
  buffer_load_dwordx4 v44, s[24:27], s54 offen offset:2048 lds
  buffer_load_dwordx4 v45, s[24:27], s54 offen offset:3072 lds
  s_waitcnt vmcnt(32) lgkmcnt(0)
  v_mfma_f32_16x16x32_bf16 a[0:3], v[64:67], a[176:179], 0
  v_xor_b32 v36, 64, v35
  ds_read_b128 a[192:195], v36 offset:0
  v_mfma_f32_16x16x32_bf16 a[4:7], v[64:67], a[180:183], 0
  ds_read_b128 a[196:199], v36 offset:16384
  ds_read_b128 a[200:203], v36 offset:32768
  v_mfma_f32_16x16x32_bf16 a[8:11], v[64:67], a[184:187], 0
  ds_read_b128 a[204:207], v36 offset:49152
  v_mfma_f32_16x16x32_bf16 a[12:15], v[64:67], a[188:191], 0
  ds_read_b64_tr_b16 v[96:97], v240 offset:8192
  ds_read_b64_tr_b16 v[100:101], v241 offset:8192
  v_mfma_f32_16x16x32_bf16 a[16:19], v[68:71], a[176:179], 0
  ds_read_b64_tr_b16 v[104:105], v242 offset:8192
  ds_read_b64_tr_b16 v[108:109], v243 offset:8192
  v_mfma_f32_16x16x32_bf16 a[20:23], v[68:71], a[180:183], 0
  ds_read_b64_tr_b16 v[112:113], v244 offset:8192
  v_mfma_f32_16x16x32_bf16 a[24:27], v[68:71], a[184:187], 0
  ds_read_b64_tr_b16 v[116:117], v245 offset:8192
  ds_read_b64_tr_b16 v[120:121], v246 offset:8192
  v_mfma_f32_16x16x32_bf16 a[28:31], v[68:71], a[188:191], 0
  ds_read_b64_tr_b16 v[124:125], v247 offset:8192
  v_mfma_f32_16x16x32_bf16 a[32:35], v[72:75], a[176:179], 0
  s_add_u32 m0, s52, 4096
  s_xor_b32 s54, s58, 81920
  v_mfma_f32_16x16x32_bf16 a[36:39], v[72:75], a[180:183], 0
  buffer_load_dwordx4 v42, s[24:27], s54 offen offset:0 lds
  v_mfma_f32_16x16x32_bf16 a[40:43], v[72:75], a[184:187], 0
  v_mfma_f32_16x16x32_bf16 a[44:47], v[72:75], a[188:191], 0
  buffer_load_dwordx4 v43, s[24:27], s54 offen offset:1024 lds
  v_mfma_f32_16x16x32_bf16 a[48:51], v[76:79], a[176:179], 0
  v_mfma_f32_16x16x32_bf16 a[52:55], v[76:79], a[180:183], 0
  buffer_load_dwordx4 v44, s[24:27], s54 offen offset:2048 lds
  v_mfma_f32_16x16x32_bf16 a[56:59], v[76:79], a[184:187], 0
  v_mfma_f32_16x16x32_bf16 a[60:63], v[76:79], a[188:191], 0
  buffer_load_dwordx4 v45, s[24:27], s54 offen offset:3072 lds
  s_waitcnt vmcnt(32) lgkmcnt(0)
  v_mfma_f32_16x16x32_bf16 a[64:67], v[80:83], a[176:179], 0
  ds_read_b64_tr_b16 v[98:99], v240 offset:12288
  v_mfma_f32_16x16x32_bf16 a[68:71], v[80:83], a[180:183], 0
  ds_read_b64_tr_b16 v[102:103], v241 offset:12288
  v_mfma_f32_16x16x32_bf16 a[72:75], v[80:83], a[184:187], 0
  ds_read_b64_tr_b16 v[106:107], v242 offset:12288
  v_mfma_f32_16x16x32_bf16 a[76:79], v[80:83], a[188:191], 0
  ds_read_b64_tr_b16 v[110:111], v243 offset:12288
  v_mfma_f32_16x16x32_bf16 a[80:83], v[84:87], a[176:179], 0
  ds_read_b64_tr_b16 v[114:115], v244 offset:12288
  v_mfma_f32_16x16x32_bf16 a[84:87], v[84:87], a[180:183], 0
  ds_read_b64_tr_b16 v[118:119], v245 offset:12288
  v_mfma_f32_16x16x32_bf16 a[88:91], v[84:87], a[184:187], 0
  ds_read_b64_tr_b16 v[122:123], v246 offset:12288
  v_mfma_f32_16x16x32_bf16 a[92:95], v[84:87], a[188:191], 0
  ds_read_b64_tr_b16 v[126:127], v247 offset:12288
  v_mfma_f32_16x16x32_bf16 a[96:99], v[88:91], a[176:179], 0
  s_add_u32 m0, s52, 8192
  s_xor_b32 s54, s58, 98304
  v_mfma_f32_16x16x32_bf16 a[100:103], v[88:91], a[180:183], 0
  buffer_load_dwordx4 v42, s[24:27], s54 offen offset:0 lds
  v_mfma_f32_16x16x32_bf16 a[104:107], v[88:91], a[184:187], 0
  v_mfma_f32_16x16x32_bf16 a[108:111], v[88:91], a[188:191], 0
  buffer_load_dwordx4 v43, s[24:27], s54 offen offset:1024 lds
  v_mfma_f32_16x16x32_bf16 a[112:115], v[92:95], a[176:179], 0
  v_mfma_f32_16x16x32_bf16 a[116:119], v[92:95], a[180:183], 0
  buffer_load_dwordx4 v44, s[24:27], s54 offen offset:2048 lds
  v_mfma_f32_16x16x32_bf16 a[120:123], v[92:95], a[184:187], 0
  v_mfma_f32_16x16x32_bf16 a[124:127], v[92:95], a[188:191], 0
  buffer_load_dwordx4 v45, s[24:27], s54 offen offset:3072 lds
  s_waitcnt vmcnt(8) lgkmcnt(0)
  v_mfma_f32_16x16x32_bf16 a[0:3], v[96:99], a[192:195], a[0:3]
  v_xor_b32 v36, 128, v35
  ds_read_b128 a[176:179], v36 offset:0
  v_mfma_f32_16x16x32_bf16 a[4:7], v[96:99], a[196:199], a[4:7]
  ds_read_b128 a[180:183], v36 offset:16384
  ds_read_b128 a[184:187], v36 offset:32768
  v_mfma_f32_16x16x32_bf16 a[8:11], v[96:99], a[200:203], a[8:11]
  ds_read_b128 a[188:191], v36 offset:49152
  v_mfma_f32_16x16x32_bf16 a[12:15], v[96:99], a[204:207], a[12:15]
  ds_read_b64_tr_b16 v[64:65], v240 offset:0
  ds_read_b64_tr_b16 v[68:69], v241 offset:0
  v_mfma_f32_16x16x32_bf16 a[16:19], v[100:103], a[192:195], a[16:19]
  ds_read_b64_tr_b16 v[72:73], v242 offset:0
  ds_read_b64_tr_b16 v[76:77], v243 offset:0
  v_mfma_f32_16x16x32_bf16 a[20:23], v[100:103], a[196:199], a[20:23]
  ds_read_b64_tr_b16 v[80:81], v244 offset:0
  v_mfma_f32_16x16x32_bf16 a[24:27], v[100:103], a[200:203], a[24:27]
  ds_read_b64_tr_b16 v[84:85], v245 offset:0
  ds_read_b64_tr_b16 v[88:89], v246 offset:0
  v_mfma_f32_16x16x32_bf16 a[28:31], v[100:103], a[204:207], a[28:31]
  ds_read_b64_tr_b16 v[92:93], v247 offset:0
  v_mfma_f32_16x16x32_bf16 a[32:35], v[104:107], a[192:195], a[32:35]
  s_add_u32 m0, s52, 12288
  s_xor_b32 s54, s58, 114688
  v_mfma_f32_16x16x32_bf16 a[36:39], v[104:107], a[196:199], a[36:39]
  buffer_load_dwordx4 v42, s[24:27], s54 offen offset:0 lds
  v_mfma_f32_16x16x32_bf16 a[40:43], v[104:107], a[200:203], a[40:43]
  v_mfma_f32_16x16x32_bf16 a[44:47], v[104:107], a[204:207], a[44:47]
  buffer_load_dwordx4 v43, s[24:27], s54 offen offset:1024 lds
  v_mfma_f32_16x16x32_bf16 a[48:51], v[108:111], a[192:195], a[48:51]
  v_mfma_f32_16x16x32_bf16 a[52:55], v[108:111], a[196:199], a[52:55]
  buffer_load_dwordx4 v44, s[24:27], s54 offen offset:2048 lds
  v_mfma_f32_16x16x32_bf16 a[56:59], v[108:111], a[200:203], a[56:59]
  v_mfma_f32_16x16x32_bf16 a[60:63], v[108:111], a[204:207], a[60:63]
  buffer_load_dwordx4 v45, s[24:27], s54 offen offset:3072 lds
  s_waitcnt vmcnt(8) lgkmcnt(0)
  v_mfma_f32_16x16x32_bf16 a[64:67], v[112:115], a[192:195], a[64:67]
  ds_read_b64_tr_b16 v[66:67], v240 offset:4096
  v_mfma_f32_16x16x32_bf16 a[68:71], v[112:115], a[196:199], a[68:71]
  ds_read_b64_tr_b16 v[70:71], v241 offset:4096
  v_mfma_f32_16x16x32_bf16 a[72:75], v[112:115], a[200:203], a[72:75]
  ds_read_b64_tr_b16 v[74:75], v242 offset:4096
  v_mfma_f32_16x16x32_bf16 a[76:79], v[112:115], a[204:207], a[76:79]
  ds_read_b64_tr_b16 v[78:79], v243 offset:4096
  v_mfma_f32_16x16x32_bf16 a[80:83], v[116:119], a[192:195], a[80:83]
  ds_read_b64_tr_b16 v[82:83], v244 offset:4096
  v_mfma_f32_16x16x32_bf16 a[84:87], v[116:119], a[196:199], a[84:87]
  ds_read_b64_tr_b16 v[86:87], v245 offset:4096
  v_mfma_f32_16x16x32_bf16 a[88:91], v[116:119], a[200:203], a[88:91]
  ds_read_b64_tr_b16 v[90:91], v246 offset:4096
  v_mfma_f32_16x16x32_bf16 a[92:95], v[116:119], a[204:207], a[92:95]
  ds_read_b64_tr_b16 v[94:95], v247 offset:4096
  v_mfma_f32_16x16x32_bf16 a[96:99], v[120:123], a[192:195], a[96:99]
  s_add_u32 m0, s52, 0
  s_xor_b32 s54, s58, 131072
  v_mfma_f32_16x16x32_bf16 a[100:103], v[120:123], a[196:199], a[100:103]
  buffer_load_dwordx4 v42, s[24:27], s54 offen offset:0 lds
  v_mfma_f32_16x16x32_bf16 a[104:107], v[120:123], a[200:203], a[104:107]
  v_mfma_f32_16x16x32_bf16 a[108:111], v[120:123], a[204:207], a[108:111]
  buffer_load_dwordx4 v43, s[24:27], s54 offen offset:1024 lds
  v_mfma_f32_16x16x32_bf16 a[112:115], v[124:127], a[192:195], a[112:115]
  v_mfma_f32_16x16x32_bf16 a[116:119], v[124:127], a[196:199], a[116:119]
  buffer_load_dwordx4 v44, s[24:27], s54 offen offset:2048 lds
  v_mfma_f32_16x16x32_bf16 a[120:123], v[124:127], a[200:203], a[120:123]
  v_mfma_f32_16x16x32_bf16 a[124:127], v[124:127], a[204:207], a[124:127]
  buffer_load_dwordx4 v45, s[24:27], s54 offen offset:3072 lds
  s_waitcnt vmcnt(8) lgkmcnt(0)
  v_mfma_f32_16x16x32_bf16 a[0:3], v[64:67], a[176:179], a[0:3]
  v_xor_b32 v36, 192, v35
  ds_read_b128 a[192:195], v36 offset:0
  v_mfma_f32_16x16x32_bf16 a[4:7], v[64:67], a[180:183], a[4:7]
  ds_read_b128 a[196:199], v36 offset:16384
  ds_read_b128 a[200:203], v36 offset:32768
  v_mfma_f32_16x16x32_bf16 a[8:11], v[64:67], a[184:187], a[8:11]
  ds_read_b128 a[204:207], v36 offset:49152
  v_mfma_f32_16x16x32_bf16 a[12:15], v[64:67], a[188:191], a[12:15]
  ds_read_b64_tr_b16 v[96:97], v240 offset:8192
  ds_read_b64_tr_b16 v[100:101], v241 offset:8192
  v_mfma_f32_16x16x32_bf16 a[16:19], v[68:71], a[176:179], a[16:19]
  ds_read_b64_tr_b16 v[104:105], v242 offset:8192
  ds_read_b64_tr_b16 v[108:109], v243 offset:8192
  v_mfma_f32_16x16x32_bf16 a[20:23], v[68:71], a[180:183], a[20:23]
  ds_read_b64_tr_b16 v[112:113], v244 offset:8192
  v_mfma_f32_16x16x32_bf16 a[24:27], v[68:71], a[184:187], a[24:27]
  ds_read_b64_tr_b16 v[116:117], v245 offset:8192
  ds_read_b64_tr_b16 v[120:121], v246 offset:8192
  v_mfma_f32_16x16x32_bf16 a[28:31], v[68:71], a[188:191], a[28:31]
  ds_read_b64_tr_b16 v[124:125], v247 offset:8192
  v_mfma_f32_16x16x32_bf16 a[32:35], v[72:75], a[176:179], a[32:35]
  s_add_u32 m0, s52, 4096
  s_xor_b32 s54, s58, 147456
  v_mfma_f32_16x16x32_bf16 a[36:39], v[72:75], a[180:183], a[36:39]
  buffer_load_dwordx4 v42, s[24:27], s54 offen offset:0 lds
  v_mfma_f32_16x16x32_bf16 a[40:43], v[72:75], a[184:187], a[40:43]
  v_mfma_f32_16x16x32_bf16 a[44:47], v[72:75], a[188:191], a[44:47]
  buffer_load_dwordx4 v43, s[24:27], s54 offen offset:1024 lds
  v_mfma_f32_16x16x32_bf16 a[48:51], v[76:79], a[176:179], a[48:51]
  v_mfma_f32_16x16x32_bf16 a[52:55], v[76:79], a[180:183], a[52:55]
  buffer_load_dwordx4 v44, s[24:27], s54 offen offset:2048 lds
  v_mfma_f32_16x16x32_bf16 a[56:59], v[76:79], a[184:187], a[56:59]
  v_mfma_f32_16x16x32_bf16 a[60:63], v[76:79], a[188:191], a[60:63]
  buffer_load_dwordx4 v45, s[24:27], s54 offen offset:3072 lds
  s_waitcnt vmcnt(8) lgkmcnt(0)
  v_mfma_f32_16x16x32_bf16 a[64:67], v[80:83], a[176:179], a[64:67]
  ds_read_b64_tr_b16 v[98:99], v240 offset:12288
  v_mfma_f32_16x16x32_bf16 a[68:71], v[80:83], a[180:183], a[68:71]
  ds_read_b64_tr_b16 v[102:103], v241 offset:12288
  v_mfma_f32_16x16x32_bf16 a[72:75], v[80:83], a[184:187], a[72:75]
  ds_read_b64_tr_b16 v[106:107], v242 offset:12288
  v_mfma_f32_16x16x32_bf16 a[76:79], v[80:83], a[188:191], a[76:79]
  ds_read_b64_tr_b16 v[110:111], v243 offset:12288
  v_mfma_f32_16x16x32_bf16 a[80:83], v[84:87], a[176:179], a[80:83]
  ds_read_b64_tr_b16 v[114:115], v244 offset:12288
  v_mfma_f32_16x16x32_bf16 a[84:87], v[84:87], a[180:183], a[84:87]
  ds_read_b64_tr_b16 v[118:119], v245 offset:12288
  v_mfma_f32_16x16x32_bf16 a[88:91], v[84:87], a[184:187], a[88:91]
  ds_read_b64_tr_b16 v[122:123], v246 offset:12288
  v_mfma_f32_16x16x32_bf16 a[92:95], v[84:87], a[188:191], a[92:95]
  ds_read_b64_tr_b16 v[126:127], v247 offset:12288
  v_mfma_f32_16x16x32_bf16 a[96:99], v[88:91], a[176:179], a[96:99]
  s_add_u32 m0, s52, 8192
  s_xor_b32 s54, s58, 163840
  v_mfma_f32_16x16x32_bf16 a[100:103], v[88:91], a[180:183], a[100:103]
  buffer_load_dwordx4 v42, s[24:27], s54 offen offset:0 lds
  v_mfma_f32_16x16x32_bf16 a[104:107], v[88:91], a[184:187], a[104:107]
  v_mfma_f32_16x16x32_bf16 a[108:111], v[88:91], a[188:191], a[108:111]
  buffer_load_dwordx4 v43, s[24:27], s54 offen offset:1024 lds
  v_mfma_f32_16x16x32_bf16 a[112:115], v[92:95], a[176:179], a[112:115]
  v_mfma_f32_16x16x32_bf16 a[116:119], v[92:95], a[180:183], a[116:119]
  buffer_load_dwordx4 v44, s[24:27], s54 offen offset:2048 lds
  v_mfma_f32_16x16x32_bf16 a[120:123], v[92:95], a[184:187], a[120:123]
  v_mfma_f32_16x16x32_bf16 a[124:127], v[92:95], a[188:191], a[124:127]
  buffer_load_dwordx4 v45, s[24:27], s54 offen offset:3072 lds
  s_waitcnt vmcnt(8) lgkmcnt(0)
  v_mfma_f32_16x16x32_bf16 a[0:3], v[96:99], a[192:195], a[0:3]
  v_xor_b32 v36, 256, v35
  ds_read_b128 a[176:179], v36 offset:0
  v_mfma_f32_16x16x32_bf16 a[4:7], v[96:99], a[196:199], a[4:7]
  ds_read_b128 a[180:183], v36 offset:16384
  ds_read_b128 a[184:187], v36 offset:32768
  v_mfma_f32_16x16x32_bf16 a[8:11], v[96:99], a[200:203], a[8:11]
  ds_read_b128 a[188:191], v36 offset:49152
  v_mfma_f32_16x16x32_bf16 a[12:15], v[96:99], a[204:207], a[12:15]
  ds_read_b64_tr_b16 v[64:65], v240 offset:0
  ds_read_b64_tr_b16 v[68:69], v241 offset:0
  v_mfma_f32_16x16x32_bf16 a[16:19], v[100:103], a[192:195], a[16:19]
  ds_read_b64_tr_b16 v[72:73], v242 offset:0
  ds_read_b64_tr_b16 v[76:77], v243 offset:0
  v_mfma_f32_16x16x32_bf16 a[20:23], v[100:103], a[196:199], a[20:23]
  ds_read_b64_tr_b16 v[80:81], v244 offset:0
  v_mfma_f32_16x16x32_bf16 a[24:27], v[100:103], a[200:203], a[24:27]
  ds_read_b64_tr_b16 v[84:85], v245 offset:0
  ds_read_b64_tr_b16 v[88:89], v246 offset:0
  v_mfma_f32_16x16x32_bf16 a[28:31], v[100:103], a[204:207], a[28:31]
  ds_read_b64_tr_b16 v[92:93], v247 offset:0
  v_mfma_f32_16x16x32_bf16 a[32:35], v[104:107], a[192:195], a[32:35]
  s_add_u32 m0, s52, 12288
  s_xor_b32 s54, s58, 180224
  v_mfma_f32_16x16x32_bf16 a[36:39], v[104:107], a[196:199], a[36:39]
  buffer_load_dwordx4 v42, s[24:27], s54 offen offset:0 lds
  v_mfma_f32_16x16x32_bf16 a[40:43], v[104:107], a[200:203], a[40:43]
  v_mfma_f32_16x16x32_bf16 a[44:47], v[104:107], a[204:207], a[44:47]
  buffer_load_dwordx4 v43, s[24:27], s54 offen offset:1024 lds
  v_mfma_f32_16x16x32_bf16 a[48:51], v[108:111], a[192:195], a[48:51]
  v_mfma_f32_16x16x32_bf16 a[52:55], v[108:111], a[196:199], a[52:55]
  buffer_load_dwordx4 v44, s[24:27], s54 offen offset:2048 lds
  v_mfma_f32_16x16x32_bf16 a[56:59], v[108:111], a[200:203], a[56:59]
  v_mfma_f32_16x16x32_bf16 a[60:63], v[108:111], a[204:207], a[60:63]
  buffer_load_dwordx4 v45, s[24:27], s54 offen offset:3072 lds
  s_waitcnt vmcnt(8) lgkmcnt(0)
  v_mfma_f32_16x16x32_bf16 a[64:67], v[112:115], a[192:195], a[64:67]
  ds_read_b64_tr_b16 v[66:67], v240 offset:4096
  v_mfma_f32_16x16x32_bf16 a[68:71], v[112:115], a[196:199], a[68:71]
  ds_read_b64_tr_b16 v[70:71], v241 offset:4096
  v_mfma_f32_16x16x32_bf16 a[72:75], v[112:115], a[200:203], a[72:75]
  ds_read_b64_tr_b16 v[74:75], v242 offset:4096
  v_mfma_f32_16x16x32_bf16 a[76:79], v[112:115], a[204:207], a[76:79]
  ds_read_b64_tr_b16 v[78:79], v243 offset:4096
  v_mfma_f32_16x16x32_bf16 a[80:83], v[116:119], a[192:195], a[80:83]
  ds_read_b64_tr_b16 v[82:83], v244 offset:4096
  v_mfma_f32_16x16x32_bf16 a[84:87], v[116:119], a[196:199], a[84:87]
  ds_read_b64_tr_b16 v[86:87], v245 offset:4096
  v_mfma_f32_16x16x32_bf16 a[88:91], v[116:119], a[200:203], a[88:91]
  ds_read_b64_tr_b16 v[90:91], v246 offset:4096
  v_mfma_f32_16x16x32_bf16 a[92:95], v[116:119], a[204:207], a[92:95]
  ds_read_b64_tr_b16 v[94:95], v247 offset:4096
  v_mfma_f32_16x16x32_bf16 a[96:99], v[120:123], a[192:195], a[96:99]
  s_add_u32 m0, s52, 0
  s_xor_b32 s54, s58, 196608
  v_mfma_f32_16x16x32_bf16 a[100:103], v[120:123], a[196:199], a[100:103]
  buffer_load_dwordx4 v42, s[24:27], s54 offen offset:0 lds
  v_mfma_f32_16x16x32_bf16 a[104:107], v[120:123], a[200:203], a[104:107]
  v_mfma_f32_16x16x32_bf16 a[108:111], v[120:123], a[204:207], a[108:111]
  buffer_load_dwordx4 v43, s[24:27], s54 offen offset:1024 lds
  v_mfma_f32_16x16x32_bf16 a[112:115], v[124:127], a[192:195], a[112:115]
  v_mfma_f32_16x16x32_bf16 a[116:119], v[124:127], a[196:199], a[116:119]
  buffer_load_dwordx4 v44, s[24:27], s54 offen offset:2048 lds
  v_mfma_f32_16x16x32_bf16 a[120:123], v[124:127], a[200:203], a[120:123]
  v_mfma_f32_16x16x32_bf16 a[124:127], v[124:127], a[204:207], a[124:127]
  buffer_load_dwordx4 v45, s[24:27], s54 offen offset:3072 lds
  s_waitcnt vmcnt(8) lgkmcnt(0)
  v_mfma_f32_16x16x32_bf16 a[0:3], v[64:67], a[176:179], a[0:3]
  v_xor_b32 v36, 320, v35
  ds_read_b128 a[192:195], v36 offset:0
  v_mfma_f32_16x16x32_bf16 a[4:7], v[64:67], a[180:183], a[4:7]
  ds_read_b128 a[196:199], v36 offset:16384
  ds_read_b128 a[200:203], v36 offset:32768
  v_mfma_f32_16x16x32_bf16 a[8:11], v[64:67], a[184:187], a[8:11]
  ds_read_b128 a[204:207], v36 offset:49152
  v_mfma_f32_16x16x32_bf16 a[12:15], v[64:67], a[188:191], a[12:15]
  ds_read_b64_tr_b16 v[96:97], v240 offset:8192
  ds_read_b64_tr_b16 v[100:101], v241 offset:8192
  v_mfma_f32_16x16x32_bf16 a[16:19], v[68:71], a[176:179], a[16:19]
  ds_read_b64_tr_b16 v[104:105], v242 offset:8192
  ds_read_b64_tr_b16 v[108:109], v243 offset:8192
  v_mfma_f32_16x16x32_bf16 a[20:23], v[68:71], a[180:183], a[20:23]
  ds_read_b64_tr_b16 v[112:113], v244 offset:8192
  v_mfma_f32_16x16x32_bf16 a[24:27], v[68:71], a[184:187], a[24:27]
  ds_read_b64_tr_b16 v[116:117], v245 offset:8192
  ds_read_b64_tr_b16 v[120:121], v246 offset:8192
  v_mfma_f32_16x16x32_bf16 a[28:31], v[68:71], a[188:191], a[28:31]
  ds_read_b64_tr_b16 v[124:125], v247 offset:8192
  v_mfma_f32_16x16x32_bf16 a[32:35], v[72:75], a[176:179], a[32:35]
  s_add_u32 m0, s52, 4096
  s_xor_b32 s54, s58, 212992
  v_mfma_f32_16x16x32_bf16 a[36:39], v[72:75], a[180:183], a[36:39]
  buffer_load_dwordx4 v42, s[24:27], s54 offen offset:0 lds
  v_mfma_f32_16x16x32_bf16 a[40:43], v[72:75], a[184:187], a[40:43]
  v_mfma_f32_16x16x32_bf16 a[44:47], v[72:75], a[188:191], a[44:47]
  buffer_load_dwordx4 v43, s[24:27], s54 offen offset:1024 lds
  v_mfma_f32_16x16x32_bf16 a[48:51], v[76:79], a[176:179], a[48:51]
  v_mfma_f32_16x16x32_bf16 a[52:55], v[76:79], a[180:183], a[52:55]
  buffer_load_dwordx4 v44, s[24:27], s54 offen offset:2048 lds
  v_mfma_f32_16x16x32_bf16 a[56:59], v[76:79], a[184:187], a[56:59]
  v_mfma_f32_16x16x32_bf16 a[60:63], v[76:79], a[188:191], a[60:63]
  buffer_load_dwordx4 v45, s[24:27], s54 offen offset:3072 lds
  s_waitcnt vmcnt(8) lgkmcnt(0)
  v_mfma_f32_16x16x32_bf16 a[64:67], v[80:83], a[176:179], a[64:67]
  ds_read_b64_tr_b16 v[98:99], v240 offset:12288
  v_mfma_f32_16x16x32_bf16 a[68:71], v[80:83], a[180:183], a[68:71]
  ds_read_b64_tr_b16 v[102:103], v241 offset:12288
  v_mfma_f32_16x16x32_bf16 a[72:75], v[80:83], a[184:187], a[72:75]
  ds_read_b64_tr_b16 v[106:107], v242 offset:12288
  v_mfma_f32_16x16x32_bf16 a[76:79], v[80:83], a[188:191], a[76:79]
  ds_read_b64_tr_b16 v[110:111], v243 offset:12288
  v_mfma_f32_16x16x32_bf16 a[80:83], v[84:87], a[176:179], a[80:83]
  ds_read_b64_tr_b16 v[114:115], v244 offset:12288
  v_mfma_f32_16x16x32_bf16 a[84:87], v[84:87], a[180:183], a[84:87]
  ds_read_b64_tr_b16 v[118:119], v245 offset:12288
  v_mfma_f32_16x16x32_bf16 a[88:91], v[84:87], a[184:187], a[88:91]
  ds_read_b64_tr_b16 v[122:123], v246 offset:12288
  v_mfma_f32_16x16x32_bf16 a[92:95], v[84:87], a[188:191], a[92:95]
  ds_read_b64_tr_b16 v[126:127], v247 offset:12288
  v_mfma_f32_16x16x32_bf16 a[96:99], v[88:91], a[176:179], a[96:99]
  s_add_u32 m0, s52, 8192
  s_xor_b32 s54, s58, 229376
  v_mfma_f32_16x16x32_bf16 a[100:103], v[88:91], a[180:183], a[100:103]
  buffer_load_dwordx4 v42, s[24:27], s54 offen offset:0 lds
  v_mfma_f32_16x16x32_bf16 a[104:107], v[88:91], a[184:187], a[104:107]
  v_mfma_f32_16x16x32_bf16 a[108:111], v[88:91], a[188:191], a[108:111]
  buffer_load_dwordx4 v43, s[24:27], s54 offen offset:1024 lds
  v_mfma_f32_16x16x32_bf16 a[112:115], v[92:95], a[176:179], a[112:115]
  v_mfma_f32_16x16x32_bf16 a[116:119], v[92:95], a[180:183], a[116:119]
  buffer_load_dwordx4 v44, s[24:27], s54 offen offset:2048 lds
  v_mfma_f32_16x16x32_bf16 a[120:123], v[92:95], a[184:187], a[120:123]
  v_mfma_f32_16x16x32_bf16 a[124:127], v[92:95], a[188:191], a[124:127]
  buffer_load_dwordx4 v45, s[24:27], s54 offen offset:3072 lds
  s_waitcnt vmcnt(8) lgkmcnt(0)
  v_mfma_f32_16x16x32_bf16 a[0:3], v[96:99], a[192:195], a[0:3]
  v_xor_b32 v36, 384, v35
  ds_read_b128 a[176:179], v36 offset:0
  v_mfma_f32_16x16x32_bf16 a[4:7], v[96:99], a[196:199], a[4:7]
  ds_read_b128 a[180:183], v36 offset:16384
  ds_read_b128 a[184:187], v36 offset:32768
  v_mfma_f32_16x16x32_bf16 a[8:11], v[96:99], a[200:203], a[8:11]
  ds_read_b128 a[188:191], v36 offset:49152
  v_mfma_f32_16x16x32_bf16 a[12:15], v[96:99], a[204:207], a[12:15]
  ds_read_b64_tr_b16 v[64:65], v240 offset:0
  ds_read_b64_tr_b16 v[68:69], v241 offset:0
  v_mfma_f32_16x16x32_bf16 a[16:19], v[100:103], a[192:195], a[16:19]
  ds_read_b64_tr_b16 v[72:73], v242 offset:0
  ds_read_b64_tr_b16 v[76:77], v243 offset:0
  v_mfma_f32_16x16x32_bf16 a[20:23], v[100:103], a[196:199], a[20:23]
  ds_read_b64_tr_b16 v[80:81], v244 offset:0
  v_mfma_f32_16x16x32_bf16 a[24:27], v[100:103], a[200:203], a[24:27]
  ds_read_b64_tr_b16 v[84:85], v245 offset:0
  ds_read_b64_tr_b16 v[88:89], v246 offset:0
  v_mfma_f32_16x16x32_bf16 a[28:31], v[100:103], a[204:207], a[28:31]
  ds_read_b64_tr_b16 v[92:93], v247 offset:0
  v_mfma_f32_16x16x32_bf16 a[32:35], v[104:107], a[192:195], a[32:35]
  s_add_u32 m0, s52, 12288
  s_xor_b32 s54, s58, 245760
  v_mfma_f32_16x16x32_bf16 a[36:39], v[104:107], a[196:199], a[36:39]
  buffer_load_dwordx4 v42, s[24:27], s54 offen offset:0 lds
  v_mfma_f32_16x16x32_bf16 a[40:43], v[104:107], a[200:203], a[40:43]
  v_mfma_f32_16x16x32_bf16 a[44:47], v[104:107], a[204:207], a[44:47]
  buffer_load_dwordx4 v43, s[24:27], s54 offen offset:1024 lds
  v_mfma_f32_16x16x32_bf16 a[48:51], v[108:111], a[192:195], a[48:51]
  v_mfma_f32_16x16x32_bf16 a[52:55], v[108:111], a[196:199], a[52:55]
  buffer_load_dwordx4 v44, s[24:27], s54 offen offset:2048 lds
  v_mfma_f32_16x16x32_bf16 a[56:59], v[108:111], a[200:203], a[56:59]
  v_mfma_f32_16x16x32_bf16 a[60:63], v[108:111], a[204:207], a[60:63]
  buffer_load_dwordx4 v45, s[24:27], s54 offen offset:3072 lds
  s_waitcnt vmcnt(8) lgkmcnt(0)
  v_mfma_f32_16x16x32_bf16 a[64:67], v[112:115], a[192:195], a[64:67]
  ds_read_b64_tr_b16 v[66:67], v240 offset:4096
  v_mfma_f32_16x16x32_bf16 a[68:71], v[112:115], a[196:199], a[68:71]
  ds_read_b64_tr_b16 v[70:71], v241 offset:4096
  v_mfma_f32_16x16x32_bf16 a[72:75], v[112:115], a[200:203], a[72:75]
  ds_read_b64_tr_b16 v[74:75], v242 offset:4096
  v_mfma_f32_16x16x32_bf16 a[76:79], v[112:115], a[204:207], a[76:79]
  ds_read_b64_tr_b16 v[78:79], v243 offset:4096
  v_mfma_f32_16x16x32_bf16 a[80:83], v[116:119], a[192:195], a[80:83]
  ds_read_b64_tr_b16 v[82:83], v244 offset:4096
  v_mfma_f32_16x16x32_bf16 a[84:87], v[116:119], a[196:199], a[84:87]
  ds_read_b64_tr_b16 v[86:87], v245 offset:4096
  v_mfma_f32_16x16x32_bf16 a[88:91], v[116:119], a[200:203], a[88:91]
  ds_read_b64_tr_b16 v[90:91], v246 offset:4096
  v_mfma_f32_16x16x32_bf16 a[92:95], v[116:119], a[204:207], a[92:95]
  ds_read_b64_tr_b16 v[94:95], v247 offset:4096
  v_mfma_f32_16x16x32_bf16 a[96:99], v[120:123], a[192:195], a[96:99]
  s_add_u32 m0, s52, 0
  s_xor_b32 s54, s58, 262144
  v_mfma_f32_16x16x32_bf16 a[100:103], v[120:123], a[196:199], a[100:103]
  buffer_load_dwordx4 v42, s[24:27], s54 offen offset:0 lds
  v_mfma_f32_16x16x32_bf16 a[104:107], v[120:123], a[200:203], a[104:107]
  v_mfma_f32_16x16x32_bf16 a[108:111], v[120:123], a[204:207], a[108:111]
  buffer_load_dwordx4 v43, s[24:27], s54 offen offset:1024 lds
  v_mfma_f32_16x16x32_bf16 a[112:115], v[124:127], a[192:195], a[112:115]
  v_mfma_f32_16x16x32_bf16 a[116:119], v[124:127], a[196:199], a[116:119]
  buffer_load_dwordx4 v44, s[24:27], s54 offen offset:2048 lds
  v_mfma_f32_16x16x32_bf16 a[120:123], v[124:127], a[200:203], a[120:123]
  v_mfma_f32_16x16x32_bf16 a[124:127], v[124:127], a[204:207], a[124:127]
  buffer_load_dwordx4 v45, s[24:27], s54 offen offset:3072 lds
  s_waitcnt vmcnt(8) lgkmcnt(0)
  v_mfma_f32_16x16x32_bf16 a[0:3], v[64:67], a[176:179], a[0:3]
  v_xor_b32 v36, 448, v35
  ds_read_b128 a[192:195], v36 offset:0
  v_mfma_f32_16x16x32_bf16 a[4:7], v[64:67], a[180:183], a[4:7]
  ds_read_b128 a[196:199], v36 offset:16384
  ds_read_b128 a[200:203], v36 offset:32768
  v_mfma_f32_16x16x32_bf16 a[8:11], v[64:67], a[184:187], a[8:11]
  ds_read_b128 a[204:207], v36 offset:49152
  v_mfma_f32_16x16x32_bf16 a[12:15], v[64:67], a[188:191], a[12:15]
  ds_read_b64_tr_b16 v[96:97], v240 offset:8192
  ds_read_b64_tr_b16 v[100:101], v241 offset:8192
  v_mfma_f32_16x16x32_bf16 a[16:19], v[68:71], a[176:179], a[16:19]
  ds_read_b64_tr_b16 v[104:105], v242 offset:8192
  ds_read_b64_tr_b16 v[108:109], v243 offset:8192
  v_mfma_f32_16x16x32_bf16 a[20:23], v[68:71], a[180:183], a[20:23]
  ds_read_b64_tr_b16 v[112:113], v244 offset:8192
  v_mfma_f32_16x16x32_bf16 a[24:27], v[68:71], a[184:187], a[24:27]
  ds_read_b64_tr_b16 v[116:117], v245 offset:8192
  ds_read_b64_tr_b16 v[120:121], v246 offset:8192
  v_mfma_f32_16x16x32_bf16 a[28:31], v[68:71], a[188:191], a[28:31]
  ds_read_b64_tr_b16 v[124:125], v247 offset:8192
  v_mfma_f32_16x16x32_bf16 a[32:35], v[72:75], a[176:179], a[32:35]
  s_add_u32 m0, s52, 4096
  s_xor_b32 s54, s58, 278528
  v_mfma_f32_16x16x32_bf16 a[36:39], v[72:75], a[180:183], a[36:39]
  buffer_load_dwordx4 v42, s[24:27], s54 offen offset:0 lds
  v_mfma_f32_16x16x32_bf16 a[40:43], v[72:75], a[184:187], a[40:43]
  v_mfma_f32_16x16x32_bf16 a[44:47], v[72:75], a[188:191], a[44:47]
  buffer_load_dwordx4 v43, s[24:27], s54 offen offset:1024 lds
  v_mfma_f32_16x16x32_bf16 a[48:51], v[76:79], a[176:179], a[48:51]
  v_mfma_f32_16x16x32_bf16 a[52:55], v[76:79], a[180:183], a[52:55]
  buffer_load_dwordx4 v44, s[24:27], s54 offen offset:2048 lds
  v_mfma_f32_16x16x32_bf16 a[56:59], v[76:79], a[184:187], a[56:59]
  v_mfma_f32_16x16x32_bf16 a[60:63], v[76:79], a[188:191], a[60:63]
  buffer_load_dwordx4 v45, s[24:27], s54 offen offset:3072 lds
  s_waitcnt vmcnt(8) lgkmcnt(0)
  v_mfma_f32_16x16x32_bf16 a[64:67], v[80:83], a[176:179], a[64:67]
  ds_read_b64_tr_b16 v[98:99], v240 offset:12288
  v_mfma_f32_16x16x32_bf16 a[68:71], v[80:83], a[180:183], a[68:71]
  ds_read_b64_tr_b16 v[102:103], v241 offset:12288
  v_mfma_f32_16x16x32_bf16 a[72:75], v[80:83], a[184:187], a[72:75]
  ds_read_b64_tr_b16 v[106:107], v242 offset:12288
  v_mfma_f32_16x16x32_bf16 a[76:79], v[80:83], a[188:191], a[76:79]
  ds_read_b64_tr_b16 v[110:111], v243 offset:12288
  v_mfma_f32_16x16x32_bf16 a[80:83], v[84:87], a[176:179], a[80:83]
  ds_read_b64_tr_b16 v[114:115], v244 offset:12288
  v_mfma_f32_16x16x32_bf16 a[84:87], v[84:87], a[180:183], a[84:87]
  ds_read_b64_tr_b16 v[118:119], v245 offset:12288
  v_mfma_f32_16x16x32_bf16 a[88:91], v[84:87], a[184:187], a[88:91]
  ds_read_b64_tr_b16 v[122:123], v246 offset:12288
  v_mfma_f32_16x16x32_bf16 a[92:95], v[84:87], a[188:191], a[92:95]
  ds_read_b64_tr_b16 v[126:127], v247 offset:12288
  v_mfma_f32_16x16x32_bf16 a[96:99], v[88:91], a[176:179], a[96:99]
  s_add_u32 m0, s52, 8192
  s_xor_b32 s54, s58, 294912
  v_mfma_f32_16x16x32_bf16 a[100:103], v[88:91], a[180:183], a[100:103]
  buffer_load_dwordx4 v42, s[24:27], s54 offen offset:0 lds
  v_mfma_f32_16x16x32_bf16 a[104:107], v[88:91], a[184:187], a[104:107]
  v_mfma_f32_16x16x32_bf16 a[108:111], v[88:91], a[188:191], a[108:111]
  buffer_load_dwordx4 v43, s[24:27], s54 offen offset:1024 lds
  v_mfma_f32_16x16x32_bf16 a[112:115], v[92:95], a[176:179], a[112:115]
  v_mfma_f32_16x16x32_bf16 a[116:119], v[92:95], a[180:183], a[116:119]
  buffer_load_dwordx4 v44, s[24:27], s54 offen offset:2048 lds
  v_mfma_f32_16x16x32_bf16 a[120:123], v[92:95], a[184:187], a[120:123]
  v_mfma_f32_16x16x32_bf16 a[124:127], v[92:95], a[188:191], a[124:127]
  buffer_load_dwordx4 v45, s[24:27], s54 offen offset:3072 lds
  s_waitcnt vmcnt(8) lgkmcnt(0)
  v_mfma_f32_16x16x32_bf16 a[0:3], v[96:99], a[192:195], a[0:3]
  v_xor_b32 v36, 512, v35
  ds_read_b128 a[176:179], v36 offset:0
  v_mfma_f32_16x16x32_bf16 a[4:7], v[96:99], a[196:199], a[4:7]
  ds_read_b128 a[180:183], v36 offset:16384
  ds_read_b128 a[184:187], v36 offset:32768
  v_mfma_f32_16x16x32_bf16 a[8:11], v[96:99], a[200:203], a[8:11]
  ds_read_b128 a[188:191], v36 offset:49152
  v_mfma_f32_16x16x32_bf16 a[12:15], v[96:99], a[204:207], a[12:15]
  ds_read_b64_tr_b16 v[64:65], v240 offset:0
  ds_read_b64_tr_b16 v[68:69], v241 offset:0
  v_mfma_f32_16x16x32_bf16 a[16:19], v[100:103], a[192:195], a[16:19]
  ds_read_b64_tr_b16 v[72:73], v242 offset:0
  ds_read_b64_tr_b16 v[76:77], v243 offset:0
  v_mfma_f32_16x16x32_bf16 a[20:23], v[100:103], a[196:199], a[20:23]
  ds_read_b64_tr_b16 v[80:81], v244 offset:0
  v_mfma_f32_16x16x32_bf16 a[24:27], v[100:103], a[200:203], a[24:27]
  ds_read_b64_tr_b16 v[84:85], v245 offset:0
  ds_read_b64_tr_b16 v[88:89], v246 offset:0
  v_mfma_f32_16x16x32_bf16 a[28:31], v[100:103], a[204:207], a[28:31]
  ds_read_b64_tr_b16 v[92:93], v247 offset:0
  v_mfma_f32_16x16x32_bf16 a[32:35], v[104:107], a[192:195], a[32:35]
  s_add_u32 m0, s52, 12288
  s_xor_b32 s54, s58, 311296
  v_mfma_f32_16x16x32_bf16 a[36:39], v[104:107], a[196:199], a[36:39]
  buffer_load_dwordx4 v42, s[24:27], s54 offen offset:0 lds
  v_mfma_f32_16x16x32_bf16 a[40:43], v[104:107], a[200:203], a[40:43]
  v_mfma_f32_16x16x32_bf16 a[44:47], v[104:107], a[204:207], a[44:47]
  buffer_load_dwordx4 v43, s[24:27], s54 offen offset:1024 lds
  v_mfma_f32_16x16x32_bf16 a[48:51], v[108:111], a[192:195], a[48:51]
  v_mfma_f32_16x16x32_bf16 a[52:55], v[108:111], a[196:199], a[52:55]
  buffer_load_dwordx4 v44, s[24:27], s54 offen offset:2048 lds
  v_mfma_f32_16x16x32_bf16 a[56:59], v[108:111], a[200:203], a[56:59]
  v_mfma_f32_16x16x32_bf16 a[60:63], v[108:111], a[204:207], a[60:63]
  buffer_load_dwordx4 v45, s[24:27], s54 offen offset:3072 lds
  s_waitcnt vmcnt(8) lgkmcnt(0)
  v_mfma_f32_16x16x32_bf16 a[64:67], v[112:115], a[192:195], a[64:67]
  ds_read_b64_tr_b16 v[66:67], v240 offset:4096
  v_mfma_f32_16x16x32_bf16 a[68:71], v[112:115], a[196:199], a[68:71]
  ds_read_b64_tr_b16 v[70:71], v241 offset:4096
  v_mfma_f32_16x16x32_bf16 a[72:75], v[112:115], a[200:203], a[72:75]
  ds_read_b64_tr_b16 v[74:75], v242 offset:4096
  v_mfma_f32_16x16x32_bf16 a[76:79], v[112:115], a[204:207], a[76:79]
  ds_read_b64_tr_b16 v[78:79], v243 offset:4096
  v_mfma_f32_16x16x32_bf16 a[80:83], v[116:119], a[192:195], a[80:83]
  ds_read_b64_tr_b16 v[82:83], v244 offset:4096
  v_mfma_f32_16x16x32_bf16 a[84:87], v[116:119], a[196:199], a[84:87]
  ds_read_b64_tr_b16 v[86:87], v245 offset:4096
  v_mfma_f32_16x16x32_bf16 a[88:91], v[116:119], a[200:203], a[88:91]
  ds_read_b64_tr_b16 v[90:91], v246 offset:4096
  v_mfma_f32_16x16x32_bf16 a[92:95], v[116:119], a[204:207], a[92:95]
  ds_read_b64_tr_b16 v[94:95], v247 offset:4096
  v_mfma_f32_16x16x32_bf16 a[96:99], v[120:123], a[192:195], a[96:99]
  s_add_u32 m0, s52, 0
  s_xor_b32 s54, s58, 327680
  v_mfma_f32_16x16x32_bf16 a[100:103], v[120:123], a[196:199], a[100:103]
  buffer_load_dwordx4 v42, s[24:27], s54 offen offset:0 lds
  v_mfma_f32_16x16x32_bf16 a[104:107], v[120:123], a[200:203], a[104:107]
  v_mfma_f32_16x16x32_bf16 a[108:111], v[120:123], a[204:207], a[108:111]
  buffer_load_dwordx4 v43, s[24:27], s54 offen offset:1024 lds
  v_mfma_f32_16x16x32_bf16 a[112:115], v[124:127], a[192:195], a[112:115]
  v_mfma_f32_16x16x32_bf16 a[116:119], v[124:127], a[196:199], a[116:119]
  buffer_load_dwordx4 v44, s[24:27], s54 offen offset:2048 lds
  v_mfma_f32_16x16x32_bf16 a[120:123], v[124:127], a[200:203], a[120:123]
  v_mfma_f32_16x16x32_bf16 a[124:127], v[124:127], a[204:207], a[124:127]
  buffer_load_dwordx4 v45, s[24:27], s54 offen offset:3072 lds
  s_waitcnt vmcnt(8) lgkmcnt(0)
  v_mfma_f32_16x16x32_bf16 a[0:3], v[64:67], a[176:179], a[0:3]
  v_xor_b32 v36, 576, v35
  ds_read_b128 a[192:195], v36 offset:0
  v_mfma_f32_16x16x32_bf16 a[4:7], v[64:67], a[180:183], a[4:7]
  ds_read_b128 a[196:199], v36 offset:16384
  ds_read_b128 a[200:203], v36 offset:32768
  v_mfma_f32_16x16x32_bf16 a[8:11], v[64:67], a[184:187], a[8:11]
  ds_read_b128 a[204:207], v36 offset:49152
  v_mfma_f32_16x16x32_bf16 a[12:15], v[64:67], a[188:191], a[12:15]
  ds_read_b64_tr_b16 v[96:97], v240 offset:8192
  ds_read_b64_tr_b16 v[100:101], v241 offset:8192
  v_mfma_f32_16x16x32_bf16 a[16:19], v[68:71], a[176:179], a[16:19]
  ds_read_b64_tr_b16 v[104:105], v242 offset:8192
  ds_read_b64_tr_b16 v[108:109], v243 offset:8192
  v_mfma_f32_16x16x32_bf16 a[20:23], v[68:71], a[180:183], a[20:23]
  ds_read_b64_tr_b16 v[112:113], v244 offset:8192
  v_mfma_f32_16x16x32_bf16 a[24:27], v[68:71], a[184:187], a[24:27]
  ds_read_b64_tr_b16 v[116:117], v245 offset:8192
  ds_read_b64_tr_b16 v[120:121], v246 offset:8192
  v_mfma_f32_16x16x32_bf16 a[28:31], v[68:71], a[188:191], a[28:31]
  ds_read_b64_tr_b16 v[124:125], v247 offset:8192
  v_mfma_f32_16x16x32_bf16 a[32:35], v[72:75], a[176:179], a[32:35]
  s_add_u32 m0, s52, 4096
  s_xor_b32 s54, s58, 344064
  v_mfma_f32_16x16x32_bf16 a[36:39], v[72:75], a[180:183], a[36:39]
  buffer_load_dwordx4 v42, s[24:27], s54 offen offset:0 lds
  v_mfma_f32_16x16x32_bf16 a[40:43], v[72:75], a[184:187], a[40:43]
  v_mfma_f32_16x16x32_bf16 a[44:47], v[72:75], a[188:191], a[44:47]
  buffer_load_dwordx4 v43, s[24:27], s54 offen offset:1024 lds
  v_mfma_f32_16x16x32_bf16 a[48:51], v[76:79], a[176:179], a[48:51]
  v_mfma_f32_16x16x32_bf16 a[52:55], v[76:79], a[180:183], a[52:55]
  buffer_load_dwordx4 v44, s[24:27], s54 offen offset:2048 lds
  v_mfma_f32_16x16x32_bf16 a[56:59], v[76:79], a[184:187], a[56:59]
  v_mfma_f32_16x16x32_bf16 a[60:63], v[76:79], a[188:191], a[60:63]
  buffer_load_dwordx4 v45, s[24:27], s54 offen offset:3072 lds
  s_waitcnt vmcnt(8) lgkmcnt(0)
  v_mfma_f32_16x16x32_bf16 a[64:67], v[80:83], a[176:179], a[64:67]
  ds_read_b64_tr_b16 v[98:99], v240 offset:12288
  v_mfma_f32_16x16x32_bf16 a[68:71], v[80:83], a[180:183], a[68:71]
  ds_read_b64_tr_b16 v[102:103], v241 offset:12288
  v_mfma_f32_16x16x32_bf16 a[72:75], v[80:83], a[184:187], a[72:75]
  ds_read_b64_tr_b16 v[106:107], v242 offset:12288
  v_mfma_f32_16x16x32_bf16 a[76:79], v[80:83], a[188:191], a[76:79]
  ds_read_b64_tr_b16 v[110:111], v243 offset:12288
  v_mfma_f32_16x16x32_bf16 a[80:83], v[84:87], a[176:179], a[80:83]
  ds_read_b64_tr_b16 v[114:115], v244 offset:12288
  v_mfma_f32_16x16x32_bf16 a[84:87], v[84:87], a[180:183], a[84:87]
  ds_read_b64_tr_b16 v[118:119], v245 offset:12288
  v_mfma_f32_16x16x32_bf16 a[88:91], v[84:87], a[184:187], a[88:91]
  ds_read_b64_tr_b16 v[122:123], v246 offset:12288
  v_mfma_f32_16x16x32_bf16 a[92:95], v[84:87], a[188:191], a[92:95]
  ds_read_b64_tr_b16 v[126:127], v247 offset:12288
  v_mfma_f32_16x16x32_bf16 a[96:99], v[88:91], a[176:179], a[96:99]
  s_add_u32 m0, s52, 8192
  s_xor_b32 s54, s58, 360448
  v_mfma_f32_16x16x32_bf16 a[100:103], v[88:91], a[180:183], a[100:103]
  buffer_load_dwordx4 v42, s[24:27], s54 offen offset:0 lds
  v_mfma_f32_16x16x32_bf16 a[104:107], v[88:91], a[184:187], a[104:107]
  v_mfma_f32_16x16x32_bf16 a[108:111], v[88:91], a[188:191], a[108:111]
  buffer_load_dwordx4 v43, s[24:27], s54 offen offset:1024 lds
  v_mfma_f32_16x16x32_bf16 a[112:115], v[92:95], a[176:179], a[112:115]
  v_mfma_f32_16x16x32_bf16 a[116:119], v[92:95], a[180:183], a[116:119]
  buffer_load_dwordx4 v44, s[24:27], s54 offen offset:2048 lds
  v_mfma_f32_16x16x32_bf16 a[120:123], v[92:95], a[184:187], a[120:123]
  v_mfma_f32_16x16x32_bf16 a[124:127], v[92:95], a[188:191], a[124:127]
  buffer_load_dwordx4 v45, s[24:27], s54 offen offset:3072 lds
  s_waitcnt vmcnt(8) lgkmcnt(0)
  v_mfma_f32_16x16x32_bf16 a[0:3], v[96:99], a[192:195], a[0:3]
  v_xor_b32 v36, 640, v35
  ds_read_b128 a[176:179], v36 offset:0
  v_mfma_f32_16x16x32_bf16 a[4:7], v[96:99], a[196:199], a[4:7]
  ds_read_b128 a[180:183], v36 offset:16384
  ds_read_b128 a[184:187], v36 offset:32768
  v_mfma_f32_16x16x32_bf16 a[8:11], v[96:99], a[200:203], a[8:11]
  ds_read_b128 a[188:191], v36 offset:49152
  v_mfma_f32_16x16x32_bf16 a[12:15], v[96:99], a[204:207], a[12:15]
  ds_read_b64_tr_b16 v[64:65], v240 offset:0
  ds_read_b64_tr_b16 v[68:69], v241 offset:0
  v_mfma_f32_16x16x32_bf16 a[16:19], v[100:103], a[192:195], a[16:19]
  ds_read_b64_tr_b16 v[72:73], v242 offset:0
  ds_read_b64_tr_b16 v[76:77], v243 offset:0
  v_mfma_f32_16x16x32_bf16 a[20:23], v[100:103], a[196:199], a[20:23]
  ds_read_b64_tr_b16 v[80:81], v244 offset:0
  v_mfma_f32_16x16x32_bf16 a[24:27], v[100:103], a[200:203], a[24:27]
  ds_read_b64_tr_b16 v[84:85], v245 offset:0
  ds_read_b64_tr_b16 v[88:89], v246 offset:0
  v_mfma_f32_16x16x32_bf16 a[28:31], v[100:103], a[204:207], a[28:31]
  ds_read_b64_tr_b16 v[92:93], v247 offset:0
  v_mfma_f32_16x16x32_bf16 a[32:35], v[104:107], a[192:195], a[32:35]
  s_add_u32 m0, s52, 12288
  s_xor_b32 s54, s58, 376832
  v_mfma_f32_16x16x32_bf16 a[36:39], v[104:107], a[196:199], a[36:39]
  buffer_load_dwordx4 v42, s[24:27], s54 offen offset:0 lds
  v_mfma_f32_16x16x32_bf16 a[40:43], v[104:107], a[200:203], a[40:43]
  v_mfma_f32_16x16x32_bf16 a[44:47], v[104:107], a[204:207], a[44:47]
  buffer_load_dwordx4 v43, s[24:27], s54 offen offset:1024 lds
  v_mfma_f32_16x16x32_bf16 a[48:51], v[108:111], a[192:195], a[48:51]
  v_mfma_f32_16x16x32_bf16 a[52:55], v[108:111], a[196:199], a[52:55]
  buffer_load_dwordx4 v44, s[24:27], s54 offen offset:2048 lds
  v_mfma_f32_16x16x32_bf16 a[56:59], v[108:111], a[200:203], a[56:59]
  v_mfma_f32_16x16x32_bf16 a[60:63], v[108:111], a[204:207], a[60:63]
  buffer_load_dwordx4 v45, s[24:27], s54 offen offset:3072 lds
  s_waitcnt vmcnt(8) lgkmcnt(0)
  v_mfma_f32_16x16x32_bf16 a[64:67], v[112:115], a[192:195], a[64:67]
  ds_read_b64_tr_b16 v[66:67], v240 offset:4096
  v_mfma_f32_16x16x32_bf16 a[68:71], v[112:115], a[196:199], a[68:71]
  ds_read_b64_tr_b16 v[70:71], v241 offset:4096
  v_mfma_f32_16x16x32_bf16 a[72:75], v[112:115], a[200:203], a[72:75]
  ds_read_b64_tr_b16 v[74:75], v242 offset:4096
  v_mfma_f32_16x16x32_bf16 a[76:79], v[112:115], a[204:207], a[76:79]
  ds_read_b64_tr_b16 v[78:79], v243 offset:4096
  v_mfma_f32_16x16x32_bf16 a[80:83], v[116:119], a[192:195], a[80:83]
  ds_read_b64_tr_b16 v[82:83], v244 offset:4096
  v_mfma_f32_16x16x32_bf16 a[84:87], v[116:119], a[196:199], a[84:87]
  ds_read_b64_tr_b16 v[86:87], v245 offset:4096
  v_mfma_f32_16x16x32_bf16 a[88:91], v[116:119], a[200:203], a[88:91]
  ds_read_b64_tr_b16 v[90:91], v246 offset:4096
  v_mfma_f32_16x16x32_bf16 a[92:95], v[116:119], a[204:207], a[92:95]
  ds_read_b64_tr_b16 v[94:95], v247 offset:4096
  v_mfma_f32_16x16x32_bf16 a[96:99], v[120:123], a[192:195], a[96:99]
  s_add_u32 m0, s52, 0
  s_xor_b32 s54, s58, 393216
  v_mfma_f32_16x16x32_bf16 a[100:103], v[120:123], a[196:199], a[100:103]
  buffer_load_dwordx4 v42, s[24:27], s54 offen offset:0 lds
  v_mfma_f32_16x16x32_bf16 a[104:107], v[120:123], a[200:203], a[104:107]
  v_mfma_f32_16x16x32_bf16 a[108:111], v[120:123], a[204:207], a[108:111]
  buffer_load_dwordx4 v43, s[24:27], s54 offen offset:1024 lds
  v_mfma_f32_16x16x32_bf16 a[112:115], v[124:127], a[192:195], a[112:115]
  v_mfma_f32_16x16x32_bf16 a[116:119], v[124:127], a[196:199], a[116:119]
  buffer_load_dwordx4 v44, s[24:27], s54 offen offset:2048 lds
  v_mfma_f32_16x16x32_bf16 a[120:123], v[124:127], a[200:203], a[120:123]
  v_mfma_f32_16x16x32_bf16 a[124:127], v[124:127], a[204:207], a[124:127]
  buffer_load_dwordx4 v45, s[24:27], s54 offen offset:3072 lds
  s_waitcnt vmcnt(8) lgkmcnt(0)
  v_mfma_f32_16x16x32_bf16 a[0:3], v[64:67], a[176:179], a[0:3]
  v_xor_b32 v36, 704, v35
  ds_read_b128 a[192:195], v36 offset:0
  v_mfma_f32_16x16x32_bf16 a[4:7], v[64:67], a[180:183], a[4:7]
  ds_read_b128 a[196:199], v36 offset:16384
  ds_read_b128 a[200:203], v36 offset:32768
  v_mfma_f32_16x16x32_bf16 a[8:11], v[64:67], a[184:187], a[8:11]
  ds_read_b128 a[204:207], v36 offset:49152
  v_mfma_f32_16x16x32_bf16 a[12:15], v[64:67], a[188:191], a[12:15]
  ds_read_b64_tr_b16 v[96:97], v240 offset:8192
  ds_read_b64_tr_b16 v[100:101], v241 offset:8192
  v_mfma_f32_16x16x32_bf16 a[16:19], v[68:71], a[176:179], a[16:19]
  ds_read_b64_tr_b16 v[104:105], v242 offset:8192
  ds_read_b64_tr_b16 v[108:109], v243 offset:8192
  v_mfma_f32_16x16x32_bf16 a[20:23], v[68:71], a[180:183], a[20:23]
  ds_read_b64_tr_b16 v[112:113], v244 offset:8192
  v_mfma_f32_16x16x32_bf16 a[24:27], v[68:71], a[184:187], a[24:27]
  ds_read_b64_tr_b16 v[116:117], v245 offset:8192
  ds_read_b64_tr_b16 v[120:121], v246 offset:8192
  v_mfma_f32_16x16x32_bf16 a[28:31], v[68:71], a[188:191], a[28:31]
  ds_read_b64_tr_b16 v[124:125], v247 offset:8192
  v_mfma_f32_16x16x32_bf16 a[32:35], v[72:75], a[176:179], a[32:35]
  s_add_u32 m0, s52, 4096
  s_xor_b32 s54, s58, 409600
  v_mfma_f32_16x16x32_bf16 a[36:39], v[72:75], a[180:183], a[36:39]
  buffer_load_dwordx4 v42, s[24:27], s54 offen offset:0 lds
  v_mfma_f32_16x16x32_bf16 a[40:43], v[72:75], a[184:187], a[40:43]
  v_mfma_f32_16x16x32_bf16 a[44:47], v[72:75], a[188:191], a[44:47]
  buffer_load_dwordx4 v43, s[24:27], s54 offen offset:1024 lds
  v_mfma_f32_16x16x32_bf16 a[48:51], v[76:79], a[176:179], a[48:51]
  v_mfma_f32_16x16x32_bf16 a[52:55], v[76:79], a[180:183], a[52:55]
  buffer_load_dwordx4 v44, s[24:27], s54 offen offset:2048 lds
  v_mfma_f32_16x16x32_bf16 a[56:59], v[76:79], a[184:187], a[56:59]
  v_mfma_f32_16x16x32_bf16 a[60:63], v[76:79], a[188:191], a[60:63]
  buffer_load_dwordx4 v45, s[24:27], s54 offen offset:3072 lds
  s_waitcnt vmcnt(8) lgkmcnt(0)
  v_mfma_f32_16x16x32_bf16 a[64:67], v[80:83], a[176:179], a[64:67]
  ds_read_b64_tr_b16 v[98:99], v240 offset:12288
  v_mfma_f32_16x16x32_bf16 a[68:71], v[80:83], a[180:183], a[68:71]
  ds_read_b64_tr_b16 v[102:103], v241 offset:12288
  v_mfma_f32_16x16x32_bf16 a[72:75], v[80:83], a[184:187], a[72:75]
  ds_read_b64_tr_b16 v[106:107], v242 offset:12288
  v_mfma_f32_16x16x32_bf16 a[76:79], v[80:83], a[188:191], a[76:79]
  ds_read_b64_tr_b16 v[110:111], v243 offset:12288
  v_mfma_f32_16x16x32_bf16 a[80:83], v[84:87], a[176:179], a[80:83]
  ds_read_b64_tr_b16 v[114:115], v244 offset:12288
  v_mfma_f32_16x16x32_bf16 a[84:87], v[84:87], a[180:183], a[84:87]
  ds_read_b64_tr_b16 v[118:119], v245 offset:12288
  v_mfma_f32_16x16x32_bf16 a[88:91], v[84:87], a[184:187], a[88:91]
  ds_read_b64_tr_b16 v[122:123], v246 offset:12288
  v_mfma_f32_16x16x32_bf16 a[92:95], v[84:87], a[188:191], a[92:95]
  ds_read_b64_tr_b16 v[126:127], v247 offset:12288
  v_mfma_f32_16x16x32_bf16 a[96:99], v[88:91], a[176:179], a[96:99]
  s_add_u32 m0, s52, 8192
  s_xor_b32 s54, s58, 425984
  v_mfma_f32_16x16x32_bf16 a[100:103], v[88:91], a[180:183], a[100:103]
  buffer_load_dwordx4 v42, s[24:27], s54 offen offset:0 lds
  v_mfma_f32_16x16x32_bf16 a[104:107], v[88:91], a[184:187], a[104:107]
  v_mfma_f32_16x16x32_bf16 a[108:111], v[88:91], a[188:191], a[108:111]
  buffer_load_dwordx4 v43, s[24:27], s54 offen offset:1024 lds
  v_mfma_f32_16x16x32_bf16 a[112:115], v[92:95], a[176:179], a[112:115]
  v_mfma_f32_16x16x32_bf16 a[116:119], v[92:95], a[180:183], a[116:119]
  buffer_load_dwordx4 v44, s[24:27], s54 offen offset:2048 lds
  v_mfma_f32_16x16x32_bf16 a[120:123], v[92:95], a[184:187], a[120:123]
  v_mfma_f32_16x16x32_bf16 a[124:127], v[92:95], a[188:191], a[124:127]
  buffer_load_dwordx4 v45, s[24:27], s54 offen offset:3072 lds
  s_waitcnt vmcnt(8) lgkmcnt(0)
  v_mfma_f32_16x16x32_bf16 a[0:3], v[96:99], a[192:195], a[0:3]
  v_xor_b32 v36, 768, v35
  ds_read_b128 a[176:179], v36 offset:0
  v_mfma_f32_16x16x32_bf16 a[4:7], v[96:99], a[196:199], a[4:7]
  ds_read_b128 a[180:183], v36 offset:16384
  ds_read_b128 a[184:187], v36 offset:32768
  v_mfma_f32_16x16x32_bf16 a[8:11], v[96:99], a[200:203], a[8:11]
  ds_read_b128 a[188:191], v36 offset:49152
  v_mfma_f32_16x16x32_bf16 a[12:15], v[96:99], a[204:207], a[12:15]
  ds_read_b64_tr_b16 v[64:65], v240 offset:0
  ds_read_b64_tr_b16 v[68:69], v241 offset:0
  v_mfma_f32_16x16x32_bf16 a[16:19], v[100:103], a[192:195], a[16:19]
  ds_read_b64_tr_b16 v[72:73], v242 offset:0
  ds_read_b64_tr_b16 v[76:77], v243 offset:0
  v_mfma_f32_16x16x32_bf16 a[20:23], v[100:103], a[196:199], a[20:23]
  ds_read_b64_tr_b16 v[80:81], v244 offset:0
  v_mfma_f32_16x16x32_bf16 a[24:27], v[100:103], a[200:203], a[24:27]
  ds_read_b64_tr_b16 v[84:85], v245 offset:0
  ds_read_b64_tr_b16 v[88:89], v246 offset:0
  v_mfma_f32_16x16x32_bf16 a[28:31], v[100:103], a[204:207], a[28:31]
  ds_read_b64_tr_b16 v[92:93], v247 offset:0
  v_mfma_f32_16x16x32_bf16 a[32:35], v[104:107], a[192:195], a[32:35]
  s_add_u32 m0, s52, 12288
  s_xor_b32 s54, s58, 442368
  v_mfma_f32_16x16x32_bf16 a[36:39], v[104:107], a[196:199], a[36:39]
  buffer_load_dwordx4 v42, s[24:27], s54 offen offset:0 lds
  v_mfma_f32_16x16x32_bf16 a[40:43], v[104:107], a[200:203], a[40:43]
  v_mfma_f32_16x16x32_bf16 a[44:47], v[104:107], a[204:207], a[44:47]
  buffer_load_dwordx4 v43, s[24:27], s54 offen offset:1024 lds
  v_mfma_f32_16x16x32_bf16 a[48:51], v[108:111], a[192:195], a[48:51]
  v_mfma_f32_16x16x32_bf16 a[52:55], v[108:111], a[196:199], a[52:55]
  buffer_load_dwordx4 v44, s[24:27], s54 offen offset:2048 lds
  v_mfma_f32_16x16x32_bf16 a[56:59], v[108:111], a[200:203], a[56:59]
  v_mfma_f32_16x16x32_bf16 a[60:63], v[108:111], a[204:207], a[60:63]
  buffer_load_dwordx4 v45, s[24:27], s54 offen offset:3072 lds
  s_waitcnt vmcnt(8) lgkmcnt(0)
  v_mfma_f32_16x16x32_bf16 a[64:67], v[112:115], a[192:195], a[64:67]
  ds_read_b64_tr_b16 v[66:67], v240 offset:4096
  v_mfma_f32_16x16x32_bf16 a[68:71], v[112:115], a[196:199], a[68:71]
  ds_read_b64_tr_b16 v[70:71], v241 offset:4096
  v_mfma_f32_16x16x32_bf16 a[72:75], v[112:115], a[200:203], a[72:75]
  ds_read_b64_tr_b16 v[74:75], v242 offset:4096
  v_mfma_f32_16x16x32_bf16 a[76:79], v[112:115], a[204:207], a[76:79]
  ds_read_b64_tr_b16 v[78:79], v243 offset:4096
  v_mfma_f32_16x16x32_bf16 a[80:83], v[116:119], a[192:195], a[80:83]
  ds_read_b64_tr_b16 v[82:83], v244 offset:4096
  v_mfma_f32_16x16x32_bf16 a[84:87], v[116:119], a[196:199], a[84:87]
  ds_read_b64_tr_b16 v[86:87], v245 offset:4096
  v_mfma_f32_16x16x32_bf16 a[88:91], v[116:119], a[200:203], a[88:91]
  ds_read_b64_tr_b16 v[90:91], v246 offset:4096
  v_mfma_f32_16x16x32_bf16 a[92:95], v[116:119], a[204:207], a[92:95]
  ds_read_b64_tr_b16 v[94:95], v247 offset:4096
  v_mfma_f32_16x16x32_bf16 a[96:99], v[120:123], a[192:195], a[96:99]
  s_add_u32 m0, s52, 0
  s_xor_b32 s54, s58, 458752
  v_mfma_f32_16x16x32_bf16 a[100:103], v[120:123], a[196:199], a[100:103]
  buffer_load_dwordx4 v42, s[24:27], s54 offen offset:0 lds
  v_mfma_f32_16x16x32_bf16 a[104:107], v[120:123], a[200:203], a[104:107]
  v_mfma_f32_16x16x32_bf16 a[108:111], v[120:123], a[204:207], a[108:111]
  buffer_load_dwordx4 v43, s[24:27], s54 offen offset:1024 lds
  v_mfma_f32_16x16x32_bf16 a[112:115], v[124:127], a[192:195], a[112:115]
  v_mfma_f32_16x16x32_bf16 a[116:119], v[124:127], a[196:199], a[116:119]
  buffer_load_dwordx4 v44, s[24:27], s54 offen offset:2048 lds
  v_mfma_f32_16x16x32_bf16 a[120:123], v[124:127], a[200:203], a[120:123]
  v_mfma_f32_16x16x32_bf16 a[124:127], v[124:127], a[204:207], a[124:127]
  buffer_load_dwordx4 v45, s[24:27], s54 offen offset:3072 lds
  s_waitcnt vmcnt(8) lgkmcnt(0)
  v_mfma_f32_16x16x32_bf16 a[0:3], v[64:67], a[176:179], a[0:3]
  v_xor_b32 v36, 832, v35
  ds_read_b128 a[192:195], v36 offset:0
  v_mfma_f32_16x16x32_bf16 a[4:7], v[64:67], a[180:183], a[4:7]
  ds_read_b128 a[196:199], v36 offset:16384
  ds_read_b128 a[200:203], v36 offset:32768
  v_mfma_f32_16x16x32_bf16 a[8:11], v[64:67], a[184:187], a[8:11]
  ds_read_b128 a[204:207], v36 offset:49152
  v_mfma_f32_16x16x32_bf16 a[12:15], v[64:67], a[188:191], a[12:15]
  ds_read_b64_tr_b16 v[96:97], v240 offset:8192
  ds_read_b64_tr_b16 v[100:101], v241 offset:8192
  v_mfma_f32_16x16x32_bf16 a[16:19], v[68:71], a[176:179], a[16:19]
  ds_read_b64_tr_b16 v[104:105], v242 offset:8192
  ds_read_b64_tr_b16 v[108:109], v243 offset:8192
  v_mfma_f32_16x16x32_bf16 a[20:23], v[68:71], a[180:183], a[20:23]
  ds_read_b64_tr_b16 v[112:113], v244 offset:8192
  v_mfma_f32_16x16x32_bf16 a[24:27], v[68:71], a[184:187], a[24:27]
  ds_read_b64_tr_b16 v[116:117], v245 offset:8192
  ds_read_b64_tr_b16 v[120:121], v246 offset:8192
  v_mfma_f32_16x16x32_bf16 a[28:31], v[68:71], a[188:191], a[28:31]
  ds_read_b64_tr_b16 v[124:125], v247 offset:8192
  v_mfma_f32_16x16x32_bf16 a[32:35], v[72:75], a[176:179], a[32:35]
  s_add_u32 m0, s52, 4096
  s_xor_b32 s54, s58, 475136
  v_mfma_f32_16x16x32_bf16 a[36:39], v[72:75], a[180:183], a[36:39]
  buffer_load_dwordx4 v42, s[24:27], s54 offen offset:0 lds
  v_mfma_f32_16x16x32_bf16 a[40:43], v[72:75], a[184:187], a[40:43]
  v_mfma_f32_16x16x32_bf16 a[44:47], v[72:75], a[188:191], a[44:47]
  buffer_load_dwordx4 v43, s[24:27], s54 offen offset:1024 lds
  v_mfma_f32_16x16x32_bf16 a[48:51], v[76:79], a[176:179], a[48:51]
  v_mfma_f32_16x16x32_bf16 a[52:55], v[76:79], a[180:183], a[52:55]
  buffer_load_dwordx4 v44, s[24:27], s54 offen offset:2048 lds
  v_mfma_f32_16x16x32_bf16 a[56:59], v[76:79], a[184:187], a[56:59]
  v_mfma_f32_16x16x32_bf16 a[60:63], v[76:79], a[188:191], a[60:63]
  buffer_load_dwordx4 v45, s[24:27], s54 offen offset:3072 lds
  s_waitcnt vmcnt(8) lgkmcnt(0)
  v_mfma_f32_16x16x32_bf16 a[64:67], v[80:83], a[176:179], a[64:67]
  ds_read_b64_tr_b16 v[98:99], v240 offset:12288
  v_mfma_f32_16x16x32_bf16 a[68:71], v[80:83], a[180:183], a[68:71]
  ds_read_b64_tr_b16 v[102:103], v241 offset:12288
  v_mfma_f32_16x16x32_bf16 a[72:75], v[80:83], a[184:187], a[72:75]
  ds_read_b64_tr_b16 v[106:107], v242 offset:12288
  v_mfma_f32_16x16x32_bf16 a[76:79], v[80:83], a[188:191], a[76:79]
  ds_read_b64_tr_b16 v[110:111], v243 offset:12288
  v_mfma_f32_16x16x32_bf16 a[80:83], v[84:87], a[176:179], a[80:83]
  ds_read_b64_tr_b16 v[114:115], v244 offset:12288
  v_mfma_f32_16x16x32_bf16 a[84:87], v[84:87], a[180:183], a[84:87]
  ds_read_b64_tr_b16 v[118:119], v245 offset:12288
  v_mfma_f32_16x16x32_bf16 a[88:91], v[84:87], a[184:187], a[88:91]
  ds_read_b64_tr_b16 v[122:123], v246 offset:12288
  v_mfma_f32_16x16x32_bf16 a[92:95], v[84:87], a[188:191], a[92:95]
  ds_read_b64_tr_b16 v[126:127], v247 offset:12288
  v_mfma_f32_16x16x32_bf16 a[96:99], v[88:91], a[176:179], a[96:99]
  s_add_u32 m0, s52, 8192
  s_xor_b32 s54, s58, 491520
  v_mfma_f32_16x16x32_bf16 a[100:103], v[88:91], a[180:183], a[100:103]
  buffer_load_dwordx4 v42, s[24:27], s54 offen offset:0 lds
  v_mfma_f32_16x16x32_bf16 a[104:107], v[88:91], a[184:187], a[104:107]
  v_mfma_f32_16x16x32_bf16 a[108:111], v[88:91], a[188:191], a[108:111]
  buffer_load_dwordx4 v43, s[24:27], s54 offen offset:1024 lds
  v_mfma_f32_16x16x32_bf16 a[112:115], v[92:95], a[176:179], a[112:115]
  v_mfma_f32_16x16x32_bf16 a[116:119], v[92:95], a[180:183], a[116:119]
  buffer_load_dwordx4 v44, s[24:27], s54 offen offset:2048 lds
  v_mfma_f32_16x16x32_bf16 a[120:123], v[92:95], a[184:187], a[120:123]
  v_mfma_f32_16x16x32_bf16 a[124:127], v[92:95], a[188:191], a[124:127]
  buffer_load_dwordx4 v45, s[24:27], s54 offen offset:3072 lds
  s_waitcnt vmcnt(8) lgkmcnt(0)
  v_mfma_f32_16x16x32_bf16 a[0:3], v[96:99], a[192:195], a[0:3]
  v_xor_b32 v36, 896, v35
  ds_read_b128 a[176:179], v36 offset:0
  v_mfma_f32_16x16x32_bf16 a[4:7], v[96:99], a[196:199], a[4:7]
  ds_read_b128 a[180:183], v36 offset:16384
  ds_read_b128 a[184:187], v36 offset:32768
  v_mfma_f32_16x16x32_bf16 a[8:11], v[96:99], a[200:203], a[8:11]
  ds_read_b128 a[188:191], v36 offset:49152
  v_mfma_f32_16x16x32_bf16 a[12:15], v[96:99], a[204:207], a[12:15]
  ds_read_b64_tr_b16 v[64:65], v240 offset:0
  ds_read_b64_tr_b16 v[68:69], v241 offset:0
  v_mfma_f32_16x16x32_bf16 a[16:19], v[100:103], a[192:195], a[16:19]
  ds_read_b64_tr_b16 v[72:73], v242 offset:0
  ds_read_b64_tr_b16 v[76:77], v243 offset:0
  v_mfma_f32_16x16x32_bf16 a[20:23], v[100:103], a[196:199], a[20:23]
  ds_read_b64_tr_b16 v[80:81], v244 offset:0
  v_mfma_f32_16x16x32_bf16 a[24:27], v[100:103], a[200:203], a[24:27]
  ds_read_b64_tr_b16 v[84:85], v245 offset:0
  ds_read_b64_tr_b16 v[88:89], v246 offset:0
  v_mfma_f32_16x16x32_bf16 a[28:31], v[100:103], a[204:207], a[28:31]
  ds_read_b64_tr_b16 v[92:93], v247 offset:0
  v_mfma_f32_16x16x32_bf16 a[32:35], v[104:107], a[192:195], a[32:35]
  s_add_u32 m0, s52, 12288
  s_xor_b32 s54, s58, 507904
  v_mfma_f32_16x16x32_bf16 a[36:39], v[104:107], a[196:199], a[36:39]
  buffer_load_dwordx4 v42, s[24:27], s54 offen offset:0 lds
  v_mfma_f32_16x16x32_bf16 a[40:43], v[104:107], a[200:203], a[40:43]
  v_mfma_f32_16x16x32_bf16 a[44:47], v[104:107], a[204:207], a[44:47]
  buffer_load_dwordx4 v43, s[24:27], s54 offen offset:1024 lds
  v_mfma_f32_16x16x32_bf16 a[48:51], v[108:111], a[192:195], a[48:51]
  v_mfma_f32_16x16x32_bf16 a[52:55], v[108:111], a[196:199], a[52:55]
  buffer_load_dwordx4 v44, s[24:27], s54 offen offset:2048 lds
  v_mfma_f32_16x16x32_bf16 a[56:59], v[108:111], a[200:203], a[56:59]
  v_mfma_f32_16x16x32_bf16 a[60:63], v[108:111], a[204:207], a[60:63]
  buffer_load_dwordx4 v45, s[24:27], s54 offen offset:3072 lds
  s_waitcnt vmcnt(8) lgkmcnt(0)
  v_mfma_f32_16x16x32_bf16 a[64:67], v[112:115], a[192:195], a[64:67]
  ds_read_b64_tr_b16 v[66:67], v240 offset:4096
  v_mfma_f32_16x16x32_bf16 a[68:71], v[112:115], a[196:199], a[68:71]
  ds_read_b64_tr_b16 v[70:71], v241 offset:4096
  v_mfma_f32_16x16x32_bf16 a[72:75], v[112:115], a[200:203], a[72:75]
  ds_read_b64_tr_b16 v[74:75], v242 offset:4096
  v_mfma_f32_16x16x32_bf16 a[76:79], v[112:115], a[204:207], a[76:79]
  ds_read_b64_tr_b16 v[78:79], v243 offset:4096
  v_mfma_f32_16x16x32_bf16 a[80:83], v[116:119], a[192:195], a[80:83]
  ds_read_b64_tr_b16 v[82:83], v244 offset:4096
  v_mfma_f32_16x16x32_bf16 a[84:87], v[116:119], a[196:199], a[84:87]
  ds_read_b64_tr_b16 v[86:87], v245 offset:4096
  v_mfma_f32_16x16x32_bf16 a[88:91], v[116:119], a[200:203], a[88:91]
  ds_read_b64_tr_b16 v[90:91], v246 offset:4096
  v_mfma_f32_16x16x32_bf16 a[92:95], v[116:119], a[204:207], a[92:95]
  ds_read_b64_tr_b16 v[94:95], v247 offset:4096
  v_mfma_f32_16x16x32_bf16 a[96:99], v[120:123], a[192:195], a[96:99]
  s_add_u32 m0, s52, 0
  s_add_u32 s54, s59, 65536
  s_sub_u32 s3, s54, 458752
  s_min_u32 s54, s54, s3
  v_mfma_f32_16x16x32_bf16 a[100:103], v[120:123], a[196:199], a[100:103]
  buffer_load_dwordx4 v38, s[36:39], s54 offen offset:0 lds
  v_mfma_f32_16x16x32_bf16 a[104:107], v[120:123], a[200:203], a[104:107]
  v_mfma_f32_16x16x32_bf16 a[108:111], v[120:123], a[204:207], a[108:111]
  buffer_load_dwordx4 v39, s[36:39], s54 offen offset:1024 lds
  v_mfma_f32_16x16x32_bf16 a[112:115], v[124:127], a[192:195], a[112:115]
  v_mfma_f32_16x16x32_bf16 a[116:119], v[124:127], a[196:199], a[116:119]
  buffer_load_dwordx4 v40, s[36:39], s54 offen offset:2048 lds
  v_mfma_f32_16x16x32_bf16 a[120:123], v[124:127], a[200:203], a[120:123]
  v_mfma_f32_16x16x32_bf16 a[124:127], v[124:127], a[204:207], a[124:127]
  buffer_load_dwordx4 v41, s[36:39], s54 offen offset:3072 lds
  s_waitcnt vmcnt(8) lgkmcnt(0)
  v_mfma_f32_16x16x32_bf16 a[0:3], v[64:67], a[176:179], a[0:3]
  v_xor_b32 v36, 960, v35
  ds_read_b128 a[192:195], v36 offset:0
  v_mfma_f32_16x16x32_bf16 a[4:7], v[64:67], a[180:183], a[4:7]
  ds_read_b128 a[196:199], v36 offset:16384
  ds_read_b128 a[200:203], v36 offset:32768
  v_mfma_f32_16x16x32_bf16 a[8:11], v[64:67], a[184:187], a[8:11]
  ds_read_b128 a[204:207], v36 offset:49152
  v_mfma_f32_16x16x32_bf16 a[12:15], v[64:67], a[188:191], a[12:15]
  ds_read_b64_tr_b16 v[96:97], v240 offset:8192
  ds_read_b64_tr_b16 v[100:101], v241 offset:8192
  v_mfma_f32_16x16x32_bf16 a[16:19], v[68:71], a[176:179], a[16:19]
  ds_read_b64_tr_b16 v[104:105], v242 offset:8192
  ds_read_b64_tr_b16 v[108:109], v243 offset:8192
  v_mfma_f32_16x16x32_bf16 a[20:23], v[68:71], a[180:183], a[20:23]
  ds_read_b64_tr_b16 v[112:113], v244 offset:8192
  v_mfma_f32_16x16x32_bf16 a[24:27], v[68:71], a[184:187], a[24:27]
  ds_read_b64_tr_b16 v[116:117], v245 offset:8192
  ds_read_b64_tr_b16 v[120:121], v246 offset:8192
  v_mfma_f32_16x16x32_bf16 a[28:31], v[68:71], a[188:191], a[28:31]
  ds_read_b64_tr_b16 v[124:125], v247 offset:8192
  v_mfma_f32_16x16x32_bf16 a[32:35], v[72:75], a[176:179], a[32:35]
  s_add_u32 m0, s52, 4096
  s_add_u32 s54, s59, 98304
  s_sub_u32 s3, s54, 458752
  s_min_u32 s54, s54, s3
  v_mfma_f32_16x16x32_bf16 a[36:39], v[72:75], a[180:183], a[36:39]
  buffer_load_dwordx4 v38, s[36:39], s54 offen offset:0 lds
  v_mfma_f32_16x16x32_bf16 a[40:43], v[72:75], a[184:187], a[40:43]
  v_mfma_f32_16x16x32_bf16 a[44:47], v[72:75], a[188:191], a[44:47]
  buffer_load_dwordx4 v39, s[36:39], s54 offen offset:1024 lds
  v_mfma_f32_16x16x32_bf16 a[48:51], v[76:79], a[176:179], a[48:51]
  v_mfma_f32_16x16x32_bf16 a[52:55], v[76:79], a[180:183], a[52:55]
  buffer_load_dwordx4 v40, s[36:39], s54 offen offset:2048 lds
  v_mfma_f32_16x16x32_bf16 a[56:59], v[76:79], a[184:187], a[56:59]
  v_mfma_f32_16x16x32_bf16 a[60:63], v[76:79], a[188:191], a[60:63]
  buffer_load_dwordx4 v41, s[36:39], s54 offen offset:3072 lds
  s_waitcnt vmcnt(8) lgkmcnt(0)
  v_mfma_f32_16x16x32_bf16 a[64:67], v[80:83], a[176:179], a[64:67]
  ds_read_b64_tr_b16 v[98:99], v240 offset:12288
  s_barrier
  v_mfma_f32_16x16x32_bf16 a[68:71], v[80:83], a[180:183], a[68:71]
  ds_read_b64_tr_b16 v[102:103], v241 offset:12288
  s_add_u32 m0, s53, 0
  s_add_u32 s54, s59, 196608
  s_sub_u32 s3, s54, 458752
  s_min_u32 s54, s54, s3
  buffer_load_dwordx4 v38, s[36:39], s54 offen offset:0 lds
  v_mfma_f32_16x16x32_bf16 a[72:75], v[80:83], a[184:187], a[72:75]
  ds_read_b64_tr_b16 v[106:107], v242 offset:12288
  v_mfma_f32_16x16x32_bf16 a[76:79], v[80:83], a[188:191], a[76:79]
  ds_read_b64_tr_b16 v[110:111], v243 offset:12288
  buffer_load_dwordx4 v39, s[36:39], s54 offen offset:1024 lds
  v_mfma_f32_16x16x32_bf16 a[80:83], v[84:87], a[176:179], a[80:83]
  ds_read_b64_tr_b16 v[114:115], v244 offset:12288
  v_mfma_f32_16x16x32_bf16 a[84:87], v[84:87], a[180:183], a[84:87]
  ds_read_b64_tr_b16 v[118:119], v245 offset:12288
  buffer_load_dwordx4 v40, s[36:39], s54 offen offset:2048 lds
  v_mfma_f32_16x16x32_bf16 a[88:91], v[84:87], a[184:187], a[88:91]
  ds_read_b64_tr_b16 v[122:123], v246 offset:12288
  v_mfma_f32_16x16x32_bf16 a[92:95], v[84:87], a[188:191], a[92:95]
  ds_read_b64_tr_b16 v[126:127], v247 offset:12288
  buffer_load_dwordx4 v41, s[36:39], s54 offen offset:3072 lds
  v_mfma_f32_16x16x32_bf16 a[96:99], v[88:91], a[176:179], a[96:99]
  s_add_u32 m0, s52, 8192
  s_add_u32 s54, s59, 131072
  s_sub_u32 s3, s54, 458752
  s_min_u32 s54, s54, s3
  v_mfma_f32_16x16x32_bf16 a[100:103], v[88:91], a[180:183], a[100:103]
  buffer_load_dwordx4 v38, s[36:39], s54 offen offset:0 lds
  v_mfma_f32_16x16x32_bf16 a[104:107], v[88:91], a[184:187], a[104:107]
  v_mfma_f32_16x16x32_bf16 a[108:111], v[88:91], a[188:191], a[108:111]
  buffer_load_dwordx4 v39, s[36:39], s54 offen offset:1024 lds
  v_mfma_f32_16x16x32_bf16 a[112:115], v[92:95], a[176:179], a[112:115]
  v_mfma_f32_16x16x32_bf16 a[116:119], v[92:95], a[180:183], a[116:119]
  buffer_load_dwordx4 v40, s[36:39], s54 offen offset:2048 lds
  v_mfma_f32_16x16x32_bf16 a[120:123], v[92:95], a[184:187], a[120:123]
  v_mfma_f32_16x16x32_bf16 a[124:127], v[92:95], a[188:191], a[124:127]
  buffer_load_dwordx4 v41, s[36:39], s54 offen offset:3072 lds
  s_waitcnt lgkmcnt(0)
  v_mfma_f32_16x16x32_bf16 a[0:3], v[96:99], a[192:195], a[0:3]
  v_mfma_f32_16x16x32_bf16 a[4:7], v[96:99], a[196:199], a[4:7]
  s_add_u32 m0, s53, 4096
  s_add_u32 s54, s59, 229376
  s_sub_u32 s3, s54, 458752
  s_min_u32 s54, s54, s3
  buffer_load_dwordx4 v38, s[36:39], s54 offen offset:0 lds
  v_mfma_f32_16x16x32_bf16 a[8:11], v[96:99], a[200:203], a[8:11]
  v_mfma_f32_16x16x32_bf16 a[12:15], v[96:99], a[204:207], a[12:15]
  buffer_load_dwordx4 v39, s[36:39], s54 offen offset:1024 lds
  v_mfma_f32_16x16x32_bf16 a[16:19], v[100:103], a[192:195], a[16:19]
  v_mfma_f32_16x16x32_bf16 a[20:23], v[100:103], a[196:199], a[20:23]
  buffer_load_dwordx4 v40, s[36:39], s54 offen offset:2048 lds
  v_mfma_f32_16x16x32_bf16 a[24:27], v[100:103], a[200:203], a[24:27]
  v_mfma_f32_16x16x32_bf16 a[28:31], v[100:103], a[204:207], a[28:31]
  buffer_load_dwordx4 v41, s[36:39], s54 offen offset:3072 lds
  v_mfma_f32_16x16x32_bf16 a[32:35], v[104:107], a[192:195], a[32:35]
  s_add_u32 m0, s52, 12288
  s_add_u32 s54, s59, 163840
  s_sub_u32 s3, s54, 458752
  s_min_u32 s54, s54, s3
  v_mfma_f32_16x16x32_bf16 a[36:39], v[104:107], a[196:199], a[36:39]
  buffer_load_dwordx4 v38, s[36:39], s54 offen offset:0 lds
  v_mfma_f32_16x16x32_bf16 a[40:43], v[104:107], a[200:203], a[40:43]
  v_mfma_f32_16x16x32_bf16 a[44:47], v[104:107], a[204:207], a[44:47]
  buffer_load_dwordx4 v39, s[36:39], s54 offen offset:1024 lds
  v_mfma_f32_16x16x32_bf16 a[48:51], v[108:111], a[192:195], a[48:51]
  v_mfma_f32_16x16x32_bf16 a[52:55], v[108:111], a[196:199], a[52:55]
  buffer_load_dwordx4 v40, s[36:39], s54 offen offset:2048 lds
  v_mfma_f32_16x16x32_bf16 a[56:59], v[108:111], a[200:203], a[56:59]
  v_mfma_f32_16x16x32_bf16 a[60:63], v[108:111], a[204:207], a[60:63]
  buffer_load_dwordx4 v41, s[36:39], s54 offen offset:3072 lds
  v_mfma_f32_16x16x32_bf16 a[64:67], v[112:115], a[192:195], a[64:67]
  ds_read_b64_tr_b16 a[176:177], v28 offset:0
  v_accvgpr_read_b32 v8, a0
  v_accvgpr_read_b32 v9, a1
  v_accvgpr_read_b32 v10, a2
  v_accvgpr_read_b32 v11, a3
  v_accvgpr_read_b32 v12, a16
  v_accvgpr_read_b32 v13, a17
  v_accvgpr_read_b32 v14, a18
  v_mfma_f32_16x16x32_bf16 a[68:71], v[112:115], a[196:199], a[68:71]
  ds_read_b64_tr_b16 a[178:179], v28 offset:512
  v_accvgpr_read_b32 v15, a19
  v_cvt_pk_bf16_f32 v8, v8, v9
  v_cvt_pk_bf16_f32 v9, v10, v11
  v_cvt_pk_bf16_f32 v10, v12, v13
  v_cvt_pk_bf16_f32 v11, v14, v15
  buffer_store_dwordx4 v[8:11], v50, s[40:43], s62 offen offset:0 sc1
  v_accvgpr_read_b32 v16, a4
  v_mfma_f32_16x16x32_bf16 a[72:75], v[112:115], a[200:203], a[72:75]
  ds_read_b64_tr_b16 a[180:181], v29 offset:0
  v_accvgpr_read_b32 v17, a5
  v_accvgpr_read_b32 v18, a6
  v_accvgpr_read_b32 v19, a7
  v_accvgpr_read_b32 v20, a20
  v_accvgpr_read_b32 v21, a21
  v_accvgpr_read_b32 v22, a22
  v_accvgpr_read_b32 v23, a23
  v_mfma_f32_16x16x32_bf16 a[76:79], v[112:115], a[204:207], a[76:79]
  ds_read_b64_tr_b16 a[182:183], v29 offset:512
  v_cvt_pk_bf16_f32 v16, v16, v17
  v_cvt_pk_bf16_f32 v17, v18, v19
  v_cvt_pk_bf16_f32 v18, v20, v21
  v_cvt_pk_bf16_f32 v19, v22, v23
  buffer_store_dwordx4 v[16:19], v50, s[40:43], s62 offen offset:2048 sc1
  v_accvgpr_read_b32 v8, a8
  v_accvgpr_read_b32 v9, a9
  v_mfma_f32_16x16x32_bf16 a[80:83], v[116:119], a[192:195], a[80:83]
  ds_read_b64_tr_b16 a[184:185], v30 offset:0
  v_accvgpr_read_b32 v10, a10
  v_accvgpr_read_b32 v11, a11
  v_accvgpr_read_b32 v12, a24
  v_accvgpr_read_b32 v13, a25
  v_accvgpr_read_b32 v14, a26
  v_accvgpr_read_b32 v15, a27
  v_cvt_pk_bf16_f32 v8, v8, v9
  v_mfma_f32_16x16x32_bf16 a[84:87], v[116:119], a[196:199], a[84:87]
  ds_read_b64_tr_b16 a[186:187], v30 offset:512
  v_cvt_pk_bf16_f32 v9, v10, v11
  v_cvt_pk_bf16_f32 v10, v12, v13
  v_cvt_pk_bf16_f32 v11, v14, v15
  buffer_store_dwordx4 v[8:11], v50, s[40:43], s63 offen offset:0 sc1
  v_accvgpr_read_b32 v16, a12
  v_accvgpr_read_b32 v17, a13
  v_accvgpr_read_b32 v18, a14
  v_mfma_f32_16x16x32_bf16 a[88:91], v[116:119], a[200:203], a[88:91]
  ds_read_b64_tr_b16 a[188:189], v31 offset:0
  v_accvgpr_read_b32 v19, a15
  v_accvgpr_read_b32 v20, a28
  v_accvgpr_read_b32 v21, a29
  v_accvgpr_read_b32 v22, a30
  v_accvgpr_read_b32 v23, a31
  v_cvt_pk_bf16_f32 v16, v16, v17
  v_cvt_pk_bf16_f32 v17, v18, v19
  v_mfma_f32_16x16x32_bf16 a[92:95], v[116:119], a[204:207], a[92:95]
  ds_read_b64_tr_b16 a[190:191], v31 offset:512
  v_cvt_pk_bf16_f32 v18, v20, v21
  v_cvt_pk_bf16_f32 v19, v22, v23
  buffer_store_dwordx4 v[16:19], v50, s[40:43], s63 offen offset:2048 sc1
  v_accvgpr_read_b32 v8, a32
  v_accvgpr_read_b32 v9, a33
  v_accvgpr_read_b32 v10, a34
  v_accvgpr_read_b32 v11, a35
  v_mfma_f32_16x16x32_bf16 a[96:99], v[120:123], a[192:195], a[96:99]
  v_accvgpr_read_b32 v12, a48
  v_accvgpr_read_b32 v13, a49
  v_accvgpr_read_b32 v14, a50
  v_accvgpr_read_b32 v15, a51
  v_cvt_pk_bf16_f32 v8, v8, v9
  v_cvt_pk_bf16_f32 v9, v10, v11
  v_cvt_pk_bf16_f32 v10, v12, v13
  v_cvt_pk_bf16_f32 v11, v14, v15
  v_mfma_f32_16x16x32_bf16 a[100:103], v[120:123], a[196:199], a[100:103]
  buffer_store_dwordx4 v[8:11], v50, s[40:43], s62 offen offset:1024 sc1
  v_accvgpr_read_b32 v16, a36
  v_accvgpr_read_b32 v17, a37
  v_accvgpr_read_b32 v18, a38
  v_accvgpr_read_b32 v19, a39
  v_accvgpr_read_b32 v20, a52
  v_accvgpr_read_b32 v21, a53
  v_accvgpr_read_b32 v22, a54
  v_mfma_f32_16x16x32_bf16 a[104:107], v[120:123], a[200:203], a[104:107]
  v_accvgpr_read_b32 v23, a55
  v_cvt_pk_bf16_f32 v16, v16, v17
  v_cvt_pk_bf16_f32 v17, v18, v19
  v_cvt_pk_bf16_f32 v18, v20, v21
  v_cvt_pk_bf16_f32 v19, v22, v23
  buffer_store_dwordx4 v[16:19], v50, s[40:43], s62 offen offset:3072 sc1
  v_accvgpr_read_b32 v8, a40
  v_accvgpr_read_b32 v9, a41
  v_mfma_f32_16x16x32_bf16 a[108:111], v[120:123], a[204:207], a[108:111]
  v_accvgpr_read_b32 v10, a42
  v_accvgpr_read_b32 v11, a43
  v_accvgpr_read_b32 v12, a56
  v_accvgpr_read_b32 v13, a57
  v_accvgpr_read_b32 v14, a58
  v_accvgpr_read_b32 v15, a59
  v_cvt_pk_bf16_f32 v8, v8, v9
  v_cvt_pk_bf16_f32 v9, v10, v11
  v_mfma_f32_16x16x32_bf16 a[112:115], v[124:127], a[192:195], a[112:115]
  v_cvt_pk_bf16_f32 v10, v12, v13
  v_cvt_pk_bf16_f32 v11, v14, v15
  buffer_store_dwordx4 v[8:11], v50, s[40:43], s63 offen offset:1024 sc1
  v_accvgpr_read_b32 v16, a44
  v_accvgpr_read_b32 v17, a45
  v_accvgpr_read_b32 v18, a46
  v_accvgpr_read_b32 v19, a47
  v_accvgpr_read_b32 v20, a60
  v_mfma_f32_16x16x32_bf16 a[116:119], v[124:127], a[196:199], a[116:119]
  v_accvgpr_read_b32 v21, a61
  v_accvgpr_read_b32 v22, a62
  v_accvgpr_read_b32 v23, a63
  v_cvt_pk_bf16_f32 v16, v16, v17
  v_cvt_pk_bf16_f32 v17, v18, v19
  v_cvt_pk_bf16_f32 v18, v20, v21
  v_cvt_pk_bf16_f32 v19, v22, v23
  buffer_store_dwordx4 v[16:19], v50, s[40:43], s63 offen offset:3072 sc1
  v_mfma_f32_16x16x32_bf16 a[120:123], v[124:127], a[200:203], a[120:123]
  v_mfma_f32_16x16x32_bf16 a[124:127], v[124:127], a[204:207], a[124:127]
  s_waitcnt lgkmcnt(0)
  v_mfma_f32_16x16x32_bf16 v[64:67], a[176:179], v[128:131], 0
  ds_read_b64_tr_b16 a[192:193], v28 offset:4096
  v_accvgpr_read_b32 v8, a64
  v_accvgpr_read_b32 v9, a65
  v_accvgpr_read_b32 v10, a66
  v_accvgpr_read_b32 v11, a67
  v_accvgpr_read_b32 v12, a80
  v_accvgpr_read_b32 v13, a81
  v_accvgpr_read_b32 v14, a82
  v_mfma_f32_16x16x32_bf16 v[80:83], a[176:179], v[132:135], 0
  ds_read_b64_tr_b16 a[194:195], v28 offset:4608
  v_accvgpr_read_b32 v15, a83
  v_cvt_pk_bf16_f32 v8, v8, v9
  v_cvt_pk_bf16_f32 v9, v10, v11
  v_cvt_pk_bf16_f32 v10, v12, v13
  v_cvt_pk_bf16_f32 v11, v14, v15
  buffer_store_dwordx4 v[8:11], v50, s[40:43], s64 offen offset:0 sc1
  v_accvgpr_read_b32 v16, a68
  v_mfma_f32_16x16x32_bf16 v[96:99], a[176:179], v[136:139], 0
  ds_read_b64_tr_b16 a[196:197], v29 offset:4096
  v_accvgpr_read_b32 v17, a69
  v_accvgpr_read_b32 v18, a70
  v_accvgpr_read_b32 v19, a71
  v_accvgpr_read_b32 v20, a84
  v_accvgpr_read_b32 v21, a85
  v_accvgpr_read_b32 v22, a86
  v_accvgpr_read_b32 v23, a87
  v_mfma_f32_16x16x32_bf16 v[112:115], a[176:179], v[140:143], 0
  ds_read_b64_tr_b16 a[198:199], v29 offset:4608
  v_cvt_pk_bf16_f32 v16, v16, v17
  v_cvt_pk_bf16_f32 v17, v18, v19
  v_cvt_pk_bf16_f32 v18, v20, v21
  v_cvt_pk_bf16_f32 v19, v22, v23
  buffer_store_dwordx4 v[16:19], v50, s[40:43], s64 offen offset:2048 sc1
  v_accvgpr_read_b32 v8, a72
  v_accvgpr_read_b32 v9, a73
  v_mfma_f32_16x16x32_bf16 v[68:71], a[180:183], v[128:131], 0
  ds_read_b64_tr_b16 a[200:201], v30 offset:4096
  v_accvgpr_read_b32 v10, a74
  v_accvgpr_read_b32 v11, a75
  v_accvgpr_read_b32 v12, a88
  v_accvgpr_read_b32 v13, a89
  v_accvgpr_read_b32 v14, a90
  v_accvgpr_read_b32 v15, a91
  v_cvt_pk_bf16_f32 v8, v8, v9
  v_mfma_f32_16x16x32_bf16 v[84:87], a[180:183], v[132:135], 0
  ds_read_b64_tr_b16 a[202:203], v30 offset:4608
  v_cvt_pk_bf16_f32 v9, v10, v11
  v_cvt_pk_bf16_f32 v10, v12, v13
  v_cvt_pk_bf16_f32 v11, v14, v15
  buffer_store_dwordx4 v[8:11], v50, s[40:43], s65 offen offset:0 sc1
  v_accvgpr_read_b32 v16, a76
  v_accvgpr_read_b32 v17, a77
  v_accvgpr_read_b32 v18, a78
  v_mfma_f32_16x16x32_bf16 v[100:103], a[180:183], v[136:139], 0
  ds_read_b64_tr_b16 a[204:205], v31 offset:4096
  v_accvgpr_read_b32 v19, a79
  v_accvgpr_read_b32 v20, a92
  v_accvgpr_read_b32 v21, a93
  v_accvgpr_read_b32 v22, a94
  v_accvgpr_read_b32 v23, a95
  v_cvt_pk_bf16_f32 v16, v16, v17
  v_cvt_pk_bf16_f32 v17, v18, v19
  v_mfma_f32_16x16x32_bf16 v[116:119], a[180:183], v[140:143], 0
  ds_read_b64_tr_b16 a[206:207], v31 offset:4608
  v_cvt_pk_bf16_f32 v18, v20, v21
  v_cvt_pk_bf16_f32 v19, v22, v23
  buffer_store_dwordx4 v[16:19], v50, s[40:43], s65 offen offset:2048 sc1
  v_mfma_f32_16x16x32_bf16 v[72:75], a[184:187], v[128:131], 0
  v_mfma_f32_16x16x32_bf16 v[88:91], a[184:187], v[132:135], 0
  v_mfma_f32_16x16x32_bf16 v[104:107], a[184:187], v[136:139], 0
  v_mfma_f32_16x16x32_bf16 v[120:123], a[184:187], v[140:143], 0
  v_mfma_f32_16x16x32_bf16 v[76:79], a[188:191], v[128:131], 0
  v_mfma_f32_16x16x32_bf16 v[92:95], a[188:191], v[132:135], 0
  v_mfma_f32_16x16x32_bf16 v[108:111], a[188:191], v[136:139], 0
  v_mfma_f32_16x16x32_bf16 v[124:127], a[188:191], v[140:143], 0
  s_sub_u32 s3, s52, s69
  v_add_u32 v28, s3, v28
  v_add_u32 v29, s3, v29
  v_add_u32 v30, s3, v30
  v_add_u32 v31, s3, v31
  s_waitcnt vmcnt(32) lgkmcnt(0)
  v_mfma_f32_16x16x32_bf16 v[64:67], a[192:195], v[144:147], v[64:67]
  ds_read_b64_tr_b16 a[176:177], v28 offset:0
  v_accvgpr_read_b32 v8, a96
  v_accvgpr_read_b32 v9, a97
  v_accvgpr_read_b32 v10, a98
  v_accvgpr_read_b32 v11, a99
  v_accvgpr_read_b32 v12, a112
  v_accvgpr_read_b32 v13, a113
  v_accvgpr_read_b32 v14, a114
  v_mfma_f32_16x16x32_bf16 v[80:83], a[192:195], v[148:151], v[80:83]
  ds_read_b64_tr_b16 a[178:179], v28 offset:512
  v_accvgpr_read_b32 v15, a115
  v_cvt_pk_bf16_f32 v8, v8, v9
  v_cvt_pk_bf16_f32 v9, v10, v11
  v_cvt_pk_bf16_f32 v10, v12, v13
  v_cvt_pk_bf16_f32 v11, v14, v15
  buffer_store_dwordx4 v[8:11], v50, s[40:43], s64 offen offset:1024 sc1
  v_accvgpr_read_b32 v16, a100
  v_mfma_f32_16x16x32_bf16 v[96:99], a[192:195], v[152:155], v[96:99]
  ds_read_b64_tr_b16 a[180:181], v29 offset:0
  v_accvgpr_read_b32 v17, a101
  v_accvgpr_read_b32 v18, a102
  v_accvgpr_read_b32 v19, a103
  v_accvgpr_read_b32 v20, a116
  v_accvgpr_read_b32 v21, a117
  v_accvgpr_read_b32 v22, a118
  v_accvgpr_read_b32 v23, a119
  v_mfma_f32_16x16x32_bf16 v[112:115], a[192:195], v[156:159], v[112:115]
  ds_read_b64_tr_b16 a[182:183], v29 offset:512
  v_cvt_pk_bf16_f32 v16, v16, v17
  v_cvt_pk_bf16_f32 v17, v18, v19
  v_cvt_pk_bf16_f32 v18, v20, v21
  v_cvt_pk_bf16_f32 v19, v22, v23
  buffer_store_dwordx4 v[16:19], v50, s[40:43], s64 offen offset:3072 sc1
  v_accvgpr_read_b32 v8, a104
  v_accvgpr_read_b32 v9, a105
  v_mfma_f32_16x16x32_bf16 v[68:71], a[196:199], v[144:147], v[68:71]
  ds_read_b64_tr_b16 a[184:185], v30 offset:0
  v_accvgpr_read_b32 v10, a106
  v_accvgpr_read_b32 v11, a107
  v_accvgpr_read_b32 v12, a120
  v_accvgpr_read_b32 v13, a121
  v_accvgpr_read_b32 v14, a122
  v_accvgpr_read_b32 v15, a123
  v_cvt_pk_bf16_f32 v8, v8, v9
  v_mfma_f32_16x16x32_bf16 v[84:87], a[196:199], v[148:151], v[84:87]
  ds_read_b64_tr_b16 a[186:187], v30 offset:512
  v_cvt_pk_bf16_f32 v9, v10, v11
  v_cvt_pk_bf16_f32 v10, v12, v13
  v_cvt_pk_bf16_f32 v11, v14, v15
  buffer_store_dwordx4 v[8:11], v50, s[40:43], s65 offen offset:1024 sc1
  v_accvgpr_read_b32 v16, a108
  v_accvgpr_read_b32 v17, a109
  v_accvgpr_read_b32 v18, a110
  v_mfma_f32_16x16x32_bf16 v[100:103], a[196:199], v[152:155], v[100:103]
  ds_read_b64_tr_b16 a[188:189], v31 offset:0
  v_accvgpr_read_b32 v19, a111
  v_accvgpr_read_b32 v20, a124
  v_accvgpr_read_b32 v21, a125
  v_accvgpr_read_b32 v22, a126
  v_accvgpr_read_b32 v23, a127
  v_cvt_pk_bf16_f32 v16, v16, v17
  v_cvt_pk_bf16_f32 v17, v18, v19
  v_mfma_f32_16x16x32_bf16 v[116:119], a[196:199], v[156:159], v[116:119]
  ds_read_b64_tr_b16 a[190:191], v31 offset:512
  v_cvt_pk_bf16_f32 v18, v20, v21
  v_cvt_pk_bf16_f32 v19, v22, v23
  buffer_store_dwordx4 v[16:19], v50, s[40:43], s65 offen offset:3072 sc1
  v_mfma_f32_16x16x32_bf16 v[72:75], a[200:203], v[144:147], v[72:75]
  v_mfma_f32_16x16x32_bf16 v[88:91], a[200:203], v[148:151], v[88:91]
  v_mfma_f32_16x16x32_bf16 v[104:107], a[200:203], v[152:155], v[104:107]
  v_mfma_f32_16x16x32_bf16 v[120:123], a[200:203], v[156:159], v[120:123]
  v_mfma_f32_16x16x32_bf16 v[76:79], a[204:207], v[144:147], v[76:79]
  v_mfma_f32_16x16x32_bf16 v[92:95], a[204:207], v[148:151], v[92:95]
  v_mfma_f32_16x16x32_bf16 v[108:111], a[204:207], v[152:155], v[108:111]
  v_mfma_f32_16x16x32_bf16 v[124:127], a[204:207], v[156:159], v[124:127]
  s_waitcnt vmcnt(32) lgkmcnt(0)
  v_mfma_f32_16x16x32_bf16 v[64:67], a[176:179], v[160:163], v[64:67]
  ds_read_b64_tr_b16 a[192:193], v28 offset:4096
  v_mfma_f32_16x16x32_bf16 v[80:83], a[176:179], v[164:167], v[80:83]
  ds_read_b64_tr_b16 a[194:195], v28 offset:4608
  v_mfma_f32_16x16x32_bf16 v[96:99], a[176:179], v[168:171], v[96:99]
  ds_read_b64_tr_b16 a[196:197], v29 offset:4096
  v_mfma_f32_16x16x32_bf16 v[112:115], a[176:179], v[172:175], v[112:115]
  ds_read_b64_tr_b16 a[198:199], v29 offset:4608
  v_mfma_f32_16x16x32_bf16 v[68:71], a[180:183], v[160:163], v[68:71]
  ds_read_b64_tr_b16 a[200:201], v30 offset:4096
  v_mfma_f32_16x16x32_bf16 v[84:87], a[180:183], v[164:167], v[84:87]
  ds_read_b64_tr_b16 a[202:203], v30 offset:4608
  v_mfma_f32_16x16x32_bf16 v[100:103], a[180:183], v[168:171], v[100:103]
  ds_read_b64_tr_b16 a[204:205], v31 offset:4096
  v_mfma_f32_16x16x32_bf16 v[116:119], a[180:183], v[172:175], v[116:119]
  ds_read_b64_tr_b16 a[206:207], v31 offset:4608
  v_mfma_f32_16x16x32_bf16 v[72:75], a[184:187], v[160:163], v[72:75]
  v_mfma_f32_16x16x32_bf16 v[88:91], a[184:187], v[164:167], v[88:91]
  v_mfma_f32_16x16x32_bf16 v[104:107], a[184:187], v[168:171], v[104:107]
  v_mfma_f32_16x16x32_bf16 v[120:123], a[184:187], v[172:175], v[120:123]
  v_mfma_f32_16x16x32_bf16 v[76:79], a[188:191], v[160:163], v[76:79]
  v_mfma_f32_16x16x32_bf16 v[92:95], a[188:191], v[164:167], v[92:95]
  v_mfma_f32_16x16x32_bf16 v[108:111], a[188:191], v[168:171], v[108:111]
  v_mfma_f32_16x16x32_bf16 v[124:127], a[188:191], v[172:175], v[124:127]
  s_waitcnt vmcnt(24) lgkmcnt(0)
  v_mfma_f32_16x16x32_bf16 v[64:67], a[192:195], v[176:179], v[64:67]
  ds_read_b64_tr_b16 a[176:177], v28 offset:8192
  v_mfma_f32_16x16x32_bf16 v[80:83], a[192:195], v[180:183], v[80:83]
  ds_read_b64_tr_b16 a[178:179], v28 offset:8704
  v_mfma_f32_16x16x32_bf16 v[96:99], a[192:195], v[184:187], v[96:99]
  ds_read_b64_tr_b16 a[180:181], v29 offset:8192
  v_mfma_f32_16x16x32_bf16 v[112:115], a[192:195], v[188:191], v[112:115]
  ds_read_b64_tr_b16 a[182:183], v29 offset:8704
  v_mfma_f32_16x16x32_bf16 v[68:71], a[196:199], v[176:179], v[68:71]
  ds_read_b64_tr_b16 a[184:185], v30 offset:8192
  v_mfma_f32_16x16x32_bf16 v[84:87], a[196:199], v[180:183], v[84:87]
  ds_read_b64_tr_b16 a[186:187], v30 offset:8704
  v_mfma_f32_16x16x32_bf16 v[100:103], a[196:199], v[184:187], v[100:103]
  ds_read_b64_tr_b16 a[188:189], v31 offset:8192
  v_mfma_f32_16x16x32_bf16 v[116:119], a[196:199], v[188:191], v[116:119]
  ds_read_b64_tr_b16 a[190:191], v31 offset:8704
  v_mfma_f32_16x16x32_bf16 v[72:75], a[200:203], v[176:179], v[72:75]
  v_mfma_f32_16x16x32_bf16 v[88:91], a[200:203], v[180:183], v[88:91]
  v_mfma_f32_16x16x32_bf16 v[104:107], a[200:203], v[184:187], v[104:107]
  v_mfma_f32_16x16x32_bf16 v[120:123], a[200:203], v[188:191], v[120:123]
  v_mfma_f32_16x16x32_bf16 v[76:79], a[204:207], v[176:179], v[76:79]
  v_mfma_f32_16x16x32_bf16 v[92:95], a[204:207], v[180:183], v[92:95]
  v_mfma_f32_16x16x32_bf16 v[108:111], a[204:207], v[184:187], v[108:111]
  v_mfma_f32_16x16x32_bf16 v[124:127], a[204:207], v[188:191], v[124:127]
  s_waitcnt vmcnt(16) lgkmcnt(0)
  v_mfma_f32_16x16x32_bf16 v[64:67], a[176:179], v[224:227], v[64:67]
  ds_read_b64_tr_b16 a[192:193], v28 offset:12288
  v_mfma_f32_16x16x32_bf16 v[80:83], a[176:179], v[228:231], v[80:83]
  ds_read_b64_tr_b16 a[194:195], v28 offset:12800
  v_mfma_f32_16x16x32_bf16 v[96:99], a[176:179], v[232:235], v[96:99]
  ds_read_b64_tr_b16 a[196:197], v29 offset:12288
  v_and_b32 v3, 7, v1
  v_lshlrev_b32 v3, 2, v3
  v_mfma_f32_16x16x32_bf16 v[112:115], a[176:179], v[236:239], v[112:115]
  ds_read_b64_tr_b16 a[198:199], v29 offset:12800
  v_mfma_f32_16x16x32_bf16 v[68:71], a[180:183], v[224:227], v[68:71]
  ds_read_b64_tr_b16 a[200:201], v30 offset:12288
  v_mfma_f32_16x16x32_bf16 v[84:87], a[180:183], v[228:231], v[84:87]
  ds_read_b64_tr_b16 a[202:203], v30 offset:12800
  s_add_u32 s55, s68, 49152
  s_sub_u32 s3, s55, 57344
  s_min_u32 s55, s55, s3
  buffer_load_dwordx4 v[240:243], v46, s[84:87], s55 offen offset:2048 sc1
  v_mfma_f32_16x16x32_bf16 v[100:103], a[180:183], v[232:235], v[100:103]
  ds_read_b64_tr_b16 a[204:205], v31 offset:12288
  s_lshr_b32 s61, s7, 1
  s_lshl2_add_u32 s61, s5, s61
  s_lshl_b32 s61, s61, 7
  v_mfma_f32_16x16x32_bf16 v[116:119], a[180:183], v[236:239], v[116:119]
  ds_read_b64_tr_b16 a[206:207], v31 offset:12800
  v_mfma_f32_16x16x32_bf16 v[72:75], a[184:187], v[224:227], v[72:75]
  s_add_u32 m0, s53, 8192
  s_add_u32 s54, s59, 262144
  s_sub_u32 s3, s54, 458752
  s_min_u32 s54, s54, s3
  v_mfma_f32_16x16x32_bf16 v[88:91], a[184:187], v[228:231], v[88:91]
  buffer_load_dwordx4 v38, s[36:39], s54 offen offset:0 lds
  v_mfma_f32_16x16x32_bf16 v[104:107], a[184:187], v[232:235], v[104:107]
  buffer_load_dwordx4 v[244:247], v46, s[84:87], s55 offen offset:3072 sc1
  v_mfma_f32_16x16x32_bf16 v[120:123], a[184:187], v[236:239], v[120:123]
  buffer_load_dwordx4 v39, s[36:39], s54 offen offset:1024 lds
  v_mfma_f32_16x16x32_bf16 v[76:79], a[188:191], v[224:227], v[76:79]
  v_mfma_f32_16x16x32_bf16 v[92:95], a[188:191], v[228:231], v[92:95]
  buffer_load_dwordx4 v40, s[36:39], s54 offen offset:2048 lds
  s_waitcnt vmcnt(5)
  v_mov_b32 v2, 1
  buffer_store_dword v2, v55, s[76:79], s70 offen sc1
  v_mfma_f32_16x16x32_bf16 v[108:111], a[188:191], v[232:235], v[108:111]
  v_mfma_f32_16x16x32_bf16 v[124:127], a[188:191], v[236:239], v[124:127]
  buffer_load_dwordx4 v41, s[36:39], s54 offen offset:3072 lds
  s_sub_u32 s3, s53, s52
  v_add_u32 v28, s3, v28
  v_add_u32 v29, s3, v29
  v_add_u32 v30, s3, v30
  v_add_u32 v31, s3, v31
  s_waitcnt lgkmcnt(0)
  v_mfma_f32_16x16x32_bf16 v[64:67], a[192:195], v[192:195], v[64:67]
  ds_read_b64_tr_b16 a[176:177], v28 offset:0
  v_mfma_f32_16x16x32_bf16 v[80:83], a[192:195], v[196:199], v[80:83]
  ds_read_b64_tr_b16 a[178:179], v28 offset:512
  v_mfma_f32_16x16x32_bf16 v[96:99], a[192:195], v[200:203], v[96:99]
  ds_read_b64_tr_b16 a[180:181], v29 offset:0
  v_mfma_f32_16x16x32_bf16 v[112:115], a[192:195], v[204:207], v[112:115]
  ds_read_b64_tr_b16 a[182:183], v29 offset:512
  v_mfma_f32_16x16x32_bf16 v[68:71], a[196:199], v[192:195], v[68:71]
  ds_read_b64_tr_b16 a[184:185], v30 offset:0
  v_mfma_f32_16x16x32_bf16 v[84:87], a[196:199], v[196:199], v[84:87]
  ds_read_b64_tr_b16 a[186:187], v30 offset:512
  s_add_u32 s55, s68, 53248
  s_sub_u32 s3, s55, 57344
  s_min_u32 s55, s55, s3
  buffer_load_dwordx4 v[248:251], v46, s[84:87], s55 offen offset:0 sc1
  v_mfma_f32_16x16x32_bf16 v[100:103], a[196:199], v[200:203], v[100:103]
  ds_read_b64_tr_b16 a[188:189], v31 offset:0
  v_mfma_f32_16x16x32_bf16 v[116:119], a[196:199], v[204:207], v[116:119]
  ds_read_b64_tr_b16 a[190:191], v31 offset:512
  v_mfma_f32_16x16x32_bf16 v[72:75], a[200:203], v[192:195], v[72:75]
  s_add_u32 m0, s53, 12288
  s_add_u32 s54, s59, 294912
  s_sub_u32 s3, s54, 458752
  s_min_u32 s54, s54, s3
  v_mfma_f32_16x16x32_bf16 v[88:91], a[200:203], v[196:199], v[88:91]
  buffer_load_dwordx4 v38, s[36:39], s54 offen offset:0 lds
  v_mfma_f32_16x16x32_bf16 v[104:107], a[200:203], v[200:203], v[104:107]
  buffer_load_dwordx4 v[252:255], v46, s[84:87], s55 offen offset:1024 sc1
  v_mfma_f32_16x16x32_bf16 v[120:123], a[200:203], v[204:207], v[120:123]
  buffer_load_dwordx4 v39, s[36:39], s54 offen offset:1024 lds
  v_mfma_f32_16x16x32_bf16 v[76:79], a[204:207], v[192:195], v[76:79]
  v_mfma_f32_16x16x32_bf16 v[92:95], a[204:207], v[196:199], v[92:95]
  buffer_load_dwordx4 v40, s[36:39], s54 offen offset:2048 lds
  v_mfma_f32_16x16x32_bf16 v[108:111], a[204:207], v[200:203], v[108:111]
  v_mfma_f32_16x16x32_bf16 v[124:127], a[204:207], v[204:207], v[124:127]
  buffer_load_dwordx4 v41, s[36:39], s54 offen offset:3072 lds
  s_waitcnt lgkmcnt(0)
  v_mfma_f32_16x16x32_bf16 v[64:67], a[176:179], v[208:211], v[64:67]
  ds_read_b64_tr_b16 a[192:193], v28 offset:4096
  v_mfma_f32_16x16x32_bf16 v[80:83], a[176:179], v[212:215], v[80:83]
  ds_read_b64_tr_b16 a[194:195], v28 offset:4608
  v_mfma_f32_16x16x32_bf16 v[96:99], a[176:179], v[216:219], v[96:99]
  ds_read_b64_tr_b16 a[196:197], v29 offset:4096
  v_mfma_f32_16x16x32_bf16 v[112:115], a[176:179], v[220:223], v[112:115]
  ds_read_b64_tr_b16 a[198:199], v29 offset:4608
  v_mfma_f32_16x16x32_bf16 v[68:71], a[180:183], v[208:211], v[68:71]
  ds_read_b64_tr_b16 a[200:201], v30 offset:4096
  v_mfma_f32_16x16x32_bf16 v[84:87], a[180:183], v[212:215], v[84:87]
  ds_read_b64_tr_b16 a[202:203], v30 offset:4608
  buffer_load_dwordx4 v[128:131], v46, s[84:87], s55 offen offset:2048 sc1
  v_mfma_f32_16x16x32_bf16 v[100:103], a[180:183], v[216:219], v[100:103]
  ds_read_b64_tr_b16 a[204:205], v31 offset:4096
  v_mfma_f32_16x16x32_bf16 v[116:119], a[180:183], v[220:223], v[116:119]
  ds_read_b64_tr_b16 a[206:207], v31 offset:4608
  v_mfma_f32_16x16x32_bf16 v[72:75], a[184:187], v[208:211], v[72:75]
  s_add_u32 m0, s69, 0
  s_add_u32 s54, s59, 327680
  s_sub_u32 s3, s54, 458752
  s_min_u32 s54, s54, s3
  v_mfma_f32_16x16x32_bf16 v[88:91], a[184:187], v[212:215], v[88:91]
  buffer_load_dwordx4 v38, s[36:39], s54 offen offset:0 lds
  v_mfma_f32_16x16x32_bf16 v[104:107], a[184:187], v[216:219], v[104:107]
  buffer_load_dwordx4 v[132:135], v46, s[84:87], s55 offen offset:3072 sc1
  v_mfma_f32_16x16x32_bf16 v[120:123], a[184:187], v[220:223], v[120:123]
  buffer_load_dwordx4 v39, s[36:39], s54 offen offset:1024 lds
  v_mfma_f32_16x16x32_bf16 v[76:79], a[188:191], v[208:211], v[76:79]
  v_mfma_f32_16x16x32_bf16 v[92:95], a[188:191], v[212:215], v[92:95]
  buffer_load_dwordx4 v40, s[36:39], s54 offen offset:2048 lds
  v_mfma_f32_16x16x32_bf16 v[108:111], a[188:191], v[216:219], v[108:111]
  v_mfma_f32_16x16x32_bf16 v[124:127], a[188:191], v[220:223], v[124:127]
  buffer_load_dwordx4 v41, s[36:39], s54 offen offset:3072 lds
  s_waitcnt vmcnt(12) lgkmcnt(0)
  v_mfma_f32_16x16x32_bf16 v[64:67], a[192:195], a[128:131], v[64:67]
  ds_read_b64_tr_b16 a[176:177], v28 offset:8192
  v_mfma_f32_16x16x32_bf16 v[80:83], a[192:195], a[132:135], v[80:83]
  ds_read_b64_tr_b16 a[178:179], v28 offset:8704
  v_mfma_f32_16x16x32_bf16 v[96:99], a[192:195], a[136:139], v[96:99]
  ds_read_b64_tr_b16 a[180:181], v29 offset:8192
  v_mfma_f32_16x16x32_bf16 v[112:115], a[192:195], a[140:143], v[112:115]
  ds_read_b64_tr_b16 a[182:183], v29 offset:8704
  v_mfma_f32_16x16x32_bf16 v[68:71], a[196:199], a[128:131], v[68:71]
  ds_read_b64_tr_b16 a[184:185], v30 offset:8192
  v_mfma_f32_16x16x32_bf16 v[84:87], a[196:199], a[132:135], v[84:87]
  ds_read_b64_tr_b16 a[186:187], v30 offset:8704
  v_mfma_f32_16x16x32_bf16 v[100:103], a[196:199], a[136:139], v[100:103]
  ds_read_b64_tr_b16 a[188:189], v31 offset:8192
  v_mfma_f32_16x16x32_bf16 v[116:119], a[196:199], a[140:143], v[116:119]
  ds_read_b64_tr_b16 a[190:191], v31 offset:8704
  v_mfma_f32_16x16x32_bf16 v[72:75], a[200:203], a[128:131], v[72:75]
  s_add_u32 m0, s69, 4096
  s_add_u32 s54, s59, 360448
  s_sub_u32 s3, s54, 458752
  s_min_u32 s54, s54, s3
  v_mfma_f32_16x16x32_bf16 v[88:91], a[200:203], a[132:135], v[88:91]
  buffer_load_dwordx4 v38, s[36:39], s54 offen offset:0 lds
  v_mfma_f32_16x16x32_bf16 v[104:107], a[200:203], a[136:139], v[104:107]
  v_mfma_f32_16x16x32_bf16 v[120:123], a[200:203], a[140:143], v[120:123]
  buffer_load_dwordx4 v39, s[36:39], s54 offen offset:1024 lds
  v_mfma_f32_16x16x32_bf16 v[76:79], a[204:207], a[128:131], v[76:79]
  v_mfma_f32_16x16x32_bf16 v[92:95], a[204:207], a[132:135], v[92:95]
  buffer_load_dwordx4 v40, s[36:39], s54 offen offset:2048 lds
  v_mfma_f32_16x16x32_bf16 v[108:111], a[204:207], a[136:139], v[108:111]
  v_mfma_f32_16x16x32_bf16 v[124:127], a[204:207], a[140:143], v[124:127]
  buffer_load_dwordx4 v41, s[36:39], s54 offen offset:3072 lds
  s_waitcnt vmcnt(10) lgkmcnt(0)
  v_mfma_f32_16x16x32_bf16 v[64:67], a[176:179], a[144:147], v[64:67]
  ds_read_b64_tr_b16 a[192:193], v28 offset:12288
  v_mfma_f32_16x16x32_bf16 v[80:83], a[176:179], a[148:151], v[80:83]
  ds_read_b64_tr_b16 a[194:195], v28 offset:12800
  v_mfma_f32_16x16x32_bf16 v[96:99], a[176:179], a[152:155], v[96:99]
  ds_read_b64_tr_b16 a[196:197], v29 offset:12288
  v_mfma_f32_16x16x32_bf16 v[112:115], a[176:179], a[156:159], v[112:115]
  ds_read_b64_tr_b16 a[198:199], v29 offset:12800
  v_mfma_f32_16x16x32_bf16 v[68:71], a[180:183], a[144:147], v[68:71]
  ds_read_b64_tr_b16 a[200:201], v30 offset:12288
  v_mfma_f32_16x16x32_bf16 v[84:87], a[180:183], a[148:151], v[84:87]
  ds_read_b64_tr_b16 a[202:203], v30 offset:12800
  v_mfma_f32_16x16x32_bf16 v[100:103], a[180:183], a[152:155], v[100:103]
  ds_read_b64_tr_b16 a[204:205], v31 offset:12288
  v_mfma_f32_16x16x32_bf16 v[116:119], a[180:183], a[156:159], v[116:119]
  ds_read_b64_tr_b16 a[206:207], v31 offset:12800
  v_mfma_f32_16x16x32_bf16 v[72:75], a[184:187], a[144:147], v[72:75]
  s_add_u32 m0, s52, 0
  s_add_u32 s54, s59, 393216
  s_sub_u32 s3, s54, 458752
  s_min_u32 s54, s54, s3
  v_mfma_f32_16x16x32_bf16 v[88:91], a[184:187], a[148:151], v[88:91]
  buffer_load_dwordx4 v38, s[36:39], s54 offen offset:0 lds
  v_mfma_f32_16x16x32_bf16 v[104:107], a[184:187], a[152:155], v[104:107]
  v_mfma_f32_16x16x32_bf16 v[120:123], a[184:187], a[156:159], v[120:123]
  buffer_load_dwordx4 v39, s[36:39], s54 offen offset:1024 lds
  v_mfma_f32_16x16x32_bf16 v[76:79], a[188:191], a[144:147], v[76:79]
  v_mfma_f32_16x16x32_bf16 v[92:95], a[188:191], a[148:151], v[92:95]
  buffer_load_dwordx4 v40, s[36:39], s54 offen offset:2048 lds
  v_mfma_f32_16x16x32_bf16 v[108:111], a[188:191], a[152:155], v[108:111]
  v_mfma_f32_16x16x32_bf16 v[124:127], a[188:191], a[156:159], v[124:127]
  buffer_load_dwordx4 v41, s[36:39], s54 offen offset:3072 lds
  s_sub_u32 s3, s69, s53
  v_add_u32 v28, s3, v28
  v_add_u32 v29, s3, v29
  v_add_u32 v30, s3, v30
  v_add_u32 v31, s3, v31
  s_waitcnt vmcnt(8) lgkmcnt(0)
  v_mfma_f32_16x16x32_bf16 v[64:67], a[192:195], a[160:163], v[64:67]
  ds_read_b64_tr_b16 a[176:177], v28 offset:0
  v_mfma_f32_16x16x32_bf16 v[80:83], a[192:195], a[164:167], v[80:83]
  ds_read_b64_tr_b16 a[178:179], v28 offset:512
  v_mfma_f32_16x16x32_bf16 v[96:99], a[192:195], a[168:171], v[96:99]
  ds_read_b64_tr_b16 a[180:181], v29 offset:0
  v_mfma_f32_16x16x32_bf16 v[112:115], a[192:195], a[172:175], v[112:115]
  ds_read_b64_tr_b16 a[182:183], v29 offset:512
  v_mfma_f32_16x16x32_bf16 v[68:71], a[196:199], a[160:163], v[68:71]
  ds_read_b64_tr_b16 a[184:185], v30 offset:0
  v_mfma_f32_16x16x32_bf16 v[84:87], a[196:199], a[164:167], v[84:87]
  ds_read_b64_tr_b16 a[186:187], v30 offset:512
  v_mfma_f32_16x16x32_bf16 v[100:103], a[196:199], a[168:171], v[100:103]
  ds_read_b64_tr_b16 a[188:189], v31 offset:0
  v_mfma_f32_16x16x32_bf16 v[116:119], a[196:199], a[172:175], v[116:119]
  ds_read_b64_tr_b16 a[190:191], v31 offset:512
  v_mfma_f32_16x16x32_bf16 v[72:75], a[200:203], a[160:163], v[72:75]
  s_add_u32 m0, s52, 4096
  s_add_u32 s54, s59, 425984
  s_sub_u32 s3, s54, 458752
  s_min_u32 s54, s54, s3
  v_mfma_f32_16x16x32_bf16 v[88:91], a[200:203], a[164:167], v[88:91]
  buffer_load_dwordx4 v38, s[36:39], s54 offen offset:0 lds
  v_mfma_f32_16x16x32_bf16 v[104:107], a[200:203], a[168:171], v[104:107]
  v_mfma_f32_16x16x32_bf16 v[120:123], a[200:203], a[172:175], v[120:123]
  buffer_load_dwordx4 v39, s[36:39], s54 offen offset:1024 lds
  v_mfma_f32_16x16x32_bf16 v[76:79], a[204:207], a[160:163], v[76:79]
  v_mfma_f32_16x16x32_bf16 v[92:95], a[204:207], a[164:167], v[92:95]
  buffer_load_dwordx4 v40, s[36:39], s54 offen offset:2048 lds
  v_mfma_f32_16x16x32_bf16 v[108:111], a[204:207], a[168:171], v[108:111]
  v_mfma_f32_16x16x32_bf16 v[124:127], a[204:207], a[172:175], v[124:127]
  buffer_load_dwordx4 v41, s[36:39], s54 offen offset:3072 lds
  s_waitcnt vmcnt(8) lgkmcnt(0)
  v_mfma_f32_16x16x32_bf16 v[64:67], a[176:179], a[240:243], v[64:67]
  ds_read_b64_tr_b16 a[192:193], v28 offset:4096
  v_mfma_f32_16x16x32_bf16 v[80:83], a[176:179], a[244:247], v[80:83]
  ds_read_b64_tr_b16 a[194:195], v28 offset:4608
  v_mfma_f32_16x16x32_bf16 v[96:99], a[176:179], a[208:211], v[96:99]
  ds_read_b64_tr_b16 a[196:197], v29 offset:4096
  v_mfma_f32_16x16x32_bf16 v[112:115], a[176:179], a[212:215], v[112:115]
  ds_read_b64_tr_b16 a[198:199], v29 offset:4608
  v_mfma_f32_16x16x32_bf16 v[68:71], a[180:183], a[240:243], v[68:71]
  ds_read_b64_tr_b16 a[200:201], v30 offset:4096
  v_mfma_f32_16x16x32_bf16 v[84:87], a[180:183], a[244:247], v[84:87]
  ds_read_b64_tr_b16 a[202:203], v30 offset:4608
  v_mfma_f32_16x16x32_bf16 v[100:103], a[180:183], a[208:211], v[100:103]
  ds_read_b64_tr_b16 a[204:205], v31 offset:4096
  v_mfma_f32_16x16x32_bf16 v[116:119], a[180:183], a[212:215], v[116:119]
  ds_read_b64_tr_b16 a[206:207], v31 offset:4608
  v_mfma_f32_16x16x32_bf16 v[72:75], a[184:187], a[240:243], v[72:75]
  v_mfma_f32_16x16x32_bf16 v[88:91], a[184:187], a[244:247], v[88:91]
  v_mfma_f32_16x16x32_bf16 v[104:107], a[184:187], a[208:211], v[104:107]
  v_mfma_f32_16x16x32_bf16 v[120:123], a[184:187], a[212:215], v[120:123]
  v_mfma_f32_16x16x32_bf16 v[76:79], a[188:191], a[240:243], v[76:79]
  v_mfma_f32_16x16x32_bf16 v[92:95], a[188:191], a[244:247], v[92:95]
  v_mfma_f32_16x16x32_bf16 v[108:111], a[188:191], a[208:211], v[108:111]
  v_mfma_f32_16x16x32_bf16 v[124:127], a[188:191], a[212:215], v[124:127]
  s_sub_u32 s3, s52, s69
  v_add_u32 v28, s3, v28
  v_add_u32 v29, s3, v29
  v_add_u32 v30, s3, v30
  v_add_u32 v31, s3, v31
  s_waitcnt vmcnt(4) lgkmcnt(0)
  v_mfma_f32_16x16x32_bf16 v[64:67], a[192:195], a[216:219], v[64:67]
  ds_read_b64_tr_b16 a[176:177], v28 offset:0
  v_mfma_f32_16x16x32_bf16 v[80:83], a[192:195], a[220:223], v[80:83]
  ds_read_b64_tr_b16 a[178:179], v28 offset:512
  v_mfma_f32_16x16x32_bf16 v[96:99], a[192:195], a[224:227], v[96:99]
  ds_read_b64_tr_b16 a[180:181], v29 offset:0
  v_mfma_f32_16x16x32_bf16 v[112:115], a[192:195], a[228:231], v[112:115]
  ds_read_b64_tr_b16 a[182:183], v29 offset:512
  v_mfma_f32_16x16x32_bf16 v[68:71], a[196:199], a[216:219], v[68:71]
  ds_read_b64_tr_b16 a[184:185], v30 offset:0
  v_mfma_f32_16x16x32_bf16 v[84:87], a[196:199], a[220:223], v[84:87]
  ds_read_b64_tr_b16 a[186:187], v30 offset:512
  v_mfma_f32_16x16x32_bf16 v[100:103], a[196:199], a[224:227], v[100:103]
  ds_read_b64_tr_b16 a[188:189], v31 offset:0
  v_mfma_f32_16x16x32_bf16 v[116:119], a[196:199], a[228:231], v[116:119]
  ds_read_b64_tr_b16 a[190:191], v31 offset:512
  v_mfma_f32_16x16x32_bf16 v[72:75], a[200:203], a[216:219], v[72:75]
  v_mfma_f32_16x16x32_bf16 v[88:91], a[200:203], a[220:223], v[88:91]
  v_mfma_f32_16x16x32_bf16 v[104:107], a[200:203], a[224:227], v[104:107]
  v_mfma_f32_16x16x32_bf16 v[120:123], a[200:203], a[228:231], v[120:123]
  v_mfma_f32_16x16x32_bf16 v[76:79], a[204:207], a[216:219], v[76:79]
  v_mfma_f32_16x16x32_bf16 v[92:95], a[204:207], a[220:223], v[92:95]
  v_mfma_f32_16x16x32_bf16 v[108:111], a[204:207], a[224:227], v[108:111]
  v_mfma_f32_16x16x32_bf16 v[124:127], a[204:207], a[228:231], v[124:127]
  s_waitcnt vmcnt(0) lgkmcnt(0)
  v_mfma_f32_16x16x32_bf16 v[64:67], a[176:179], a[232:235], v[64:67]
  ds_read_b64_tr_b16 a[192:193], v28 offset:4096
  v_mfma_f32_16x16x32_bf16 v[80:83], a[176:179], a[236:239], v[80:83]
  ds_read_b64_tr_b16 a[194:195], v28 offset:4608
  v_mfma_f32_16x16x32_bf16 v[96:99], a[176:179], v[240:243], v[96:99]
  ds_read_b64_tr_b16 a[196:197], v29 offset:4096
  v_mfma_f32_16x16x32_bf16 v[112:115], a[176:179], v[244:247], v[112:115]
  ds_read_b64_tr_b16 a[198:199], v29 offset:4608
  v_mfma_f32_16x16x32_bf16 v[68:71], a[180:183], a[232:235], v[68:71]
  ds_read_b64_tr_b16 a[200:201], v30 offset:4096
  v_mfma_f32_16x16x32_bf16 v[84:87], a[180:183], a[236:239], v[84:87]
  ds_read_b64_tr_b16 a[202:203], v30 offset:4608
  v_mfma_f32_16x16x32_bf16 v[100:103], a[180:183], v[240:243], v[100:103]
  ds_read_b64_tr_b16 a[204:205], v31 offset:4096
  v_mfma_f32_16x16x32_bf16 v[116:119], a[180:183], v[244:247], v[116:119]
  ds_read_b64_tr_b16 a[206:207], v31 offset:4608
  v_mfma_f32_16x16x32_bf16 v[72:75], a[184:187], a[232:235], v[72:75]
  v_mfma_f32_16x16x32_bf16 v[88:91], a[184:187], a[236:239], v[88:91]
  v_mfma_f32_16x16x32_bf16 v[104:107], a[184:187], v[240:243], v[104:107]
  v_mfma_f32_16x16x32_bf16 v[120:123], a[184:187], v[244:247], v[120:123]
  v_mfma_f32_16x16x32_bf16 v[76:79], a[188:191], a[232:235], v[76:79]
  v_mfma_f32_16x16x32_bf16 v[92:95], a[188:191], a[236:239], v[92:95]
  v_mfma_f32_16x16x32_bf16 v[108:111], a[188:191], v[240:243], v[108:111]
  v_mfma_f32_16x16x32_bf16 v[124:127], a[188:191], v[244:247], v[124:127]
  buffer_load_dword v4, v3, s[76:79], s61 offen sc1
  s_waitcnt lgkmcnt(0)
  v_mfma_f32_16x16x32_bf16 v[64:67], a[192:195], v[248:251], v[64:67]
  v_mfma_f32_16x16x32_bf16 v[80:83], a[192:195], v[252:255], v[80:83]
  v_mfma_f32_16x16x32_bf16 v[96:99], a[192:195], v[128:131], v[96:99]
  v_mfma_f32_16x16x32_bf16 v[112:115], a[192:195], v[132:135], v[112:115]
  v_mfma_f32_16x16x32_bf16 v[68:71], a[196:199], v[248:251], v[68:71]
  v_mfma_f32_16x16x32_bf16 v[84:87], a[196:199], v[252:255], v[84:87]
  v_mfma_f32_16x16x32_bf16 v[100:103], a[196:199], v[128:131], v[100:103]
  v_mfma_f32_16x16x32_bf16 v[116:119], a[196:199], v[132:135], v[116:119]
  v_mfma_f32_16x16x32_bf16 v[72:75], a[200:203], v[248:251], v[72:75]
  v_mfma_f32_16x16x32_bf16 v[88:91], a[200:203], v[252:255], v[88:91]
  v_mfma_f32_16x16x32_bf16 v[104:107], a[200:203], v[128:131], v[104:107]
  v_mfma_f32_16x16x32_bf16 v[120:123], a[200:203], v[132:135], v[120:123]
  v_mfma_f32_16x16x32_bf16 v[76:79], a[204:207], v[248:251], v[76:79]
  v_mfma_f32_16x16x32_bf16 v[92:95], a[204:207], v[252:255], v[92:95]
  v_mfma_f32_16x16x32_bf16 v[108:111], a[204:207], v[128:131], v[108:111]
  v_mfma_f32_16x16x32_bf16 v[124:127], a[204:207], v[132:135], v[124:127]
  v_lshlrev_b32 v36, 4, v1
  v_add_u32 v52, s52, v36
  s_lshl_b32 s3, s4, 12
  s_add_u32 s3, s3, 98304
  v_add_u32 v53, s3, v36
  v_accvgpr_read_b32 v240, a248
  v_accvgpr_read_b32 v241, a249
  v_accvgpr_read_b32 v242, a250
  v_accvgpr_read_b32 v243, a251
  v_accvgpr_read_b32 v244, a252
  v_accvgpr_read_b32 v245, a253
  v_accvgpr_read_b32 v246, a254
  v_accvgpr_read_b32 v247, a255
  s_waitcnt vmcnt(0)
  v_cmp_ne_u32 vcc, 1, v4
  s_mov_b32 s95, 0
  s_nop 2
  s_cbranch_vccnz Lnotyet
  ds_write_b128 v52, v[64:67] offset:0
  s_add_u32 s55, s92, 0
  buffer_load_dwordx4 v[152:155], v46, s[40:43], s55 offen offset:0 sc1
  ds_write_b128 v52, v[68:71] offset:1024
  buffer_load_dwordx4 v[156:159], v46, s[40:43], s55 offen offset:1024 sc1
  ds_write_b128 v52, v[72:75] offset:2048
  s_add_u32 s55, s92, 8192
  buffer_load_dwordx4 v[160:163], v46, s[40:43], s55 offen offset:0 sc1
  ds_write_b128 v52, v[76:79] offset:3072
  buffer_load_dwordx4 v[164:167], v46, s[40:43], s55 offen offset:1024 sc1
  ds_write_b128 v52, v[80:83] offset:4096
  s_add_u32 s55, s92, 16384
  buffer_load_dwordx4 v[168:171], v46, s[40:43], s55 offen offset:0 sc1
  ds_write_b128 v52, v[84:87] offset:5120
  buffer_load_dwordx4 v[172:175], v46, s[40:43], s55 offen offset:1024 sc1
  ds_write_b128 v52, v[88:91] offset:6144
  s_add_u32 s55, s92, 24576
  buffer_load_dwordx4 v[176:179], v46, s[40:43], s55 offen offset:0 sc1
  ds_write_b128 v52, v[92:95] offset:7168
  buffer_load_dwordx4 v[180:183], v46, s[40:43], s55 offen offset:1024 sc1
  ds_write_b128 v52, v[96:99] offset:8192
  s_add_u32 s55, s92, 32768
  buffer_load_dwordx4 v[184:187], v46, s[40:43], s55 offen offset:0 sc1
  ds_write_b128 v52, v[100:103] offset:9216
  buffer_load_dwordx4 v[188:191], v46, s[40:43], s55 offen offset:1024 sc1
  ds_write_b128 v52, v[104:107] offset:10240
  s_add_u32 s55, s92, 40960
  buffer_load_dwordx4 v[192:195], v46, s[40:43], s55 offen offset:0 sc1
  ds_write_b128 v52, v[108:111] offset:11264
  buffer_load_dwordx4 v[196:199], v46, s[40:43], s55 offen offset:1024 sc1
  ds_write_b128 v52, v[112:115] offset:12288
  s_add_u32 s55, s92, 49152
  buffer_load_dwordx4 v[200:203], v46, s[40:43], s55 offen offset:0 sc1
  ds_write_b128 v52, v[116:119] offset:13312
  buffer_load_dwordx4 v[204:207], v46, s[40:43], s55 offen offset:1024 sc1
  ds_write_b128 v52, v[120:123] offset:14336
  s_add_u32 s55, s92, 57344
  buffer_load_dwordx4 v[208:211], v46, s[40:43], s55 offen offset:0 sc1
  ds_write_b128 v52, v[124:127] offset:15360
  buffer_load_dwordx4 v[212:215], v46, s[40:43], s55 offen offset:1024 sc1
  s_mov_b32 s95, 1
  s_branch Lwritten
Lnotyet:
  ds_write_b128 v52, v[64:67] offset:0
  ds_write_b128 v52, v[68:71] offset:1024
  ds_write_b128 v52, v[72:75] offset:2048
  ds_write_b128 v52, v[76:79] offset:3072
  ds_write_b128 v52, v[80:83] offset:4096
  ds_write_b128 v52, v[84:87] offset:5120
  ds_write_b128 v52, v[88:91] offset:6144
  ds_write_b128 v52, v[92:95] offset:7168
  ds_write_b128 v52, v[96:99] offset:8192
  ds_write_b128 v52, v[100:103] offset:9216
  ds_write_b128 v52, v[104:107] offset:10240
  ds_write_b128 v52, v[108:111] offset:11264
  ds_write_b128 v52, v[112:115] offset:12288
  ds_write_b128 v52, v[116:119] offset:13312
  ds_write_b128 v52, v[120:123] offset:14336
  ds_write_b128 v52, v[124:127] offset:15360
Lwritten:
  v_lshlrev_b32 v216, 16, v240
  v_and_b32 v217, 0xffff0000, v240
  v_lshlrev_b32 v218, 16, v241
  v_and_b32 v219, 0xffff0000, v241
  v_lshlrev_b32 v220, 16, v242
  v_and_b32 v221, 0xffff0000, v242
  v_lshlrev_b32 v222, 16, v243
  v_and_b32 v223, 0xffff0000, v243
  v_lshlrev_b32 v224, 16, v244
  v_and_b32 v225, 0xffff0000, v244
  v_lshlrev_b32 v226, 16, v245
  v_and_b32 v227, 0xffff0000, v245
  v_lshlrev_b32 v228, 16, v246
  v_and_b32 v229, 0xffff0000, v246
  v_lshlrev_b32 v230, 16, v247
  v_and_b32 v231, 0xffff0000, v247
  s_waitcnt lgkmcnt(0)
  s_barrier
  ds_read_b128 v[64:67], v53 offset:0
  ds_read_b128 v[68:71], v53 offset:1024
  ds_read_b128 v[72:75], v53 offset:2048
  ds_read_b128 v[76:79], v53 offset:3072
  ds_read_b128 v[80:83], v53 offset:16384
  ds_read_b128 v[84:87], v53 offset:17408
  ds_read_b128 v[88:91], v53 offset:18432
  ds_read_b128 v[92:95], v53 offset:19456
  ds_read_b128 v[96:99], v53 offset:32768
  ds_read_b128 v[100:103], v53 offset:33792
  ds_read_b128 v[104:107], v53 offset:34816
  ds_read_b128 v[108:111], v53 offset:35840
  ds_read_b128 v[112:115], v53 offset:49152
  ds_read_b128 v[116:119], v53 offset:50176
  ds_read_b128 v[120:123], v53 offset:51200
  ds_read_b128 v[124:127], v53 offset:52224
  s_mov_b32 s3, 0
  s_cmp_eq_u32 s95, 1
  s_cbranch_scc1 Lhave
Lpoll:
  buffer_load_dword v4, v3, s[76:79], s61 offen sc1
  s_waitcnt vmcnt(0)
  v_cmp_ne_u32 vcc, 1, v4
  s_add_u32 s3, s3, 1
  s_nop 2
  s_cbranch_vccz Lready
  s_sleep 1
  s_cmp_lt_u32 s3, 1048576
  s_cbranch_scc1 Lpoll
Lready:
  s_add_u32 s55, s92, 0
  buffer_load_dwordx4 v[152:155], v46, s[40:43], s55 offen offset:0 sc1
  buffer_load_dwordx4 v[156:159], v46, s[40:43], s55 offen offset:1024 sc1
  s_add_u32 s55, s92, 8192
  buffer_load_dwordx4 v[160:163], v46, s[40:43], s55 offen offset:0 sc1
  buffer_load_dwordx4 v[164:167], v46, s[40:43], s55 offen offset:1024 sc1
  s_add_u32 s55, s92, 16384
  buffer_load_dwordx4 v[168:171], v46, s[40:43], s55 offen offset:0 sc1
  buffer_load_dwordx4 v[172:175], v46, s[40:43], s55 offen offset:1024 sc1
  s_add_u32 s55, s92, 24576
  buffer_load_dwordx4 v[176:179], v46, s[40:43], s55 offen offset:0 sc1
  buffer_load_dwordx4 v[180:183], v46, s[40:43], s55 offen offset:1024 sc1
  s_add_u32 s55, s92, 32768
  buffer_load_dwordx4 v[184:187], v46, s[40:43], s55 offen offset:0 sc1
  buffer_load_dwordx4 v[188:191], v46, s[40:43], s55 offen offset:1024 sc1
  s_add_u32 s55, s92, 40960
  buffer_load_dwordx4 v[192:195], v46, s[40:43], s55 offen offset:0 sc1
  buffer_load_dwordx4 v[196:199], v46, s[40:43], s55 offen offset:1024 sc1
  s_add_u32 s55, s92, 49152
  buffer_load_dwordx4 v[200:203], v46, s[40:43], s55 offen offset:0 sc1
  buffer_load_dwordx4 v[204:207], v46, s[40:43], s55 offen offset:1024 sc1
  s_add_u32 s55, s92, 57344
  buffer_load_dwordx4 v[208:211], v46, s[40:43], s55 offen offset:0 sc1
  buffer_load_dwordx4 v[212:215], v46, s[40:43], s55 offen offset:1024 sc1
Lhave:
  s_waitcnt lgkmcnt(11)
  v_pk_add_f32 v[64:65], v[64:65], v[80:81]
  v_pk_add_f32 v[66:67], v[66:67], v[82:83]
  s_waitcnt lgkmcnt(10)
  v_pk_add_f32 v[68:69], v[68:69], v[84:85]
  v_pk_add_f32 v[70:71], v[70:71], v[86:87]
  s_waitcnt lgkmcnt(9)
  v_pk_add_f32 v[72:73], v[72:73], v[88:89]
  v_pk_add_f32 v[74:75], v[74:75], v[90:91]
  s_waitcnt lgkmcnt(8)
  v_pk_add_f32 v[76:77], v[76:77], v[92:93]
  v_pk_add_f32 v[78:79], v[78:79], v[94:95]
  s_waitcnt lgkmcnt(3)
  v_pk_add_f32 v[96:97], v[96:97], v[112:113]
  v_pk_add_f32 v[98:99], v[98:99], v[114:115]
  s_waitcnt lgkmcnt(2)
  v_pk_add_f32 v[100:101], v[100:101], v[116:117]
  v_pk_add_f32 v[102:103], v[102:103], v[118:119]
  s_waitcnt lgkmcnt(1)
  v_pk_add_f32 v[104:105], v[104:105], v[120:121]
  v_pk_add_f32 v[106:107], v[106:107], v[122:123]
  s_waitcnt lgkmcnt(0)
  v_pk_add_f32 v[108:109], v[108:109], v[124:125]
  v_pk_add_f32 v[110:111], v[110:111], v[126:127]
  v_pk_add_f32 v[64:65], v[64:65], v[96:97]
  v_pk_add_f32 v[66:67], v[66:67], v[98:99]
  v_pk_add_f32 v[68:69], v[68:69], v[100:101]
  v_pk_add_f32 v[70:71], v[70:71], v[102:103]
  v_pk_add_f32 v[72:73], v[72:73], v[104:105]
  v_pk_add_f32 v[74:75], v[74:75], v[106:107]
  v_pk_add_f32 v[76:77], v[76:77], v[108:109]
  v_pk_add_f32 v[78:79], v[78:79], v[110:111]
  v_cvt_pk_bf16_f32 v232, v64, v65
  v_cvt_pk_bf16_f32 v233, v66, v67
  v_cvt_pk_bf16_f32 v234, v68, v69
  v_cvt_pk_bf16_f32 v235, v70, v71
  v_cvt_pk_bf16_f32 v236, v72, v73
  v_cvt_pk_bf16_f32 v237, v74, v75
  v_cvt_pk_bf16_f32 v238, v76, v77
  v_cvt_pk_bf16_f32 v239, v78, v79
  v_lshlrev_b32 v64, 16, v232
  v_and_b32 v65, 0xffff0000, v232
  v_lshlrev_b32 v66, 16, v233
  v_and_b32 v67, 0xffff0000, v233
  v_lshlrev_b32 v68, 16, v234
  v_and_b32 v69, 0xffff0000, v234
  v_lshlrev_b32 v70, 16, v235
  v_and_b32 v71, 0xffff0000, v235
  v_lshlrev_b32 v72, 16, v236
  v_and_b32 v73, 0xffff0000, v236
  v_lshlrev_b32 v74, 16, v237
  v_and_b32 v75, 0xffff0000, v237
  v_lshlrev_b32 v76, 16, v238
  v_and_b32 v77, 0xffff0000, v238
  v_lshlrev_b32 v78, 16, v239
  v_and_b32 v79, 0xffff0000, v239
  v_mul_f32 v80, 0xbfb8aa3b, v64
  v_mul_f32 v81, 0xbfb8aa3b, v65
  v_mul_f32 v82, 0xbfb8aa3b, v66
  v_mul_f32 v83, 0xbfb8aa3b, v67
  v_mul_f32 v84, 0xbfb8aa3b, v68
  v_mul_f32 v85, 0xbfb8aa3b, v69
  v_mul_f32 v86, 0xbfb8aa3b, v70
  v_mul_f32 v87, 0xbfb8aa3b, v71
  v_mul_f32 v88, 0xbfb8aa3b, v72
  v_mul_f32 v89, 0xbfb8aa3b, v73
  v_mul_f32 v90, 0xbfb8aa3b, v74
  v_mul_f32 v91, 0xbfb8aa3b, v75
  v_mul_f32 v92, 0xbfb8aa3b, v76
  v_mul_f32 v93, 0xbfb8aa3b, v77
  v_mul_f32 v94, 0xbfb8aa3b, v78
  v_mul_f32 v95, 0xbfb8aa3b, v79
  v_exp_f32 v80, v80
  v_exp_f32 v81, v81
  v_exp_f32 v82, v82
  v_exp_f32 v83, v83
  v_exp_f32 v84, v84
  v_exp_f32 v85, v85
  v_exp_f32 v86, v86
  v_exp_f32 v87, v87
  v_exp_f32 v88, v88
  v_exp_f32 v89, v89
  v_exp_f32 v90, v90
  v_exp_f32 v91, v91
  v_exp_f32 v92, v92
  v_exp_f32 v93, v93
  v_exp_f32 v94, v94
  v_exp_f32 v95, v95
  v_add_f32 v80, 1.0, v80
  v_add_f32 v81, 1.0, v81
  v_add_f32 v82, 1.0, v82
  v_add_f32 v83, 1.0, v83
  v_add_f32 v84, 1.0, v84
  v_add_f32 v85, 1.0, v85
  v_add_f32 v86, 1.0, v86
  v_add_f32 v87, 1.0, v87
  v_add_f32 v88, 1.0, v88
  v_add_f32 v89, 1.0, v89
  v_add_f32 v90, 1.0, v90
  v_add_f32 v91, 1.0, v91
  v_add_f32 v92, 1.0, v92
  v_add_f32 v93, 1.0, v93
  v_add_f32 v94, 1.0, v94
  v_add_f32 v95, 1.0, v95
  v_rcp_f32 v80, v80
  v_rcp_f32 v81, v81
  v_rcp_f32 v82, v82
  v_rcp_f32 v83, v83
  v_rcp_f32 v84, v84
  v_rcp_f32 v85, v85
  v_rcp_f32 v86, v86
  v_rcp_f32 v87, v87
  v_rcp_f32 v88, v88
  v_rcp_f32 v89, v89
  v_rcp_f32 v90, v90
  v_rcp_f32 v91, v91
  v_rcp_f32 v92, v92
  v_rcp_f32 v93, v93
  v_rcp_f32 v94, v94
  v_rcp_f32 v95, v95
  v_pk_mul_f32 v[64:65], v[64:65], v[80:81]
  v_pk_mul_f32 v[66:67], v[66:67], v[82:83]
  v_pk_mul_f32 v[68:69], v[68:69], v[84:85]
  v_pk_mul_f32 v[70:71], v[70:71], v[86:87]
  v_pk_mul_f32 v[72:73], v[72:73], v[88:89]
  v_pk_mul_f32 v[74:75], v[74:75], v[90:91]
  v_pk_mul_f32 v[76:77], v[76:77], v[92:93]
  v_pk_mul_f32 v[78:79], v[78:79], v[94:95]
  v_cvt_pk_bf16_f32 v232, v64, v65
  v_cvt_pk_bf16_f32 v233, v66, v67
  v_cvt_pk_bf16_f32 v234, v68, v69
  v_cvt_pk_bf16_f32 v235, v70, v71
  v_cvt_pk_bf16_f32 v236, v72, v73
  v_cvt_pk_bf16_f32 v237, v74, v75
  v_cvt_pk_bf16_f32 v238, v76, v77
  v_cvt_pk_bf16_f32 v239, v78, v79
  v_lshlrev_b32 v64, 16, v232
  v_and_b32 v65, 0xffff0000, v232
  v_lshlrev_b32 v66, 16, v233
  v_and_b32 v67, 0xffff0000, v233
  v_lshlrev_b32 v68, 16, v234
  v_and_b32 v69, 0xffff0000, v234
  v_lshlrev_b32 v70, 16, v235
  v_and_b32 v71, 0xffff0000, v235
  v_lshlrev_b32 v72, 16, v236
  v_and_b32 v73, 0xffff0000, v236
  v_lshlrev_b32 v74, 16, v237
  v_and_b32 v75, 0xffff0000, v237
  v_lshlrev_b32 v76, 16, v238
  v_and_b32 v77, 0xffff0000, v238
  v_lshlrev_b32 v78, 16, v239
  v_and_b32 v79, 0xffff0000, v239
  s_waitcnt vmcnt(15)
  v_lshlrev_b32 v80, 16, v152
  v_and_b32 v81, 0xffff0000, v152
  v_lshlrev_b32 v82, 16, v153
  v_and_b32 v83, 0xffff0000, v153
  v_lshlrev_b32 v84, 16, v154
  v_and_b32 v85, 0xffff0000, v154
  v_lshlrev_b32 v86, 16, v155
  v_and_b32 v87, 0xffff0000, v155
  s_waitcnt vmcnt(14)
  v_lshlrev_b32 v88, 16, v156
  v_and_b32 v89, 0xffff0000, v156
  v_lshlrev_b32 v90, 16, v157
  v_and_b32 v91, 0xffff0000, v157
  v_lshlrev_b32 v92, 16, v158
  v_and_b32 v93, 0xffff0000, v158
  v_lshlrev_b32 v94, 16, v159
  v_and_b32 v95, 0xffff0000, v159
  s_waitcnt vmcnt(13)
  v_lshlrev_b32 v232, 16, v160
  v_and_b32 v233, 0xffff0000, v160
  v_pk_add_f32 v[80:81], v[80:81], v[232:233]
  v_lshlrev_b32 v234, 16, v161
  v_and_b32 v235, 0xffff0000, v161
  v_pk_add_f32 v[82:83], v[82:83], v[234:235]
  v_lshlrev_b32 v236, 16, v162
  v_and_b32 v237, 0xffff0000, v162
  v_pk_add_f32 v[84:85], v[84:85], v[236:237]
  v_lshlrev_b32 v238, 16, v163
  v_and_b32 v239, 0xffff0000, v163
  v_pk_add_f32 v[86:87], v[86:87], v[238:239]
  s_waitcnt vmcnt(12)
  v_lshlrev_b32 v232, 16, v164
  v_and_b32 v233, 0xffff0000, v164
  v_pk_add_f32 v[88:89], v[88:89], v[232:233]
  v_lshlrev_b32 v234, 16, v165
  v_and_b32 v235, 0xffff0000, v165
  v_pk_add_f32 v[90:91], v[90:91], v[234:235]
  v_lshlrev_b32 v236, 16, v166
  v_and_b32 v237, 0xffff0000, v166
  v_pk_add_f32 v[92:93], v[92:93], v[236:237]
  v_lshlrev_b32 v238, 16, v167
  v_and_b32 v239, 0xffff0000, v167
  v_pk_add_f32 v[94:95], v[94:95], v[238:239]
  s_waitcnt vmcnt(11)
  v_lshlrev_b32 v232, 16, v168
  v_and_b32 v233, 0xffff0000, v168
  v_pk_add_f32 v[80:81], v[80:81], v[232:233]
  v_lshlrev_b32 v234, 16, v169
  v_and_b32 v235, 0xffff0000, v169
  v_pk_add_f32 v[82:83], v[82:83], v[234:235]
  v_lshlrev_b32 v236, 16, v170
  v_and_b32 v237, 0xffff0000, v170
  v_pk_add_f32 v[84:85], v[84:85], v[236:237]
  v_lshlrev_b32 v238, 16, v171
  v_and_b32 v239, 0xffff0000, v171
  v_pk_add_f32 v[86:87], v[86:87], v[238:239]
  s_waitcnt vmcnt(10)
  v_lshlrev_b32 v232, 16, v172
  v_and_b32 v233, 0xffff0000, v172
  v_pk_add_f32 v[88:89], v[88:89], v[232:233]
  v_lshlrev_b32 v234, 16, v173
  v_and_b32 v235, 0xffff0000, v173
  v_pk_add_f32 v[90:91], v[90:91], v[234:235]
  v_lshlrev_b32 v236, 16, v174
  v_and_b32 v237, 0xffff0000, v174
  v_pk_add_f32 v[92:93], v[92:93], v[236:237]
  v_lshlrev_b32 v238, 16, v175
  v_and_b32 v239, 0xffff0000, v175
  v_pk_add_f32 v[94:95], v[94:95], v[238:239]
  s_waitcnt vmcnt(9)
  v_lshlrev_b32 v232, 16, v176
  v_and_b32 v233, 0xffff0000, v176
  v_pk_add_f32 v[80:81], v[80:81], v[232:233]
  v_lshlrev_b32 v234, 16, v177
  v_and_b32 v235, 0xffff0000, v177
  v_pk_add_f32 v[82:83], v[82:83], v[234:235]
  v_lshlrev_b32 v236, 16, v178
  v_and_b32 v237, 0xffff0000, v178
  v_pk_add_f32 v[84:85], v[84:85], v[236:237]
  v_lshlrev_b32 v238, 16, v179
  v_and_b32 v239, 0xffff0000, v179
  v_pk_add_f32 v[86:87], v[86:87], v[238:239]
  s_waitcnt vmcnt(8)
  v_lshlrev_b32 v232, 16, v180
  v_and_b32 v233, 0xffff0000, v180
  v_pk_add_f32 v[88:89], v[88:89], v[232:233]
  v_lshlrev_b32 v234, 16, v181
  v_and_b32 v235, 0xffff0000, v181
  v_pk_add_f32 v[90:91], v[90:91], v[234:235]
  v_lshlrev_b32 v236, 16, v182
  v_and_b32 v237, 0xffff0000, v182
  v_pk_add_f32 v[92:93], v[92:93], v[236:237]
  v_lshlrev_b32 v238, 16, v183
  v_and_b32 v239, 0xffff0000, v183
  v_pk_add_f32 v[94:95], v[94:95], v[238:239]
  s_waitcnt vmcnt(7)
  v_lshlrev_b32 v232, 16, v184
  v_and_b32 v233, 0xffff0000, v184
  v_pk_add_f32 v[80:81], v[80:81], v[232:233]
  v_lshlrev_b32 v234, 16, v185
  v_and_b32 v235, 0xffff0000, v185
  v_pk_add_f32 v[82:83], v[82:83], v[234:235]
  v_lshlrev_b32 v236, 16, v186
  v_and_b32 v237, 0xffff0000, v186
  v_pk_add_f32 v[84:85], v[84:85], v[236:237]
  v_lshlrev_b32 v238, 16, v187
  v_and_b32 v239, 0xffff0000, v187
  v_pk_add_f32 v[86:87], v[86:87], v[238:239]
  s_waitcnt vmcnt(6)
  v_lshlrev_b32 v232, 16, v188
  v_and_b32 v233, 0xffff0000, v188
  v_pk_add_f32 v[88:89], v[88:89], v[232:233]
  v_lshlrev_b32 v234, 16, v189
  v_and_b32 v235, 0xffff0000, v189
  v_pk_add_f32 v[90:91], v[90:91], v[234:235]
  v_lshlrev_b32 v236, 16, v190
  v_and_b32 v237, 0xffff0000, v190
  v_pk_add_f32 v[92:93], v[92:93], v[236:237]
  v_lshlrev_b32 v238, 16, v191
  v_and_b32 v239, 0xffff0000, v191
  v_pk_add_f32 v[94:95], v[94:95], v[238:239]
  s_waitcnt vmcnt(5)
  v_lshlrev_b32 v232, 16, v192
  v_and_b32 v233, 0xffff0000, v192
  v_pk_add_f32 v[80:81], v[80:81], v[232:233]
  v_lshlrev_b32 v234, 16, v193
  v_and_b32 v235, 0xffff0000, v193
  v_pk_add_f32 v[82:83], v[82:83], v[234:235]
  v_lshlrev_b32 v236, 16, v194
  v_and_b32 v237, 0xffff0000, v194
  v_pk_add_f32 v[84:85], v[84:85], v[236:237]
  v_lshlrev_b32 v238, 16, v195
  v_and_b32 v239, 0xffff0000, v195
  v_pk_add_f32 v[86:87], v[86:87], v[238:239]
  s_waitcnt vmcnt(4)
  v_lshlrev_b32 v232, 16, v196
  v_and_b32 v233, 0xffff0000, v196
  v_pk_add_f32 v[88:89], v[88:89], v[232:233]
  v_lshlrev_b32 v234, 16, v197
  v_and_b32 v235, 0xffff0000, v197
  v_pk_add_f32 v[90:91], v[90:91], v[234:235]
  v_lshlrev_b32 v236, 16, v198
  v_and_b32 v237, 0xffff0000, v198
  v_pk_add_f32 v[92:93], v[92:93], v[236:237]
  v_lshlrev_b32 v238, 16, v199
  v_and_b32 v239, 0xffff0000, v199
  v_pk_add_f32 v[94:95], v[94:95], v[238:239]
  s_waitcnt vmcnt(3)
  v_lshlrev_b32 v232, 16, v200
  v_and_b32 v233, 0xffff0000, v200
  v_pk_add_f32 v[80:81], v[80:81], v[232:233]
  v_lshlrev_b32 v234, 16, v201
  v_and_b32 v235, 0xffff0000, v201
  v_pk_add_f32 v[82:83], v[82:83], v[234:235]
  v_lshlrev_b32 v236, 16, v202
  v_and_b32 v237, 0xffff0000, v202
  v_pk_add_f32 v[84:85], v[84:85], v[236:237]
  v_lshlrev_b32 v238, 16, v203
  v_and_b32 v239, 0xffff0000, v203
  v_pk_add_f32 v[86:87], v[86:87], v[238:239]
  s_waitcnt vmcnt(2)
  v_lshlrev_b32 v232, 16, v204
  v_and_b32 v233, 0xffff0000, v204
  v_pk_add_f32 v[88:89], v[88:89], v[232:233]
  v_lshlrev_b32 v234, 16, v205
  v_and_b32 v235, 0xffff0000, v205
  v_pk_add_f32 v[90:91], v[90:91], v[234:235]
  v_lshlrev_b32 v236, 16, v206
  v_and_b32 v237, 0xffff0000, v206
  v_pk_add_f32 v[92:93], v[92:93], v[236:237]
  v_lshlrev_b32 v238, 16, v207
  v_and_b32 v239, 0xffff0000, v207
  v_pk_add_f32 v[94:95], v[94:95], v[238:239]
  s_waitcnt vmcnt(1)
  v_lshlrev_b32 v232, 16, v208
  v_and_b32 v233, 0xffff0000, v208
  v_pk_add_f32 v[80:81], v[80:81], v[232:233]
  v_lshlrev_b32 v234, 16, v209
  v_and_b32 v235, 0xffff0000, v209
  v_pk_add_f32 v[82:83], v[82:83], v[234:235]
  v_lshlrev_b32 v236, 16, v210
  v_and_b32 v237, 0xffff0000, v210
  v_pk_add_f32 v[84:85], v[84:85], v[236:237]
  v_lshlrev_b32 v238, 16, v211
  v_and_b32 v239, 0xffff0000, v211
  v_pk_add_f32 v[86:87], v[86:87], v[238:239]
  s_waitcnt vmcnt(0)
  v_lshlrev_b32 v232, 16, v212
  v_and_b32 v233, 0xffff0000, v212
  v_pk_add_f32 v[88:89], v[88:89], v[232:233]
  v_lshlrev_b32 v234, 16, v213
  v_and_b32 v235, 0xffff0000, v213
  v_pk_add_f32 v[90:91], v[90:91], v[234:235]
  v_lshlrev_b32 v236, 16, v214
  v_and_b32 v237, 0xffff0000, v214
  v_pk_add_f32 v[92:93], v[92:93], v[236:237]
  v_lshlrev_b32 v238, 16, v215
  v_and_b32 v239, 0xffff0000, v215
  v_pk_add_f32 v[94:95], v[94:95], v[238:239]
  v_cvt_pk_bf16_f32 v232, v80, v81
  v_cvt_pk_bf16_f32 v233, v82, v83
  v_cvt_pk_bf16_f32 v234, v84, v85
  v_cvt_pk_bf16_f32 v235, v86, v87
  v_cvt_pk_bf16_f32 v236, v88, v89
  v_cvt_pk_bf16_f32 v237, v90, v91
  v_cvt_pk_bf16_f32 v238, v92, v93
  v_cvt_pk_bf16_f32 v239, v94, v95
  v_lshlrev_b32 v80, 16, v232
  v_and_b32 v81, 0xffff0000, v232
  v_lshlrev_b32 v82, 16, v233
  v_and_b32 v83, 0xffff0000, v233
  v_lshlrev_b32 v84, 16, v234
  v_and_b32 v85, 0xffff0000, v234
  v_lshlrev_b32 v86, 16, v235
  v_and_b32 v87, 0xffff0000, v235
  v_lshlrev_b32 v88, 16, v236
  v_and_b32 v89, 0xffff0000, v236
  v_lshlrev_b32 v90, 16, v237
  v_and_b32 v91, 0xffff0000, v237
  v_lshlrev_b32 v92, 16, v238
  v_and_b32 v93, 0xffff0000, v238
  v_lshlrev_b32 v94, 16, v239
  v_and_b32 v95, 0xffff0000, v239
  v_pk_mul_f32 v[80:81], v[80:81], v[64:65]
  v_pk_mul_f32 v[82:83], v[82:83], v[66:67]
  v_pk_mul_f32 v[84:85], v[84:85], v[68:69]
  v_pk_mul_f32 v[86:87], v[86:87], v[70:71]
  v_pk_mul_f32 v[88:89], v[88:89], v[72:73]
  v_pk_mul_f32 v[90:91], v[90:91], v[74:75]
  v_pk_mul_f32 v[92:93], v[92:93], v[76:77]
  v_pk_mul_f32 v[94:95], v[94:95], v[78:79]
  v_cvt_pk_bf16_f32 v232, v80, v81
  v_cvt_pk_bf16_f32 v233, v82, v83
  v_cvt_pk_bf16_f32 v234, v84, v85
  v_cvt_pk_bf16_f32 v235, v86, v87
  v_cvt_pk_bf16_f32 v236, v88, v89
  v_cvt_pk_bf16_f32 v237, v90, v91
  v_cvt_pk_bf16_f32 v238, v92, v93
  v_cvt_pk_bf16_f32 v239, v94, v95
  v_lshlrev_b32 v80, 16, v232
  v_and_b32 v81, 0xffff0000, v232
  v_lshlrev_b32 v82, 16, v233
  v_and_b32 v83, 0xffff0000, v233
  v_lshlrev_b32 v84, 16, v234
  v_and_b32 v85, 0xffff0000, v234
  v_lshlrev_b32 v86, 16, v235
  v_and_b32 v87, 0xffff0000, v235
  v_lshlrev_b32 v88, 16, v236
  v_and_b32 v89, 0xffff0000, v236
  v_lshlrev_b32 v90, 16, v237
  v_and_b32 v91, 0xffff0000, v237
  v_lshlrev_b32 v92, 16, v238
  v_and_b32 v93, 0xffff0000, v238
  v_lshlrev_b32 v94, 16, v239
  v_and_b32 v95, 0xffff0000, v239
  v_pk_add_f32 v[80:81], v[80:81], v[216:217]
  v_pk_add_f32 v[82:83], v[82:83], v[218:219]
  v_pk_add_f32 v[84:85], v[84:85], v[220:221]
  v_pk_add_f32 v[86:87], v[86:87], v[222:223]
  v_pk_add_f32 v[88:89], v[88:89], v[224:225]
  v_pk_add_f32 v[90:91], v[90:91], v[226:227]
  v_pk_add_f32 v[92:93], v[92:93], v[228:229]
  v_pk_add_f32 v[94:95], v[94:95], v[230:231]
  v_cvt_pk_bf16_f32 v232, v80, v81
  v_cvt_pk_bf16_f32 v233, v82, v83
  v_cvt_pk_bf16_f32 v234, v84, v85
  v_cvt_pk_bf16_f32 v235, v86, v87
  v_cvt_pk_bf16_f32 v236, v88, v89
  v_cvt_pk_bf16_f32 v237, v90, v91
  v_cvt_pk_bf16_f32 v238, v92, v93
  v_cvt_pk_bf16_f32 v239, v94, v95
  buffer_store_dwordx2 v[232:233], v47, s[48:51], s93 offen offset:0
  buffer_store_dwordx2 v[234:235], v47, s[48:51], s93 offen offset:32
  buffer_store_dwordx2 v[236:237], v47, s[48:51], s93 offen offset:64
  buffer_store_dwordx2 v[238:239], v47, s[48:51], s93 offen offset:96
  s_endpgm
Lidle:
  s_waitcnt vmcnt(0)
  s_and_b32 s3, s5, 4
  s_lshl_b32 s3, s3, 5
  v_xor_b32 v34, s3, v34
  v_xor_b32 v36, 0, v34
  ds_read_b128 a[160:163], v36 offset:0
  ds_read_b128 a[164:167], v36 offset:32768
  ds_read_b64_tr_b16 a[128:129], v24 offset:0
  ds_read_b64_tr_b16 a[130:131], v24 offset:1024
  ds_read_b64_tr_b16 a[132:133], v25 offset:0
  ds_read_b64_tr_b16 a[134:135], v25 offset:1024
  ds_read_b64_tr_b16 a[136:137], v26 offset:0
  ds_read_b64_tr_b16 a[138:139], v26 offset:1024
  ds_read_b64_tr_b16 a[140:141], v27 offset:0
  ds_read_b64_tr_b16 a[142:143], v27 offset:1024
  s_mov_b32 s12, s74
  s_mov_b32 s13, s75
  s_mov_b32 s14, 4194304
  s_mov_b32 s15, 0x20000
  s_mov_b32 s16, s76
  s_mov_b32 s17, s77
  s_mov_b32 s18, 4194304
  s_mov_b32 s19, 0x20000
  s_mov_b32 s24, s80
  s_mov_b32 s25, s81
  s_mov_b32 s26, 4194304
  s_mov_b32 s27, 0x20000
  s_add_u32 s76, s94, 33554432
  s_addc_u32 s77, s95, 0
  s_mov_b32 s78, 32768
  s_mov_b32 s79, 0x20000
  s_mov_b32 s80, s92
  s_mov_b32 s81, s93
  s_mov_b32 s82, 256
  s_mov_b32 s83, 0x20000
  s_lshl2_add_u32 s70, s5, s4
  s_lshl_b32 s70, s70, 7
  s_lshl2_add_u32 s70, s6, s70
  v_mov_b32 v5, 0
  buffer_store_dword v5, off, s[76:79], s70 sc1
  s_lshl_b32 s61, s5, 7
  s_add_u32 s61, s61, 16384
  s_lshl2_add_u32 s3, s6, s61
  buffer_store_dword v5, off, s[76:79], s3 sc1
  v_min_u32 v4, 1, v0
  v_lshlrev_b32 v4, 20, v4
  v_mov_b32 v5, 1
  s_lshl_b32 s71, s5, 2
  s_add_u32 s71, s71, 128
  v_mul_f32 v54, v128, v128
  v_mul_f32 v56, v192, v192
  v_mul_f32 v55, v129, v129
  v_mul_f32 v57, v193, v193
  v_fmac_f32 v54, v130, v130
  v_fmac_f32 v56, v194, v194
  v_fmac_f32 v55, v131, v131
  v_fmac_f32 v57, v195, v195
  v_fmac_f32 v54, v132, v132
  v_fmac_f32 v56, v196, v196
  v_fmac_f32 v55, v133, v133
  v_fmac_f32 v57, v197, v197
  v_fmac_f32 v54, v134, v134
  v_fmac_f32 v56, v198, v198
  v_fmac_f32 v55, v135, v135
  v_fmac_f32 v57, v199, v199
  v_fmac_f32 v54, v136, v136
  v_fmac_f32 v56, v200, v200
  v_fmac_f32 v55, v137, v137
  v_fmac_f32 v57, v201, v201
  v_fmac_f32 v54, v138, v138
  v_fmac_f32 v56, v202, v202
  v_fmac_f32 v55, v139, v139
  v_fmac_f32 v57, v203, v203
  v_fmac_f32 v54, v140, v140
  v_fmac_f32 v56, v204, v204
  v_fmac_f32 v55, v141, v141
  v_fmac_f32 v57, v205, v205
  v_fmac_f32 v54, v142, v142
  v_fmac_f32 v56, v206, v206
  v_fmac_f32 v55, v143, v143
  v_fmac_f32 v57, v207, v207
  v_fmac_f32 v54, v144, v144
  v_fmac_f32 v56, v208, v208
  v_fmac_f32 v55, v145, v145
  v_fmac_f32 v57, v209, v209
  v_fmac_f32 v54, v146, v146
  v_fmac_f32 v56, v210, v210
  v_fmac_f32 v55, v147, v147
  v_fmac_f32 v57, v211, v211
  v_fmac_f32 v54, v148, v148
  v_fmac_f32 v56, v212, v212
  v_fmac_f32 v55, v149, v149
  v_fmac_f32 v57, v213, v213
  v_fmac_f32 v54, v150, v150
  v_fmac_f32 v56, v214, v214
  v_fmac_f32 v55, v151, v151
  v_fmac_f32 v57, v215, v215
  v_fmac_f32 v54, v152, v152
  v_fmac_f32 v56, v216, v216
  v_fmac_f32 v55, v153, v153
  v_fmac_f32 v57, v217, v217
  v_fmac_f32 v54, v154, v154
  v_fmac_f32 v56, v218, v218
  v_fmac_f32 v55, v155, v155
  v_fmac_f32 v57, v219, v219
  v_fmac_f32 v54, v156, v156
  v_fmac_f32 v56, v220, v220
  v_fmac_f32 v55, v157, v157
  v_fmac_f32 v57, v221, v221
  v_fmac_f32 v54, v158, v158
  v_fmac_f32 v56, v222, v222
  v_fmac_f32 v55, v159, v159
  v_fmac_f32 v57, v223, v223
  v_fmac_f32 v54, v160, v160
  v_fmac_f32 v56, v224, v224
  v_fmac_f32 v55, v161, v161
  v_fmac_f32 v57, v225, v225
  v_fmac_f32 v54, v162, v162
  v_fmac_f32 v56, v226, v226
  v_fmac_f32 v55, v163, v163
  v_fmac_f32 v57, v227, v227
  v_fmac_f32 v54, v164, v164
  v_fmac_f32 v56, v228, v228
  v_fmac_f32 v55, v165, v165
  v_fmac_f32 v57, v229, v229
  v_fmac_f32 v54, v166, v166
  v_fmac_f32 v56, v230, v230
  v_fmac_f32 v55, v167, v167
  v_fmac_f32 v57, v231, v231
  v_fmac_f32 v54, v168, v168
  v_fmac_f32 v56, v232, v232
  v_fmac_f32 v55, v169, v169
  v_fmac_f32 v57, v233, v233
  v_fmac_f32 v54, v170, v170
  v_fmac_f32 v56, v234, v234
  v_fmac_f32 v55, v171, v171
  v_fmac_f32 v57, v235, v235
  v_fmac_f32 v54, v172, v172
  v_fmac_f32 v56, v236, v236
  v_fmac_f32 v55, v173, v173
  v_fmac_f32 v57, v237, v237
  v_fmac_f32 v54, v174, v174
  v_fmac_f32 v56, v238, v238
  v_fmac_f32 v55, v175, v175
  v_fmac_f32 v57, v239, v239
  v_fmac_f32 v54, v176, v176
  v_fmac_f32 v56, v240, v240
  v_fmac_f32 v55, v177, v177
  v_fmac_f32 v57, v241, v241
  v_fmac_f32 v54, v178, v178
  v_fmac_f32 v56, v242, v242
  v_fmac_f32 v55, v179, v179
  v_fmac_f32 v57, v243, v243
  v_fmac_f32 v54, v180, v180
  v_fmac_f32 v56, v244, v244
  v_fmac_f32 v55, v181, v181
  v_fmac_f32 v57, v245, v245
  v_fmac_f32 v54, v182, v182
  v_fmac_f32 v56, v246, v246
  v_fmac_f32 v55, v183, v183
  v_fmac_f32 v57, v247, v247
  v_fmac_f32 v54, v184, v184
  v_fmac_f32 v56, v248, v248
  v_fmac_f32 v55, v185, v185
  v_fmac_f32 v57, v249, v249
  v_fmac_f32 v54, v186, v186
  v_fmac_f32 v56, v250, v250
  v_fmac_f32 v55, v187, v187
  v_fmac_f32 v57, v251, v251
  v_fmac_f32 v54, v188, v188
  v_fmac_f32 v56, v252, v252
  v_fmac_f32 v55, v189, v189
  v_fmac_f32 v57, v253, v253
  v_fmac_f32 v54, v190, v190
  v_fmac_f32 v56, v254, v254
  v_fmac_f32 v55, v191, v191
  v_fmac_f32 v57, v255, v255
  v_add_f32 v54, v54, v55
  v_add_f32 v56, v56, v57
  v_mul_f32 v32, v32, v32
  v_mul_f32 v33, v33, v33
  v_add_f32_dpp v54, v54, v54 quad_perm:[1,0,3,2] row_mask:0xf bank_mask:0xf
  v_add_f32_dpp v56, v56, v56 quad_perm:[1,0,3,2] row_mask:0xf bank_mask:0xf
  s_nop 0
  v_add_f32_dpp v54, v54, v54 quad_perm:[2,3,0,1] row_mask:0xf bank_mask:0xf
  v_add_f32_dpp v56, v56, v56 quad_perm:[2,3,0,1] row_mask:0xf bank_mask:0xf
  s_nop 0
  v_add_f32_dpp v54, v54, v54 row_half_mirror row_mask:0xf bank_mask:0xf
  v_add_f32_dpp v56, v56, v56 row_half_mirror row_mask:0xf bank_mask:0xf
  v_mul_f32 v54, 0x3b000000, v54
  v_mul_f32 v56, 0x3b000000, v56
  v_sub_f32 v54, v54, v32
  v_sub_f32 v56, v56, v33
  v_cvt_pk_bf16_f32 v54, v54, v54
  v_cvt_pk_bf16_f32 v56, v56, v56
  v_lshlrev_b32 v54, 16, v54
  v_lshlrev_b32 v56, 16, v56
  v_add_f32 v54, 0x3727c5ac, v54
  v_add_f32 v56, 0x3727c5ac, v56
  v_cvt_pk_bf16_f32 v54, v54, v54
  v_cvt_pk_bf16_f32 v56, v56, v56
  v_lshlrev_b32 v54, 16, v54
  v_lshlrev_b32 v56, 16, v56
  v_sqrt_f32 v54, v54
  v_sqrt_f32 v56, v56
  v_cvt_pk_bf16_f32 v54, v54, v54
  v_cvt_pk_bf16_f32 v56, v56, v56
  v_lshlrev_b32 v54, 16, v54
  v_lshlrev_b32 v56, 16, v56
  ds_write_b32 v53, v54
  ds_write_b32 v53, v56 offset:32
  s_waitcnt vmcnt(0) lgkmcnt(0)
  s_barrier
  buffer_atomic_add v5, v4, s[80:83], s71 offen
  ds_read_b32 v10, v58
  ds_read_b32 v11, v58 offset:128
  s_waitcnt lgkmcnt(1)
  v_rcp_f32 v8, v10
  s_waitcnt lgkmcnt(0)
  v_rcp_f32 v9, v11
  v_mul_f32 v58, 0x3e0293ee, v8
  v_mul_f32 v59, 0x3e0293ee, v9
  v_mul_f32 v8, 0xbfb8aa3b, v8
  v_mul_f32 v9, 0xbfb8aa3b, v9
  s_mov_b32 s36, s88
  s_mov_b32 s37, s89
  s_mov_b32 s38, 1835008
  s_mov_b32 s39, 0x20000
  s_mov_b32 s48, s90
  s_mov_b32 s49, s91
  s_mov_b32 s50, 2097152
  s_mov_b32 s51, 0x20000
  s_mov_b32 s40, s94
  s_mov_b32 s41, s95
  s_mov_b32 s42, 33554432
  s_mov_b32 s43, 0x20000
  s_add_u32 s44, s94, 20971520
  s_addc_u32 s45, s95, 0
  s_mov_b32 s46, 7340032
  s_mov_b32 s47, 0x20000
  s_add_u32 s84, s94, 20971520
  s_addc_u32 s85, s95, 0
  s_mov_b32 s86, 63488
  s_mov_b32 s87, 0x20000
  s_cmp_eq_u32 s101, 1
  s_cselect_b32 s46, 0, s46
  s_mov_b32 s94, s61
  s_lshl_b32 s58, s6, 19
  s_lshl_b32 s3, s57, 14
  s_or_b32 s58, s58, s3
  s_lshl_b32 s60, s6, 19
  s_or_b32 s60, s60, 0x60000
  s_lshl_b32 s3, s5, 14
  s_and_b32 s3, s3, 114688
  s_or_b32 s60, s60, s3
  s_mul_i32 s68, s5, 229376
  s_lshl_b32 s3, s4, 13
  s_add_u32 s66, s68, s3
  s_lshl_b32 s3, s7, 15
  s_add_u32 s66, s66, s3
  s_add_u32 s67, s66, 4096
  s_mul_i32 s3, s4, 55296
  s_add_u32 s3, s3, s68
  s_add_u32 s84, s84, s3
  s_addc_u32 s85, s85, 0
  s_lshr_b32 s3, s2, 5
  s_mul_i32 s3, s3, 2
  s_and_b32 s55, s6, 3
  s_mul_i32 s55, s55, 4
  s_add_u32 s3, s3, s55
  s_sub_u32 s55, s3, 14
  s_min_u32 s3, s3, s55
  s_sub_u32 s55, s3, 14
  s_min_u32 s3, s3, s55
  s_sub_u32 s55, s3, 14
  s_min_u32 s3, s3, s55
  s_sub_u32 s55, s3, 14
  s_min_u32 s3, s3, s55
  s_lshl_b32 s59, s3, 15
  s_lshl_b32 s68, s3, 12
  s_lshl_b32 s62, s5, 19
  s_lshl_b32 s3, s6, 13
  s_add_u32 s62, s62, s3
  s_add_u32 s63, s62, 4096
  s_add_u32 s64, s62, 65536
  s_add_u32 s65, s62, 69632
  s_and_b32 s3, s5, 0
  s_xor_b32 s7, s6, s3
  s_lshl3_add_u32 s92, s5, s7
  s_lshl_b32 s92, s92, 16
  s_lshl_b32 s3, s7, 7
  s_add_u32 s93, s100, s3
  s_lshl_b32 s3, s4, 17
  v_lshlrev_b32 v50, 4, v1
  v_add_u32 v50, s3, v50
  v_lshrrev_b32 v6, 4, v1
  v_and_b32 v7, 15, v1
  s_lshl_b32 s55, s4, 12
  s_lshl_b32 s3, s4, 8
  v_add_u32 v16, 0, v6
  v_xor_b32 v16, v16, v7
  v_lshlrev_b32 v16, 4, v16
  v_lshl_add_u32 v16, v6, 8, v16
  v_add_u32 v16, s55, v16
  v_lshlrev_b32 v42, 1, v6
  v_xor_b32 v42, 0, v42
  v_xor_b32 v42, v42, v7
  v_lshlrev_b32 v42, 4, v42
  v_lshl_add_u32 v42, v6, 10, v42
  v_add_u32 v42, s3, v42
  v_add_u32 v42, 0, v42
  v_add_u32 v17, 4, v6
  v_xor_b32 v17, v17, v7
  v_lshlrev_b32 v17, 4, v17
  v_lshl_add_u32 v17, v6, 8, v17
  v_add_u32 v17, s55, v17
  v_lshlrev_b32 v43, 1, v6
  v_xor_b32 v43, 8, v43
  v_xor_b32 v43, v43, v7
  v_lshlrev_b32 v43, 4, v43
  v_lshl_add_u32 v43, v6, 10, v43
  v_add_u32 v43, s3, v43
  v_add_u32 v43, 3072, v43
  v_add_u32 v18, 8, v6
  v_xor_b32 v18, v18, v7
  v_lshlrev_b32 v18, 4, v18
  v_lshl_add_u32 v18, v6, 8, v18
  v_add_u32 v18, s55, v18
  v_lshlrev_b32 v44, 1, v6
  v_xor_b32 v44, 0, v44
  v_xor_b32 v44, v44, v7
  v_lshlrev_b32 v44, 4, v44
  v_lshl_add_u32 v44, v6, 10, v44
  v_add_u32 v44, s3, v44
  v_add_u32 v44, 6144, v44
  v_add_u32 v19, 12, v6
  v_xor_b32 v19, v19, v7
  v_lshlrev_b32 v19, 4, v19
  v_lshl_add_u32 v19, v6, 8, v19
  v_add_u32 v19, s55, v19
  v_lshlrev_b32 v45, 1, v6
  v_xor_b32 v45, 8, v45
  v_xor_b32 v45, v45, v7
  v_lshlrev_b32 v45, 4, v45
  v_lshl_add_u32 v45, v6, 10, v45
  v_add_u32 v45, s3, v45
  v_add_u32 v45, 9216, v45
  v_lshrrev_b32 v2, 5, v1
  v_bfe_u32 v3, v1, 2, 2
  v_lshl_add_u32 v6, v2, 3, v3
  v_bfe_u32 v7, v1, 4, 1
  v_lshlrev_b32 v23, 4, v7
  v_and_b32 v7, 1, v1
  v_lshl_add_u32 v23, v7, 3, v23
  v_bfe_u32 v7, v1, 1, 1
  v_lshl_add_u32 v23, v7, 5, v23
  v_lshl_add_u32 v6, v6, 8, v23
  v_add_u32 v6, 98304, v6
  v_xor_b32 v7, 0, v3
  v_lshl_add_u32 v20, v7, 6, v6
  v_xor_b32 v7, 1, v3
  v_lshl_add_u32 v21, v7, 6, v6
  v_xor_b32 v7, 2, v3
  v_lshl_add_u32 v22, v7, 6, v6
  v_xor_b32 v7, 3, v3
  v_lshl_add_u32 v23, v7, 6, v6
  s_branch LQ
Lspina:
  s_mov_b32 s3, 0
Lspina1:
  s_sleep 8
  buffer_load_dword v6, off, s[80:83], s71 sc1
  s_waitcnt vmcnt(0)
  v_cmp_gt_u32 vcc, 8, v6
  s_add_u32 s3, s3, 1
  s_nop 2
  s_cbranch_vccz Lspina_ret
  s_cmp_lt_u32 s3, 262144
  s_cbranch_scc1 Lspina1
  s_branch Lspina_ret
Lspinb:
  s_mov_b32 s3, 0
Lspinb1:
  s_sleep 8
  buffer_load_dword v6, v7, s[76:79], s94 offen sc1
  s_waitcnt vmcnt(0)
  v_cmp_ne_u32 vcc, 1, v6
  s_add_u32 s3, s3, 1
  s_nop 2
  s_cbranch_vccz Lspinb_ret
  s_cmp_lt_u32 s3, 262144
  s_cbranch_scc1 Lspinb1
  s_branch Lspinb_ret
Lslow:
  s_nop 15
  s_waitcnt vmcnt(0) lgkmcnt(0)
  v_bfe_u32 v2, v8, 14, 1
  v_and_b32 v64, 0xfff, v8
  v_lshl_add_u32 v64, v2, 12, v64
  v_add_u32 v64, s52, v64
  v_bfe_u32 v2, v9, 14, 1
  v_and_b32 v65, 0xfff, v9
  v_lshl_add_u32 v65, v2, 12, v65
  v_add_u32 v65, s52, v65
  v_bfe_u32 v2, v10, 14, 1
  v_and_b32 v66, 0xfff, v10
  v_lshl_add_u32 v66, v2, 12, v66
  v_add_u32 v66, s52, v66
  v_bfe_u32 v2, v11, 14, 1
  v_and_b32 v67, 0xfff, v11
  v_lshl_add_u32 v67, v2, 12, v67
  v_add_u32 v67, s52, v67
  v_bfe_u32 v2, v12, 14, 1
  v_and_b32 v68, 0xfff, v12
  v_lshl_add_u32 v68, v2, 12, v68
  v_add_u32 v68, s52, v68
  v_bfe_u32 v2, v13, 14, 1
  v_and_b32 v69, 0xfff, v13
  v_lshl_add_u32 v69, v2, 12, v69
  v_add_u32 v69, s52, v69
  v_bfe_u32 v2, v14, 14, 1
  v_and_b32 v70, 0xfff, v14
  v_lshl_add_u32 v70, v2, 12, v70
  v_add_u32 v70, s52, v70
  v_bfe_u32 v2, v15, 14, 1
  v_and_b32 v71, 0xfff, v15
  v_lshl_add_u32 v71, v2, 12, v71
  v_add_u32 v71, s52, v71
  s_lshl_b32 s55, s4, 12
  v_subrev_u32 v72, s55, v16
  v_and_b32 v80, 0xfff, v20
  v_add_u32 v80, s52, v80
  v_subrev_u32 v73, s55, v17
  v_and_b32 v81, 0xfff, v21
  v_add_u32 v81, s52, v81
  v_subrev_u32 v74, s55, v18
  v_and_b32 v82, 0xfff, v22
  v_add_u32 v82, s52, v82
  v_subrev_u32 v75, s55, v19
  v_and_b32 v83, 0xfff, v23
  v_add_u32 v83, s52, v83
  v_subrev_u32 v76, s55, v48
  s_and_b32 s61, s60, 4294852607
  v_mov_b32 v77, 0xff800000
  v_mov_b32 v78, 0xff800000
  s_mov_b32 s55, s61
  s_add_u32 s3, s61, 131072
Lslow1:
  s_add_u32 m0, s52, 0
  s_add_u32 s54, s55, 0
  buffer_load_dwordx4 v72, s[12:15], s54 offen offset:0 lds
  buffer_load_dwordx4 v73, s[12:15], s54 offen offset:1024 lds
  buffer_load_dwordx4 v74, s[12:15], s54 offen offset:2048 lds
  buffer_load_dwordx4 v75, s[12:15], s54 offen offset:3072 lds
  s_add_u32 m0, s52, 4096
  s_add_u32 s54, s55, 4096
  buffer_load_dwordx4 v72, s[12:15], s54 offen offset:0 lds
  buffer_load_dwordx4 v73, s[12:15], s54 offen offset:1024 lds
  buffer_load_dwordx4 v74, s[12:15], s54 offen offset:2048 lds
  buffer_load_dwordx4 v75, s[12:15], s54 offen offset:3072 lds
  s_waitcnt vmcnt(0)
  ds_read_b128 a[176:179], v64
  ds_read_b128 a[180:183], v65
  ds_read_b128 a[184:187], v66
  ds_read_b128 a[188:191], v67
  ds_read_b128 a[192:195], v68
  ds_read_b128 a[196:199], v69
  ds_read_b128 a[200:203], v70
  ds_read_b128 a[204:207], v71
  s_waitcnt lgkmcnt(0)
  v_mfma_f32_32x32x16_bf16 v[96:111], a[176:179], v[128:131], 0
  v_mfma_f32_32x32x16_bf16 v[112:127], a[176:179], v[136:139], 0
  v_mfma_f32_32x32x16_bf16 v[96:111], a[180:183], v[132:135], v[96:111]
  v_mfma_f32_32x32x16_bf16 v[112:127], a[180:183], v[140:143], v[112:127]
  v_mfma_f32_32x32x16_bf16 v[96:111], a[184:187], v[144:147], v[96:111]
  v_mfma_f32_32x32x16_bf16 v[112:127], a[184:187], v[152:155], v[112:127]
  v_mfma_f32_32x32x16_bf16 v[96:111], a[188:191], v[148:151], v[96:111]
  v_mfma_f32_32x32x16_bf16 v[112:127], a[188:191], v[156:159], v[112:127]
  v_mfma_f32_32x32x16_bf16 v[96:111], a[192:195], v[160:163], v[96:111]
  v_mfma_f32_32x32x16_bf16 v[112:127], a[192:195], v[168:171], v[112:127]
  v_mfma_f32_32x32x16_bf16 v[96:111], a[196:199], v[164:167], v[96:111]
  v_mfma_f32_32x32x16_bf16 v[112:127], a[196:199], v[172:175], v[112:127]
  v_mfma_f32_32x32x16_bf16 v[96:111], a[200:203], v[176:179], v[96:111]
  v_mfma_f32_32x32x16_bf16 v[112:127], a[200:203], v[184:187], v[112:127]
  v_mfma_f32_32x32x16_bf16 v[96:111], a[204:207], v[180:183], v[96:111]
  v_mfma_f32_32x32x16_bf16 v[112:127], a[204:207], v[188:191], v[112:127]
  s_nop 15
  v_max3_f32 v2, v96, v97, v98
  v_max3_f32 v3, v112, v113, v114
  v_max3_f32 v2, v99, v100, v2
  v_max3_f32 v3, v115, v116, v3
  v_max3_f32 v2, v101, v102, v2
  v_max3_f32 v3, v117, v118, v3
  v_max3_f32 v2, v103, v104, v2
  v_max3_f32 v3, v119, v120, v3
  v_max3_f32 v2, v105, v106, v2
  v_max3_f32 v3, v121, v122, v3
  v_max3_f32 v2, v107, v108, v2
  v_max3_f32 v3, v123, v124, v3
  v_max3_f32 v2, v109, v110, v2
  v_max3_f32 v3, v125, v126, v3
  v_max_f32 v32, v111, v2
  v_max_f32 v33, v127, v3
  v_max_f32 v77, v77, v32
  v_max_f32 v78, v78, v33
  s_add_u32 s55, s55, 8192
  s_cmp_lt_u32 s55, s3
  s_cbranch_scc1 Lslow1
  v_mov_b32 v2, v77
  v_mov_b32 v3, v78
  s_nop 0
  v_permlane32_swap_b32 v2, v77
  v_permlane32_swap_b32 v3, v78
  v_max_f32 v77, v77, v2
  v_max_f32 v78, v78, v3
  v_sub_f32 v224, 0, v77
  v_sub_f32 v225, 0, v77
  v_sub_f32 v226, 0, v77
  v_sub_f32 v227, 0, v77
  v_sub_f32 v228, 0, v77
  v_sub_f32 v229, 0, v77
  v_sub_f32 v230, 0, v77
  v_sub_f32 v231, 0, v77
  v_sub_f32 v232, 0, v77
  v_sub_f32 v233, 0, v77
  v_sub_f32 v234, 0, v77
  v_sub_f32 v235, 0, v77
  v_sub_f32 v236, 0, v77
  v_sub_f32 v237, 0, v77
  v_sub_f32 v238, 0, v77
  v_sub_f32 v239, 0, v77
  v_sub_f32 v240, 0, v78
  v_sub_f32 v241, 0, v78
  v_sub_f32 v242, 0, v78
  v_sub_f32 v243, 0, v78
  v_sub_f32 v244, 0, v78
  v_sub_f32 v245, 0, v78
  v_sub_f32 v246, 0, v78
  v_sub_f32 v247, 0, v78
  v_sub_f32 v248, 0, v78
  v_sub_f32 v249, 0, v78
  v_sub_f32 v250, 0, v78
  v_sub_f32 v251, 0, v78
  v_sub_f32 v252, 0, v78
  v_sub_f32 v253, 0, v78
  v_sub_f32 v254, 0, v78
  v_sub_f32 v255, 0, v78
  v_accvgpr_write_b32 a0, 0
  v_accvgpr_write_b32 a1, 0
  v_accvgpr_write_b32 a2, 0
  v_accvgpr_write_b32 a3, 0
  v_accvgpr_write_b32 a4, 0
  v_accvgpr_write_b32 a5, 0
  v_accvgpr_write_b32 a6, 0
  v_accvgpr_write_b32 a7, 0
  v_accvgpr_write_b32 a8, 0
  v_accvgpr_write_b32 a9, 0
  v_accvgpr_write_b32 a10, 0
  v_accvgpr_write_b32 a11, 0
  v_accvgpr_write_b32 a12, 0
  v_accvgpr_write_b32 a13, 0
  v_accvgpr_write_b32 a14, 0
  v_accvgpr_write_b32 a15, 0
  v_accvgpr_write_b32 a16, 0
  v_accvgpr_write_b32 a17, 0
  v_accvgpr_write_b32 a18, 0
  v_accvgpr_write_b32 a19, 0
  v_accvgpr_write_b32 a20, 0
  v_accvgpr_write_b32 a21, 0
  v_accvgpr_write_b32 a22, 0
  v_accvgpr_write_b32 a23, 0
  v_accvgpr_write_b32 a24, 0
  v_accvgpr_write_b32 a25, 0
  v_accvgpr_write_b32 a26, 0
  v_accvgpr_write_b32 a27, 0
  v_accvgpr_write_b32 a28, 0
  v_accvgpr_write_b32 a29, 0
  v_accvgpr_write_b32 a30, 0
  v_accvgpr_write_b32 a31, 0
  v_accvgpr_write_b32 a32, 0
  v_accvgpr_write_b32 a33, 0
  v_accvgpr_write_b32 a34, 0
  v_accvgpr_write_b32 a35, 0
  v_accvgpr_write_b32 a36, 0
  v_accvgpr_write_b32 a37, 0
  v_accvgpr_write_b32 a38, 0
  v_accvgpr_write_b32 a39, 0
  v_accvgpr_write_b32 a40, 0
  v_accvgpr_write_b32 a41, 0
  v_accvgpr_write_b32 a42, 0
  v_accvgpr_write_b32 a43, 0
  v_accvgpr_write_b32 a44, 0
  v_accvgpr_write_b32 a45, 0
  v_accvgpr_write_b32 a46, 0
  v_accvgpr_write_b32 a47, 0
  v_accvgpr_write_b32 a48, 0
  v_accvgpr_write_b32 a49, 0
  v_accvgpr_write_b32 a50, 0
  v_accvgpr_write_b32 a51, 0
  v_accvgpr_write_b32 a52, 0
  v_accvgpr_write_b32 a53, 0
  v_accvgpr_write_b32 a54, 0
  v_accvgpr_write_b32 a55, 0
  v_accvgpr_write_b32 a56, 0
  v_accvgpr_write_b32 a57, 0
  v_accvgpr_write_b32 a58, 0
  v_accvgpr_write_b32 a59, 0
  v_accvgpr_write_b32 a60, 0
  v_accvgpr_write_b32 a61, 0
  v_accvgpr_write_b32 a62, 0
  v_accvgpr_write_b32 a63, 0
  v_accvgpr_write_b32 a64, 0
  v_accvgpr_write_b32 a65, 0
  v_accvgpr_write_b32 a66, 0
  v_accvgpr_write_b32 a67, 0
  v_accvgpr_write_b32 a68, 0
  v_accvgpr_write_b32 a69, 0
  v_accvgpr_write_b32 a70, 0
  v_accvgpr_write_b32 a71, 0
  v_accvgpr_write_b32 a72, 0
  v_accvgpr_write_b32 a73, 0
  v_accvgpr_write_b32 a74, 0
  v_accvgpr_write_b32 a75, 0
  v_accvgpr_write_b32 a76, 0
  v_accvgpr_write_b32 a77, 0
  v_accvgpr_write_b32 a78, 0
  v_accvgpr_write_b32 a79, 0
  v_accvgpr_write_b32 a80, 0
  v_accvgpr_write_b32 a81, 0
  v_accvgpr_write_b32 a82, 0
  v_accvgpr_write_b32 a83, 0
  v_accvgpr_write_b32 a84, 0
  v_accvgpr_write_b32 a85, 0
  v_accvgpr_write_b32 a86, 0
  v_accvgpr_write_b32 a87, 0
  v_accvgpr_write_b32 a88, 0
  v_accvgpr_write_b32 a89, 0
  v_accvgpr_write_b32 a90, 0
  v_accvgpr_write_b32 a91, 0
  v_accvgpr_write_b32 a92, 0
  v_accvgpr_write_b32 a93, 0
  v_accvgpr_write_b32 a94, 0
  v_accvgpr_write_b32 a95, 0
  v_accvgpr_write_b32 a96, 0
  v_accvgpr_write_b32 a97, 0
  v_accvgpr_write_b32 a98, 0
  v_accvgpr_write_b32 a99, 0
  v_accvgpr_write_b32 a100, 0
  v_accvgpr_write_b32 a101, 0
  v_accvgpr_write_b32 a102, 0
  v_accvgpr_write_b32 a103, 0
  v_accvgpr_write_b32 a104, 0
  v_accvgpr_write_b32 a105, 0
  v_accvgpr_write_b32 a106, 0
  v_accvgpr_write_b32 a107, 0
  v_accvgpr_write_b32 a108, 0
  v_accvgpr_write_b32 a109, 0
  v_accvgpr_write_b32 a110, 0
  v_accvgpr_write_b32 a111, 0
  v_accvgpr_write_b32 a112, 0
  v_accvgpr_write_b32 a113, 0
  v_accvgpr_write_b32 a114, 0
  v_accvgpr_write_b32 a115, 0
  v_accvgpr_write_b32 a116, 0
  v_accvgpr_write_b32 a117, 0
  v_accvgpr_write_b32 a118, 0
  v_accvgpr_write_b32 a119, 0
  v_accvgpr_write_b32 a120, 0
  v_accvgpr_write_b32 a121, 0
  v_accvgpr_write_b32 a122, 0
  v_accvgpr_write_b32 a123, 0
  v_accvgpr_write_b32 a124, 0
  v_accvgpr_write_b32 a125, 0
  v_accvgpr_write_b32 a126, 0
  v_accvgpr_write_b32 a127, 0
  v_mov_b32 v60, 0
  v_mov_b32 v61, 0
  s_mov_b32 s55, s61
Lslow2:
  s_add_u32 m0, s52, 0
  s_add_u32 s54, s55, 0
  buffer_load_dwordx4 v72, s[12:15], s54 offen offset:0 lds
  buffer_load_dwordx4 v73, s[12:15], s54 offen offset:1024 lds
  buffer_load_dwordx4 v74, s[12:15], s54 offen offset:2048 lds
  buffer_load_dwordx4 v75, s[12:15], s54 offen offset:3072 lds
  s_add_u32 m0, s52, 8192
  s_nop 0
  buffer_load_dwordx4 v76, s[16:19], s54 offen offset:0 lds
  buffer_load_dwordx4 v76, s[16:19], s54 offen offset:1024 lds
  buffer_load_dwordx4 v76, s[16:19], s54 offen offset:2048 lds
  buffer_load_dwordx4 v76, s[16:19], s54 offen offset:3072 lds
  s_add_u32 m0, s52, 4096
  s_add_u32 s54, s55, 4096
  buffer_load_dwordx4 v72, s[12:15], s54 offen offset:0 lds
  buffer_load_dwordx4 v73, s[12:15], s54 offen offset:1024 lds
  buffer_load_dwordx4 v74, s[12:15], s54 offen offset:2048 lds
  buffer_load_dwordx4 v75, s[12:15], s54 offen offset:3072 lds
  s_add_u32 m0, s52, 12288
  s_nop 0
  buffer_load_dwordx4 v76, s[16:19], s54 offen offset:0 lds
  buffer_load_dwordx4 v76, s[16:19], s54 offen offset:1024 lds
  buffer_load_dwordx4 v76, s[16:19], s54 offen offset:2048 lds
  buffer_load_dwordx4 v76, s[16:19], s54 offen offset:3072 lds
  s_waitcnt vmcnt(0)
  ds_read_b128 a[176:179], v64
  ds_read_b128 a[180:183], v65
  ds_read_b128 a[184:187], v66
  ds_read_b128 a[188:191], v67
  ds_read_b128 a[192:195], v68
  ds_read_b128 a[196:199], v69
  ds_read_b128 a[200:203], v70
  ds_read_b128 a[204:207], v71
  s_waitcnt lgkmcnt(0)
  v_mfma_f32_32x32x16_bf16 v[96:111], a[176:179], v[128:131], v[224:239]
  v_mfma_f32_32x32x16_bf16 v[112:127], a[176:179], v[136:139], v[240:255]
  v_mfma_f32_32x32x16_bf16 v[96:111], a[180:183], v[132:135], v[96:111]
  v_mfma_f32_32x32x16_bf16 v[112:127], a[180:183], v[140:143], v[112:127]
  v_mfma_f32_32x32x16_bf16 v[96:111], a[184:187], v[144:147], v[96:111]
  v_mfma_f32_32x32x16_bf16 v[112:127], a[184:187], v[152:155], v[112:127]
  v_mfma_f32_32x32x16_bf16 v[96:111], a[188:191], v[148:151], v[96:111]
  v_mfma_f32_32x32x16_bf16 v[112:127], a[188:191], v[156:159], v[112:127]
  v_mfma_f32_32x32x16_bf16 v[96:111], a[192:195], v[160:163], v[96:111]
  v_mfma_f32_32x32x16_bf16 v[112:127], a[192:195], v[168:171], v[112:127]
  v_mfma_f32_32x32x16_bf16 v[96:111], a[196:199], v[164:167], v[96:111]
  v_mfma_f32_32x32x16_bf16 v[112:127], a[196:199], v[172:175], v[112:127]
  v_mfma_f32_32x32x16_bf16 v[96:111], a[200:203], v[176:179], v[96:111]
  v_mfma_f32_32x32x16_bf16 v[112:127], a[200:203], v[184:187], v[112:127]
  v_mfma_f32_32x32x16_bf16 v[96:111], a[204:207], v[180:183], v[96:111]
  v_mfma_f32_32x32x16_bf16 v[112:127], a[204:207], v[188:191], v[112:127]
  s_nop 15
  ds_read_b64_tr_b16 a[176:177], v80 offset:8192
  ds_read_b64_tr_b16 a[178:179], v80 offset:9216
  ds_read_b64_tr_b16 a[180:181], v81 offset:8192
  ds_read_b64_tr_b16 a[182:183], v81 offset:9216
  ds_read_b64_tr_b16 a[184:185], v82 offset:8192
  ds_read_b64_tr_b16 a[186:187], v82 offset:9216
  ds_read_b64_tr_b16 a[188:189], v83 offset:8192
  ds_read_b64_tr_b16 a[190:191], v83 offset:9216
  ds_read_b64_tr_b16 a[192:193], v80 offset:12288
  ds_read_b64_tr_b16 a[194:195], v80 offset:13312
  ds_read_b64_tr_b16 a[196:197], v81 offset:12288
  ds_read_b64_tr_b16 a[198:199], v81 offset:13312
  ds_read_b64_tr_b16 a[200:201], v82 offset:12288
  ds_read_b64_tr_b16 a[202:203], v82 offset:13312
  ds_read_b64_tr_b16 a[204:205], v83 offset:12288
  ds_read_b64_tr_b16 a[206:207], v83 offset:13312
  v_exp_f32 v96, v96
  v_exp_f32 v97, v97
  v_add_f32 v60, v60, v96
  v_exp_f32 v98, v98
  v_add_f32 v60, v60, v97
  v_cvt_pk_bf16_f32 v96, v96, v97
  v_exp_f32 v99, v99
  v_add_f32 v60, v60, v98
  v_exp_f32 v100, v100
  v_add_f32 v60, v60, v99
  v_cvt_pk_bf16_f32 v97, v98, v99
  v_exp_f32 v101, v101
  v_add_f32 v60, v60, v100
  v_exp_f32 v102, v102
  v_add_f32 v60, v60, v101
  v_cvt_pk_bf16_f32 v98, v100, v101
  v_exp_f32 v103, v103
  v_add_f32 v60, v60, v102
  v_exp_f32 v112, v112
  v_add_f32 v60, v60, v103
  v_cvt_pk_bf16_f32 v99, v102, v103
  v_exp_f32 v113, v113
  v_add_f32 v61, v61, v112
  v_exp_f32 v114, v114
  v_add_f32 v61, v61, v113
  v_cvt_pk_bf16_f32 v112, v112, v113
  v_exp_f32 v115, v115
  v_add_f32 v61, v61, v114
  v_exp_f32 v116, v116
  v_add_f32 v61, v61, v115
  v_cvt_pk_bf16_f32 v113, v114, v115
  v_exp_f32 v117, v117
  v_add_f32 v61, v61, v116
  v_exp_f32 v118, v118
  v_add_f32 v61, v61, v117
  v_cvt_pk_bf16_f32 v114, v116, v117
  v_exp_f32 v119, v119
  v_add_f32 v61, v61, v118
  v_exp_f32 v104, v104
  v_add_f32 v61, v61, v119
  v_cvt_pk_bf16_f32 v115, v118, v119
  v_exp_f32 v105, v105
  v_add_f32 v60, v60, v104
  v_exp_f32 v106, v106
  v_add_f32 v60, v60, v105
  v_cvt_pk_bf16_f32 v104, v104, v105
  v_exp_f32 v107, v107
  v_add_f32 v60, v60, v106
  v_exp_f32 v108, v108
  v_add_f32 v60, v60, v107
  v_cvt_pk_bf16_f32 v105, v106, v107
  v_exp_f32 v109, v109
  v_add_f32 v60, v60, v108
  v_exp_f32 v110, v110
  v_add_f32 v60, v60, v109
  v_cvt_pk_bf16_f32 v106, v108, v109
  v_exp_f32 v111, v111
  v_add_f32 v60, v60, v110
  v_exp_f32 v120, v120
  v_add_f32 v60, v60, v111
  v_cvt_pk_bf16_f32 v107, v110, v111
  v_exp_f32 v121, v121
  v_add_f32 v61, v61, v120
  v_exp_f32 v122, v122
  v_add_f32 v61, v61, v121
  v_cvt_pk_bf16_f32 v120, v120, v121
  v_exp_f32 v123, v123
  v_add_f32 v61, v61, v122
  v_exp_f32 v124, v124
  v_add_f32 v61, v61, v123
  v_cvt_pk_bf16_f32 v121, v122, v123
  v_exp_f32 v125, v125
  v_add_f32 v61, v61, v124
  v_exp_f32 v126, v126
  v_add_f32 v61, v61, v125
  v_cvt_pk_bf16_f32 v122, v124, v125
  v_exp_f32 v127, v127
  v_add_f32 v61, v61, v126
  v_add_f32 v61, v61, v127
  v_cvt_pk_bf16_f32 v123, v126, v127
  s_waitcnt lgkmcnt(0)
  s_nop 3
  v_mfma_f32_32x32x16_bf16 a[0:15], a[176:179], v[96:99], a[0:15]
  v_mfma_f32_32x32x16_bf16 a[16:31], a[176:179], v[112:115], a[16:31]
  v_mfma_f32_32x32x16_bf16 a[32:47], a[180:183], v[96:99], a[32:47]
  v_mfma_f32_32x32x16_bf16 a[48:63], a[180:183], v[112:115], a[48:63]
  v_mfma_f32_32x32x16_bf16 a[64:79], a[184:187], v[96:99], a[64:79]
  v_mfma_f32_32x32x16_bf16 a[80:95], a[184:187], v[112:115], a[80:95]
  v_mfma_f32_32x32x16_bf16 a[96:111], a[188:191], v[96:99], a[96:111]
  v_mfma_f32_32x32x16_bf16 a[112:127], a[188:191], v[112:115], a[112:127]
  v_mfma_f32_32x32x16_bf16 a[0:15], a[192:195], v[104:107], a[0:15]
  v_mfma_f32_32x32x16_bf16 a[16:31], a[192:195], v[120:123], a[16:31]
  v_mfma_f32_32x32x16_bf16 a[32:47], a[196:199], v[104:107], a[32:47]
  v_mfma_f32_32x32x16_bf16 a[48:63], a[196:199], v[120:123], a[48:63]
  v_mfma_f32_32x32x16_bf16 a[64:79], a[200:203], v[104:107], a[64:79]
  v_mfma_f32_32x32x16_bf16 a[80:95], a[200:203], v[120:123], a[80:95]
  v_mfma_f32_32x32x16_bf16 a[96:111], a[204:207], v[104:107], a[96:111]
  v_mfma_f32_32x32x16_bf16 a[112:127], a[204:207], v[120:123], a[112:127]
  s_nop 15
  s_add_u32 s55, s55, 8192
  s_cmp_lt_u32 s55, s3
  s_cbranch_scc1 Lslow2
  v_mov_b32 v2, v60
  v_mov_b32 v3, v61
  s_nop 0
  v_permlane32_swap_b32 v2, v60
  v_permlane32_swap_b32 v3, v61
  v_add_f32 v60, v60, v2
  v_add_f32 v61, v61, v3
  v_rcp_f32 v32, v60
  v_rcp_f32 v33, v61
  v_lshrrev_b32 v6, 2, v1
  v_and_b32 v5, 3, v1
  v_lshlrev_b32 v5, 3, v5
  v_lshl_add_u32 v7, v6, 8, v5
  v_and_b32 v6, 7, v6
  v_lshl_add_u32 v7, v6, 5, v7
  v_add_u32 v240, s52, v7
  v_xor_b32 v241, 32, v240
  v_xor_b32 v242, 64, v240
  v_xor_b32 v243, 96, v240
  v_xor_b32 v244, 128, v240
  v_xor_b32 v245, 160, v240
  v_xor_b32 v246, 192, v240
  v_xor_b32 v247, 224, v240
  s_add_u32 m0, s52, 0
  s_xor_b32 s54, s58, 0
  buffer_load_dwordx4 v42, s[24:27], s54 offen offset:0 lds
  buffer_load_dwordx4 v43, s[24:27], s54 offen offset:1024 lds
  buffer_load_dwordx4 v44, s[24:27], s54 offen offset:2048 lds
  buffer_load_dwordx4 v45, s[24:27], s54 offen offset:3072 lds
  s_add_u32 m0, s52, 4096
  s_xor_b32 s54, s58, 16384
  buffer_load_dwordx4 v42, s[24:27], s54 offen offset:0 lds
  buffer_load_dwordx4 v43, s[24:27], s54 offen offset:1024 lds
  buffer_load_dwordx4 v44, s[24:27], s54 offen offset:2048 lds
  buffer_load_dwordx4 v45, s[24:27], s54 offen offset:3072 lds
  s_add_u32 m0, s52, 8192
  s_xor_b32 s54, s58, 32768
  buffer_load_dwordx4 v42, s[24:27], s54 offen offset:0 lds
  buffer_load_dwordx4 v43, s[24:27], s54 offen offset:1024 lds
  buffer_load_dwordx4 v44, s[24:27], s54 offen offset:2048 lds
  buffer_load_dwordx4 v45, s[24:27], s54 offen offset:3072 lds
  s_add_u32 m0, s52, 12288
  s_xor_b32 s54, s58, 49152
  buffer_load_dwordx4 v42, s[24:27], s54 offen offset:0 lds
  buffer_load_dwordx4 v43, s[24:27], s54 offen offset:1024 lds
  buffer_load_dwordx4 v44, s[24:27], s54 offen offset:2048 lds
  buffer_load_dwordx4 v45, s[24:27], s54 offen offset:3072 lds
  s_waitcnt vmcnt(0)
  s_nop 7
  s_branch Lrejoin
Lmain_end:
  s_endpgm
.section .rodata,"a"
.p2align 6
.amdhsa_kernel recurrent_scan__sliding_block_cached__glu_gated_glu__prompt_kernel
  .amdhsa_next_free_vgpr 512
  .amdhsa_next_free_sgpr 102
  .amdhsa_accum_offset 256
  .amdhsa_group_segment_fixed_size 0
  .amdhsa_kernarg_size 96
  .amdhsa_user_sgpr_count 2
  .amdhsa_user_sgpr_kernarg_segment_ptr 1
  .amdhsa_system_sgpr_workgroup_id_x 1
.end_amdhsa_kernel
```
